```python
import torch

def _softmax(x, axis=-1):
    return torch.softmax(x, dim=axis)

def _gelu(x):
    return torch.nn.functional.gelu(x, approximate='tanh')

def _silu(x):
    return torch.nn.functional.silu(x)

def _sigmoid(x):
    return torch.sigmoid(x)

def _layernorm(x, axis=-1, eps=1e-05):
    m = x.mean(dim=axis, keepdim=True)
    v = x.var(dim=axis, keepdim=True, unbiased=False)
    return (x - m) / torch.sqrt(v + eps)

def _scatter_add(tgt, idx, src, axis=0):
    return tgt.clone().index_add_(axis, idx, src)

def _segment_sum(src, seg, n):
    out = torch.zeros((n,) + src.shape[1:], dtype=src.dtype)
    return out.index_add_(0, seg, src)

def _pad(x, pw):
    flat = tuple((v for pair in reversed(pw) for v in pair))
    return torch.nn.functional.pad(x, flat)
kernel_name = 'adaLN_cond__ssm_conv_s4__glu_gated_geglu__prompt'

def setup_inputs():

    _w = lambda a: (lambda t: t.to(torch.bfloat16) if t.is_floating_point() else t)(torch.as_tensor(a))

    def _A_setup():
        B, L, D, N = (1, 2048, 640, 192)
        A_re = -(lambda _x: torch.exp(torch.as_tensor(_x)))((lambda *s: torch.randn(*s, dtype=torch.bfloat16) * 3.2)(D, N))
        A_im = torch.pi * (lambda *s: torch.randn(*s, dtype=torch.bfloat16) * 0.1)(D, N)
        B_re = (lambda *s: torch.randn(*s, dtype=torch.bfloat16) * 0.1)(D, N)
        B_im = (lambda *s: torch.randn(*s, dtype=torch.bfloat16) * 0.1)(D, N)
        C_re = (lambda *s: torch.randn(*s, dtype=torch.bfloat16) * 0.1)(D, N)
        C_im = (lambda *s: torch.randn(*s, dtype=torch.bfloat16) * 0.1)(D, N)
        log_dt = (lambda *s: torch.randn(*s, dtype=torch.bfloat16) * 0.1)(D) * 0.5 - 4.0
        Dskip = (lambda *s: torch.randn(*s, dtype=torch.bfloat16) * 0.1)(D)
        return {'u': _w((lambda *s: torch.randn(*s, dtype=torch.bfloat16) * 0.05)(B, L, D)), 'A_re': _w(A_re), 'A_im': _w(A_im), 'B_re': _w(B_re), 'B_im': _w(B_im), 'C_re': _w(C_re), 'C_im': _w(C_im), 'log_dt': _w(log_dt), 'Dskip': _w(Dskip)}
    _A_in = _A_setup()

    def _B_setup():
        B, S, Dm, Df = (1, 2048, 640, 1536)
        return {'x': _w((lambda *s: torch.randn(*s, dtype=torch.bfloat16) * 0.05)(B, S, Dm)), 'w_gate': _w((lambda *s: torch.randn(*s, dtype=torch.bfloat16) * 1.6)(Dm, Df) * Dm ** (-0.5)), 'w_up': _w((lambda *s: torch.randn(*s, dtype=torch.bfloat16) * 1.6)(Dm, Df) * Dm ** (-0.5)), 'w_down': _w((lambda *s: torch.randn(*s, dtype=torch.bfloat16) * 1.6)(Df, Dm) * Df ** (-0.5))}
    _B_in = _B_setup()
    return {'A_u': _A_in['u'], 'A_A_re': _A_in['A_re'], 'A_A_im': _A_in['A_im'], 'A_B_re': _A_in['B_re'], 'A_B_im': _A_in['B_im'], 'A_C_re': _A_in['C_re'], 'A_C_im': _A_in['C_im'], 'A_log_dt': _A_in['log_dt'], 'A_Dskip': _A_in['Dskip'], 'B_x': _B_in['x'], 'B_w_gate': _B_in['w_gate'], 'B_w_up': _B_in['w_up'], 'B_w_down': _B_in['w_down'], 'c': _w((lambda *s: torch.randn(*s, dtype=torch.bfloat16) * 0.1)(1, 640) * 8.0), 'w_mod': _w((lambda *s: torch.randn(*s, dtype=torch.bfloat16) * 0.1)(640, 6 * 640) * 640 ** (-0.5) * 8.0)}

def reference(A_u, A_A_re, A_A_im, A_B_re, A_B_im, A_C_re, A_C_im, A_log_dt, A_Dskip, B_x, B_w_gate, B_w_up, B_w_down, c, w_mod):

    def _A_ref(u, A_re, A_im, B_re, B_im, C_re, C_im, log_dt, Dskip):
        Bsz, L, D = u.shape
        dt = torch.exp(log_dt)[:, None]
        A = A_re + 1j * A_im
        Bc = B_re + 1j * B_im
        Cc = C_re + 1j * C_im
        logdA = dt * A
        dB = dt * Bc
        l = (lambda x, dt: x.to(dt))(torch.arange(L), A_re.dtype)
        P = torch.exp(logdA[:, :, None] * l[None, None, :])
        K = torch.einsum('dn,dnl,dn->dl', Cc, P, dB).real
        L2 = 2 * L
        Kp = _pad(K, ((0, 0), (0, L)))
        up = (lambda x, *d: x.permute(*d))(u, 0, 2, 1)
        up = _pad(up, ((0, 0), (0, 0), (0, L)))
        Kf = (lambda x, axes=(-2, -1): torch.fft.rfft2(x.float(), dim=axes))(Kp[:, None, :], axes=(-2, -1))
        Uf = (lambda x, axes=(-2, -1): torch.fft.rfft2(x.float(), dim=axes))(up[:, :, None, :], axes=(-2, -1))
        Yf = Uf * Kf[None, :, :, :]
        y = (lambda x, s, axes=(-2, -1): torch.fft.irfft2(x, s=s, dim=axes).to(torch.bfloat16))(Yf, (1, L2), axes=(-2, -1))[:, :, 0, :L]
        y = (lambda x, *d: x.permute(*d))(y, 0, 2, 1) + u * Dskip[None, None, :]
        return y

    def _B_ref(x, w_gate, w_up, w_down):
        g = torch.einsum('bsd,df->bsf', x, w_gate)
        u = torch.einsum('bsd,df->bsf', x, w_up)
        h = _gelu(g) * u
        return torch.einsum('bsf,fd->bsd', h, w_down)
    x = A_u
    mod = (_silu(c) @ w_mod).reshape(c.shape[0], 6, 1, -1)
    sa, ca, ga, sb, cb, gb = (mod[:, 0].clone(), mod[:, 1].clone(), mod[:, 2].clone(), mod[:, 3].clone(), mod[:, 4].clone(), mod[:, 5].clone())
    h = _layernorm(x, axis=-1) * (1 + ca) + sa
    x = x + ga * _A_ref(h, A_A_re, A_A_im, A_B_re, A_B_im, A_C_re, A_C_im, A_log_dt, A_Dskip)
    h = _layernorm(x, axis=-1) * (1 + cb) + sb
    x = x + gb * _B_ref(h, B_w_gate, B_w_up, B_w_down)
    return x
```

```asm
; @launch grid=(256,1,1) block=(256,1,1) lds=163840
.amdgcn_target "amdgcn-amd-amdhsa--gfx950"
.text
.globl adaLN_cond__ssm_conv_s4__glu_gated_geglu__prompt_kernel
.p2align 8
.type adaLN_cond__ssm_conv_s4__glu_gated_geglu__prompt_kernel,@function
adaLN_cond__ssm_conv_s4__glu_gated_geglu__prompt_kernel:
  s_cmp_ge_u32 s2, 256
  s_cbranch_scc1 f_end
  s_cmp_ge_u32 s2, 160
  s_cbranch_scc1 u_e1
  s_load_dwordx16 s[4:19], s[0:1], 8
  s_mov_b32 s49, 0
  s_branch u_e2
u_e1:
  s_load_dwordx4 s[4:7], s[0:1], 80
  s_load_dwordx4 s[8:11], s[0:1], 104
  s_mov_b32 s49, 1
u_e2:
  s_load_dwordx2 s[22:23], s[0:1], 136
  s_load_dwordx2 s[36:37], s[0:1], 0
  s_load_dwordx2 s[38:39], s[0:1], 96
  s_load_dwordx2 s[66:67], s[0:1], 120
  v_lshrrev_b32 v1, 6, v0
  s_getpc_b64 s[40:41]
u_pc:
  v_readfirstlane_b32 s20, v1
  s_lshr_b32 s42, s2, 3
  s_lshl_b32 s42, s42, 11
  v_and_b32 v2, 3, v0
  v_lshl_add_u32 v2, v1, 2, v2
  v_lshl_add_u32 v2, v2, 7, s42
  v_min_u32 v2, code_end-u_pc-4, v2
  v_mov_b32 v3, s41
  v_add_co_u32 v2, vcc, s40, v2
  s_nop 1
  v_addc_co_u32 v3, vcc, 0, v3, vcc
  s_mov_b64 exec, 15
  global_load_dword v255, v[2:3], off
  s_mov_b64 exec, -1
  v_and_b32 v1, 63, v0
  v_mov_b32 v247, 589760
  s_and_b32 s100, s2, 7
  s_mul_i32 s100, s100, 73984
  s_add_u32 s100, s100, 4194304
  s_cmp_eq_u32 s49, 0
  s_cbranch_scc1 f_conv
  s_sub_u32 s3, s2, 160
  s_lshr_b32 s12, s3, 2
  s_and_b32 s13, s3, 3
  s_mul_i32 s16, s13, 160
  v_lshrrev_b32 v50, 3, v0
  v_add_u32 v50, s16, v50
  v_mul_u32_u24 v51, 7680, v50
  v_and_b32 v5, 7, v0
  v_lshl_add_u32 v51, v5, 4, v51
  v_lshlrev_b32 v50, 1, v50
  s_add_u32 s26, s3, 0
  s_cmp_ge_u32 s26, 240
  s_cselect_b32 s27, 48, 0
  s_sub_u32 s26, s26, s27
  s_lshr_b32 s27, s26, 2
  s_mul_i32 s28, s27, 6554
  s_lshr_b32 s28, s28, 16
  s_mul_i32 s29, s28, 10
  s_sub_u32 s27, s27, s29
  s_lshl_b32 s28, s28, 2
  s_lshr_b32 s28, 5447940, s28
  s_and_b32 s28, s28, 7
  s_mul_i32 s28, s28, 10
  s_add_u32 s27, s27, s28
  s_lshl_b32 s28, s27, 7
  v_add_u32 v48, s28, v51
  s_lshl_b32 s27, s27, 8
  s_mul_i32 s28, s13, 15360
  s_add_u32 s27, s27, s28
  s_add_u32 s50, s27, 0
  s_waitcnt lgkmcnt(0)
  global_load_ushort v56, v50, s[8:9] offset:0
  global_load_ushort v57, v50, s[8:9] offset:64
  global_load_ushort v58, v50, s[8:9] offset:128
  global_load_ushort v59, v50, s[8:9] offset:192
  global_load_ushort v60, v50, s[8:9] offset:256
  global_load_dwordx4 v[68:71], v48, s[10:11]
  v_add_u32 v48, 245760, v48
  global_load_dwordx4 v[72:75], v48, s[10:11]
  v_add_u32 v48, 245760, v48
  global_load_dwordx4 v[76:79], v48, s[10:11]
  v_add_u32 v48, 245760, v48
  global_load_dwordx4 v[80:83], v48, s[10:11]
  v_add_u32 v48, 245760, v48
  global_load_dwordx4 v[84:87], v48, s[10:11]
  s_mov_b64 exec, 1
  global_load_dword v248, v247, s[22:23] sc1
  s_mov_b64 exec, -1
  s_mov_b64 exec, 0
  s_cmp_eq_u32 s20, 0
  s_cbranch_scc1 warm0
  s_cmp_eq_u32 s20, 1
  s_cbranch_scc1 warm1
  s_cmp_eq_u32 s20, 2
  s_cbranch_scc1 warm2
  s_cbranch_execz warm3
warm_aux:
  s_mov_b64 exec, -1
  s_branch body_aux
f_conv:
  s_and_b32 s21, s2, 7
  s_mul_i32 s21, s21, 20
  s_lshr_b32 s3, s2, 3
  s_add_u32 s21, s21, s3
  s_lshl_b32 s48, s21, 2
  s_add_u32 s48, s48, s20
  s_mul_i32 s25, s48, 384
  v_lshl_add_u32 v138, v1, 2, s25
  v_lshl_add_u32 v139, v1, 1, s25
  s_lshr_b32 s26, s48, 1
  s_lshl_b32 s26, s26, 2
  v_and_b32 v5, 15, v1
  v_lshrrev_b32 v6, 4, v1
  v_lshlrev_b32 v7, 3, v6
  s_and_b32 s40, s2, 3
  s_bfe_u32 s41, s2, 0x50002
  s_lshl_b32 s42, s41, 5
  s_lshl_b32 s43, s20, 3
  s_add_u32 s42, s42, s43
  s_add_u32 s42, s42, s40
  s_mul_i32 s42, s42, 2560
  v_lshrrev_b32 v3, 1, v6
  v_and_b32 v4, 1, v6
  v_lshl_add_u32 v2, v3, 3, v4
  v_mul_u32_u24 v2, 1280, v2
  v_lshl_add_u32 v2, v5, 4, v2
  v_add_u32 v2, s42, v2
  s_lshl_b32 s42, s20, 5
  s_add_u32 s43, s42, 129280
  v_mul_u32_u24 v28, 144, v5
  v_add3_u32 v28, v28, v7, s43
  s_lshr_b32 s43, s41, 3
  s_lshl_b32 s43, s43, 12
  s_lshl_b32 s44, s40, 10
  s_add_u32 s43, s43, s44
  s_and_b32 s44, s41, 7
  s_lshl_b32 s44, s44, 7
  s_add_u32 s43, s43, s44
  s_add_u32 s44, s43, s42
  s_add_u32 s44, s44, 131072
  v_add_u32 v31, s44, v7
  s_and_b32 s44, s20, 1
  s_mul_i32 s44, s44, 40
  v_lshrrev_b32 v3, 3, v1
  v_add_u32 v3, s44, v3
  v_and_b32 v4, 7, v1
  v_lshlrev_b32 v4, 4, v4
  s_waitcnt lgkmcnt(0)
  s_load_dword s27, s[16:17], s26
  s_load_dword s28, s[18:19], s26
  global_load_dword v112, v138, s[4:5]
  global_load_dword v113, v138, s[6:7]
  global_load_dword v114, v138, s[8:9]
  global_load_dword v115, v138, s[10:11]
  global_load_dword v116, v138, s[12:13]
  global_load_dword v117, v138, s[14:15]
  s_cmp_ge_u32 s2, 128
  s_cbranch_scc1 u_noiss
  global_load_dwordx4 v[8:11], v2, s[36:37] offset:0
  global_load_dwordx4 v[12:15], v2, s[36:37] offset:256
  global_load_dwordx4 v[16:19], v2, s[36:37] offset:512
  global_load_dwordx4 v[20:23], v2, s[36:37] offset:768
  global_load_dwordx4 v[24:27], v2, s[36:37] offset:1024
u_noiss:
  global_load_ushort v118, v139, s[4:5] offset:256
  global_load_ushort v119, v139, s[6:7] offset:256
  global_load_ushort v120, v139, s[8:9] offset:256
  global_load_ushort v121, v139, s[10:11] offset:256
  global_load_ushort v122, v139, s[12:13] offset:256
  global_load_ushort v123, v139, s[14:15] offset:256
  s_mov_b64 exec, 1
  global_load_dword v248, v247, s[22:23] sc1
  s_mov_b64 exec, -1
  v_mul_u32_u24 v29, 144, v3
  s_lshr_b32 s44, s20, 1
  s_mul_i32 s42, s44, 11520
  s_add_u32 s42, s42, 129280
  v_add3_u32 v29, v29, v4, s42
  v_mul_u32_u24 v30, 33280, v3
  s_mul_i32 s44, s44, 16640
  s_add_u32 s43, s43, s44
  s_add_u32 s43, s43, 1048576
  v_add3_u32 v30, v30, v4, s43
  s_lshl_b32 s44, s2, 4
  s_add_u32 s44, s44, 4194304
  v_mul_u32_u24 v246, 73984, v1
  v_add_u32 v246, s44, v246
  s_and_b32 s44, s2, 7
  s_lshl_b32 s44, s44, 8
  s_add_u32 s44, s44, 4980864
  v_lshl_add_u32 v244, v1, 2, s44
  s_lshl_b32 s43, s3, 2
  s_add_u32 s44, s44, s43
  v_mov_b32 v243, s44
  s_mov_b32 s45, 0x3f803f80
  s_mov_b32 s46, 0x00010001
  s_mov_b32 s47, 0x00010001
  s_min_u32 s30, s2, 127
  s_lshl_b32 s30, s30, 11
  s_add_u32 s30, s30, 262144
  v_lshl_add_u32 v80, v0, 3, s30
  v_mov_b32 v82, -1.0
  v_mov_b32 v83, -1.0
  s_mul_i32 s29, s20, 14688
  s_mov_b32 m0, s29
  v_and_b32 v124, 31, v1
  v_mul_u32_u24 v124, 272, v124
  v_lshrrev_b32 v76, 5, v1
  v_lshl_add_u32 v76, v76, 4, s29
  v_add_u32 v124, v124, v76
  v_mov_b32 v127, 0x3f80
  v_mov_b32 v224, 0
  s_mov_b32 s34, 1069066811
  s_mov_b32 s35, 1042479491
  v_and_b32 v77, 31, v1
  v_lshrrev_b32 v78, 2, v77
  v_and_b32 v77, 3, v77
  v_lshlrev_b32 v77, 3, v77
  v_mov_b32 v125, 50462976
  v_cmp_eq_u32 vcc, 1, v78
  v_mov_b32 v79, 185207049
  s_nop 0
  v_cndmask_b32 v125, v125, v79, vcc
  v_cmp_eq_u32 vcc, 2, v78
  v_mov_b32 v79, 117835012
  s_nop 0
  v_cndmask_b32 v125, v125, v79, vcc
  v_cmp_eq_u32 vcc, 3, v78
  v_mov_b32 v79, 218893067
  s_nop 0
  v_cndmask_b32 v125, v125, v79, vcc
  v_cmp_eq_u32 vcc, 4, v78
  v_mov_b32 v79, 302976520
  s_nop 0
  v_cndmask_b32 v125, v125, v79, vcc
  v_cmp_eq_u32 vcc, 5, v78
  v_mov_b32 v79, 319885325
  s_nop 0
  v_cndmask_b32 v125, v125, v79, vcc
  v_cmp_eq_u32 vcc, 6, v78
  v_mov_b32 v79, 20
  s_nop 0
  v_cndmask_b32 v125, v125, v79, vcc
  v_cmp_eq_u32 vcc, 7, v78
  v_mov_b32 v79, 21
  s_nop 0
  v_cndmask_b32 v125, v125, v79, vcc
  v_bfe_u32 v125, v125, v77, 8
  v_mul_u32_u24 v125, 272, v125
  v_add_u32 v125, v125, v76
  v_mov_b32 v76, 1984
  v_lshlrev_b32 v76, v5, v76
  v_lshrrev_b32 v76, v7, v76
  v_and_b32 v76, 0xff, v76
  v_mul_u32_u24 v76, 0x8001, v76
  v_and_b32 v48, 0x10001, v76
  v_mul_u32_u24 v48, 0x3f80, v48
  v_lshrrev_b32 v76, 2, v76
  v_and_b32 v49, 0x10001, v76
  v_mul_u32_u24 v49, 0x3f80, v49
  v_lshrrev_b32 v76, 2, v76
  v_and_b32 v50, 0x10001, v76
  v_mul_u32_u24 v50, 0x3f80, v50
  v_lshrrev_b32 v76, 2, v76
  v_and_b32 v51, 0x10001, v76
  v_mul_u32_u24 v51, 0x3f80, v51
  v_mov_b32 v76, 56
  v_lshlrev_b32 v76, v5, v76
  v_lshrrev_b32 v76, v7, v76
  v_and_b32 v76, 0xff, v76
  v_mul_u32_u24 v76, 0x8001, v76
  v_and_b32 v52, 0x10001, v76
  v_mul_u32_u24 v52, 0x3f80, v52
  v_lshrrev_b32 v76, 2, v76
  v_and_b32 v53, 0x10001, v76
  v_mul_u32_u24 v53, 0x3f80, v53
  v_lshrrev_b32 v76, 2, v76
  v_and_b32 v54, 0x10001, v76
  v_mul_u32_u24 v54, 0x3f80, v54
  v_lshrrev_b32 v76, 2, v76
  v_and_b32 v55, 0x10001, v76
  v_mul_u32_u24 v55, 0x3f80, v55
  v_mov_b32 v76, 14336
  v_lshlrev_b32 v76, v5, v76
  v_lshrrev_b32 v76, v7, v76
  v_and_b32 v76, 0xff, v76
  v_mul_u32_u24 v76, 0x8001, v76
  v_and_b32 v60, 0x10001, v76
  v_mul_u32_u24 v60, 0x3f80, v60
  v_lshrrev_b32 v76, 2, v76
  v_and_b32 v61, 0x10001, v76
  v_mul_u32_u24 v61, 0x3f80, v61
  v_lshrrev_b32 v76, 2, v76
  v_and_b32 v62, 0x10001, v76
  v_mul_u32_u24 v62, 0x3f80, v62
  v_lshrrev_b32 v76, 2, v76
  v_and_b32 v63, 0x10001, v76
  v_mul_u32_u24 v63, 0x3f80, v63
  v_mov_b32 v76, 8176
  v_lshlrev_b32 v76, v5, v76
  v_lshrrev_b32 v76, v7, v76
  v_and_b32 v76, 0xff, v76
  v_mul_u32_u24 v76, 0x8001, v76
  v_and_b32 v64, 0x10001, v76
  v_mul_u32_u24 v64, 0x3f80, v64
  v_lshrrev_b32 v76, 2, v76
  v_and_b32 v65, 0x10001, v76
  v_mul_u32_u24 v65, 0x3f80, v65
  v_lshrrev_b32 v76, 2, v76
  v_and_b32 v66, 0x10001, v76
  v_mul_u32_u24 v66, 0x3f80, v66
  v_lshrrev_b32 v76, 2, v76
  v_and_b32 v67, 0x10001, v76
  v_mul_u32_u24 v67, 0x3f80, v67
  v_mov_b32 v76, 4064
  v_lshlrev_b32 v76, v5, v76
  v_lshrrev_b32 v76, v7, v76
  v_and_b32 v76, 0xff, v76
  v_mul_u32_u24 v76, 0x8001, v76
  v_and_b32 v68, 0x10001, v76
  v_mul_u32_u24 v68, 0x3f80, v68
  v_lshrrev_b32 v76, 2, v76
  v_and_b32 v69, 0x10001, v76
  v_mul_u32_u24 v69, 0x3f80, v69
  v_lshrrev_b32 v76, 2, v76
  v_and_b32 v70, 0x10001, v76
  v_mul_u32_u24 v70, 0x3f80, v70
  v_lshrrev_b32 v76, 2, v76
  v_and_b32 v71, 0x10001, v76
  v_mul_u32_u24 v71, 0x3f80, v71
  v_mov_b32 v76, 12288
  v_lshlrev_b32 v76, v5, v76
  v_lshrrev_b32 v76, v7, v76
  v_and_b32 v76, 0xff, v76
  v_mul_u32_u24 v76, 0x8001, v76
  v_and_b32 v72, 0x10001, v76
  v_lshrrev_b32 v76, 2, v76
  v_and_b32 v73, 0x10001, v76
  v_lshrrev_b32 v76, 2, v76
  v_and_b32 v74, 0x10001, v76
  v_lshrrev_b32 v76, 2, v76
  v_and_b32 v75, 0x10001, v76
  s_mul_i32 s24, s20, 3072
  s_add_u32 s24, s24, 116992
  s_mul_i32 s30, s20, 4608
  s_add_u32 s30, s30, 81920
  v_lshlrev_b32 v100, 5, v5
  v_lshl_add_u32 v100, v6, 4, v100
  v_add_u32 v100, s30, v100
  v_lshl_add_u32 v106, v1, 3, s30
  v_and_b32 v76, 1, v5
  v_mul_u32_u24 v76, 1102, v76
  v_sub_u32 v101, v7, v5
  v_lshl_add_u32 v101, v101, 1, v76
  v_add_u32 v101, 32, v101
  v_add_u32 v101, s24, v101
  v_add_u32 v109, 1024, v101
  v_lshlrev_b32 v76, 2, v6
  v_sub_u32 v76, v76, v5
  v_lshl_add_u32 v102, v76, 3, s24
  v_lshl_add_u32 v103, v76, 2, s24
  v_add_u32 v103, 2764, v103
  s_mul_i32 s30, s20, 4160
  s_add_u32 s30, s30, 100352
  v_lshlrev_b32 v104, 5, v5
  v_add3_u32 v104, v104, v7, s30
  v_lshlrev_b32 v105, 4, v0
  v_add_u32 v105, 81920, v105
  v_lshlrev_b32 v76, 4, v1
  v_sub_u32 v220, s24, v76
  v_lshlrev_b32 v76, 2, v1
  v_sub_u32 v222, s24, v76
  v_lshlrev_b32 v76, 1, v1
  v_sub_u32 v223, s24, v76
  v_and_b32 v221, 31, v1
  v_mov_b32 v76, v221
  v_cmp_le_u32 vcc, 4, v76
  v_mov_b32 v77, 64
  s_nop 0
  v_cndmask_b32 v77, 0, v77, vcc
  v_add_u32 v221, v221, v77
  v_cmp_le_u32 vcc, 9, v76
  v_mov_b32 v77, 64
  s_nop 0
  v_cndmask_b32 v77, 0, v77, vcc
  v_add_u32 v221, v221, v77
  v_cmp_le_u32 vcc, 17, v76
  v_mov_b32 v77, 16
  s_nop 0
  v_cndmask_b32 v77, 0, v77, vcc
  v_add_u32 v221, v221, v77
  v_cmp_le_u32 vcc, 25, v76
  v_mov_b32 v77, 16
  s_nop 0
  v_cndmask_b32 v77, 0, v77, vcc
  v_add_u32 v221, v221, v77
  v_lshl_add_u32 v221, v221, 4, s24
  v_mov_b32 v228, 0
  v_mov_b32 v229, 0
  v_mov_b32 v230, 0
  v_mov_b32 v231, 0
  s_lshl_b32 s31, s20, 12
  s_lshl_b32 s30, s20, 9
  s_add_u32 s30, s30, s100
  v_lshl_add_u32 v225, v1, 4, s30
  v_lshl_add_u32 v233, v1, 4, s31
  s_mul_i32 s30, s21, 16640
  s_add_u32 s30, s30, 1048576
  v_add_u32 v232, s30, v233
  v_add_u32 v233, 131072, v233
  v_bfe_u32 v76, v1, 2, 2
  v_and_b32 v77, 1, v6
  v_mul_u32_u24 v76, 30720, v76
  v_mul_u32_u24 v227, 5120, v6
  s_mov_b32 s56, -1
  s_mov_b32 s57, 0xffff
  s_add_u32 s58, s20, 32
  v_add_u32 v227, v227, v76
  v_and_b32 v76, 3, v1
  v_lshlrev_b32 v76, 3, v76
  s_lshl_b32 s30, s21, 5
  s_add_u32 s30, s30, 655360
  v_add3_u32 v227, v227, v76, s30
  v_cvt_f32_u32 v242, v77
  s_min_u32 s4, s2, 239
  s_mul_i32 s5, s4, 13108
  s_lshr_b32 s5, s5, 16
  s_mul_i32 s6, s5, 5
  s_sub_u32 s4, s4, s6
  s_lshl_b32 s4, s4, 2
  s_add_u32 s4, s4, s20
  s_mul_i32 s6, s5, 40960
  s_lshl_b32 s7, s4, 6
  s_add_u32 s6, s6, s7
  s_mov_b64 exec, 0
  s_cmp_eq_u32 s20, 0
  s_cbranch_scc1 warm0
  s_cmp_eq_u32 s20, 1
  s_cbranch_scc1 warm1
  s_cmp_eq_u32 s20, 2
  s_cbranch_scc1 warm2
  s_cbranch_execz warm3
warm_conv:
  s_mov_b64 exec, -1
  s_branch body_conv
warm_back:
  s_cmp_eq_u32 s49, 0
  s_cbranch_scc1 warm_conv
  s_branch warm_aux
.p2align 12
body_aux:
warm0:
  s_cbranch_execz warm4
  s_add_u32 s26, s3, 96
  s_cmp_ge_u32 s26, 240
  s_cselect_b32 s27, 48, 0
  s_sub_u32 s26, s26, s27
  s_lshr_b32 s27, s26, 2
  s_mul_i32 s28, s27, 6554
  s_lshr_b32 s28, s28, 16
  s_mul_i32 s29, s28, 10
  s_sub_u32 s27, s27, s29
  s_lshl_b32 s28, s28, 2
  s_lshr_b32 s28, 5447940, s28
  s_and_b32 s28, s28, 7
  s_mul_i32 s28, s28, 10
  s_add_u32 s27, s27, s28
  s_lshl_b32 s28, s27, 7
  v_add_u32 v49, s28, v51
  s_lshl_b32 s27, s27, 8
  s_mul_i32 s28, s13, 15360
  s_add_u32 s27, s27, s28
  s_add_u32 s52, s27, 0
  v_lshrrev_b32 v6, 4, v1
  v_lshlrev_b32 v53, 3, v6
  v_lshl_add_u32 v53, v5, 5, v53
  s_lshl_b32 s26, s20, 8
  v_add_u32 v53, s26, v53
  v_and_b32 v7, 15, v1
  s_lshl_b32 s26, s20, 6
  v_lshl_add_u32 v55, v7, 2, s26
  v_lshl_add_u32 v54, v6, 8, v55
  s_lshr_b32 s14, s20, 1
  s_and_b32 s15, s20, 1
  v_lshrrev_b32 v52, 3, v1
  v_bfe_u32 v7, v1, 4, 1
  s_lshl_b32 s17, s20, 1
  v_or_b32 v7, s17, v7
  v_xor_b32 v7, v7, v5
  v_mul_u32_u24 v52, 3072, v52
  v_lshl_add_u32 v52, v7, 4, v52
  s_lshl_b32 s17, s15, 3
  s_add_u32 s17, s17, s16
  s_mul_i32 s17, s17, 3072
  s_lshl_b32 s18, s12, 7
  s_add_u32 s17, s17, s18
  v_add_u32 v52, s17, v52
  s_mul_i32 s18, s14, 20480
  s_lshl_b32 s19, s15, 10
  s_add_u32 s18, s18, s19
  s_cmp_eq_u32 s14, 0
  s_cselect_b32 s30, s4, s6
  s_cselect_b32 s31, s5, s7
  v_min_u32 v5, 159, v0
  v_add_u32 v6, s16, v5
  v_lshlrev_b32 v6, 3, v6
  v_add_u32 v44, 673280, v6
  v_add_u32 v45, 704000, v6
  v_add_u32 v46, 734720, v6
  v_add_u32 v47, 765440, v6
  v_lshrrev_b32 v6, 4, v1
  v_bfe_u32 v7, v1, 2, 2
  v_lshl_add_u32 v2, v6, 3, v7
  v_lshlrev_b32 v2, 7, v2
  v_bfe_u32 v3, v1, 1, 1
  v_mul_u32_u24 v4, 20480, v3
  v_add_u32 v2, v2, v4
  v_bfe_u32 v4, v1, 0, 1
  v_lshl_add_u32 v2, v4, 3, v2
  v_lshrrev_b32 v7, 1, v7
  v_and_b32 v4, 1, v6
  v_lshl_add_u32 v7, v4, 1, v7
  v_lshl_add_u32 v7, v3, 2, v7
  s_lshl_b32 s16, s20, 1
  v_xor_b32 v7, s16, v7
  v_lshl_add_u32 v16, v7, 4, v2
  v_xor_b32 v7, 1, v7
  v_lshl_add_u32 v17, v7, 4, v2
  v_lshlrev_b32 v18, 4, v6
  v_bfe_u32 v2, v1, 1, 2
  v_lshlrev_b32 v2, 2, v2
  v_lshl_add_u32 v2, v6, 4, v2
  v_bfe_u32 v3, v1, 3, 1
  v_lshl_add_u32 v2, v3, 1, v2
  v_and_b32 v3, 1, v1
  v_add_u32 v2, v2, v3
  s_lshl_b32 s24, s12, 3
  s_add_u32 s24, s24, s16
  s_add_u32 s25, s24, 0
  s_mul_i32 s26, s25, 21846
  s_lshr_b32 s26, s26, 16
  s_mul_i32 s26, s26, 60
  s_add_u32 s26, s26, s25
  s_lshl_b32 s26, s26, 10
  s_add_u32 s26, s26, 25165824
  s_mul_i32 s27, s13, 15360
  s_add_u32 s27, s27, s26
  v_lshl_add_u32 v19, v2, 4, s27
  s_lshl_b32 s27, s13, 8
  s_add_u32 s27, s27, s26
  s_add_u32 s27, s27, 61440
  v_lshl_add_u32 v21, v2, 4, s27
  s_add_u32 s25, s24, 1
  s_mul_i32 s26, s25, 21846
  s_lshr_b32 s26, s26, 16
  s_mul_i32 s26, s26, 60
  s_add_u32 s26, s26, s25
  s_lshl_b32 s26, s26, 10
  s_add_u32 s26, s26, 25165824
  s_mul_i32 s27, s13, 15360
  s_add_u32 s27, s27, s26
  v_lshl_add_u32 v20, v2, 4, s27
  s_lshl_b32 s27, s13, 8
  s_add_u32 s27, s27, s26
  s_add_u32 s27, s27, 61440
  v_lshl_add_u32 v22, v2, 4, s27
  v_lshlrev_b32 v5, 1, v5
  s_lshl_b32 s4, s3, 7
  s_add_u32 s4, s4, 4198400
  s_mov_b32 s63, s2
  v_lshrrev_b32 v23, 3, v1
  v_mul_u32_u24 v23, 73856, v23
  v_lshl_add_u32 v23, v1, 4, v23
  v_add_u32 v23, s4, v23
  s_add_u32 s26, s3, 192
  s_cmp_ge_u32 s26, 240
  s_cselect_b32 s27, 48, 0
  s_sub_u32 s26, s26, s27
  s_lshr_b32 s27, s26, 2
  s_mul_i32 s28, s27, 6554
  s_lshr_b32 s28, s28, 16
  s_mul_i32 s29, s28, 10
  s_sub_u32 s27, s27, s29
  s_lshl_b32 s28, s28, 2
  s_lshr_b32 s28, 5447940, s28
  s_and_b32 s28, s28, 7
  s_mul_i32 s28, s28, 10
  s_add_u32 s27, s27, s28
  s_lshl_b32 s28, s27, 7
  v_add_u32 v236, s28, v51
  s_lshl_b32 s27, s27, 8
  s_mul_i32 s28, s13, 15360
  s_add_u32 s27, s27, s28
  s_add_u32 s54, s27, 0
  s_min_u32 s4, s2, 239
  s_mul_i32 s5, s4, 13108
  s_lshr_b32 s5, s5, 16
  s_mul_i32 s6, s5, 5
  s_sub_u32 s4, s4, s6
  s_lshl_b32 s4, s4, 2
  s_add_u32 s4, s4, s20
  s_mul_i32 s6, s5, 40960
  s_lshl_b32 s7, s4, 6
  s_add_u32 s6, s6, s7
  v_lshrrev_b32 v250, 2, v1
  v_mul_u32_u24 v250, 1216, v250
  v_lshl_add_u32 v250, v1, 4, v250
  v_add_u32 v250, s6, v250
  s_mul_i32 s5, s5, 5
  s_lshl_b32 s4, s4, 1
  s_mul_i32 s6, s4, 13108
  s_lshr_b32 s6, s6, 16
  s_mul_i32 s6, s6, 235
  s_add_u32 s6, s6, s4
  s_add_u32 s6, s6, s5
  s_lshl_b32 s6, s6, 10
  s_add_u32 s40, s6, 6291456
  s_add_u32 s4, s4, 1
  s_mul_i32 s6, s4, 13108
  s_lshr_b32 s6, s6, 16
  s_mul_i32 s6, s6, 235
  s_add_u32 s6, s6, s4
  s_add_u32 s6, s6, s5
  s_lshl_b32 s6, s6, 10
  s_add_u32 s41, s6, 6291456
  s_add_u32 s4, s4, 1
  s_waitcnt vmcnt(10)
  v_lshlrev_b32 v56, 16, v56
  v_mul_f32 v61, 0xbfb8aa3b, v56
  v_exp_f32 v61, v61
  s_waitcnt vmcnt(9)
  v_lshlrev_b32 v57, 16, v57
  v_mul_f32 v62, 0xbfb8aa3b, v57
  v_exp_f32 v62, v62
  s_waitcnt vmcnt(8)
  v_lshlrev_b32 v58, 16, v58
  v_mul_f32 v63, 0xbfb8aa3b, v58
  v_exp_f32 v63, v63
  s_waitcnt vmcnt(7)
  v_lshlrev_b32 v59, 16, v59
  v_mul_f32 v64, 0xbfb8aa3b, v59
  v_exp_f32 v64, v64
  s_waitcnt vmcnt(6)
  v_lshlrev_b32 v60, 16, v60
  v_mul_f32 v65, 0xbfb8aa3b, v60
  v_exp_f32 v65, v65
  v_add_f32 v61, 1.0, v61
  v_rcp_f32 v61, v61
  v_add_f32 v62, 1.0, v62
  v_rcp_f32 v62, v62
  v_add_f32 v63, 1.0, v63
  v_rcp_f32 v63, v63
  v_add_f32 v64, 1.0, v64
  v_rcp_f32 v64, v64
  v_add_f32 v65, 1.0, v65
  v_rcp_f32 v65, v65
  v_mul_f32 v56, v56, v61
  v_mul_f32 v57, v57, v62
  v_mul_f32 v58, v58, v63
  v_mul_f32 v59, v59, v64
  v_mul_f32 v60, v60, v65
  v_cvt_pk_bf16_f32 v56, v56, 0
  v_lshlrev_b32 v61, 16, v56
  v_cvt_pk_bf16_f32 v57, v57, 0
  v_lshlrev_b32 v62, 16, v57
  v_cvt_pk_bf16_f32 v58, v58, 0
  v_lshlrev_b32 v63, 16, v58
  v_cvt_pk_bf16_f32 v59, v59, 0
  v_lshlrev_b32 v64, 16, v59
  v_cvt_pk_bf16_f32 v60, v60, 0
  v_lshlrev_b32_e64 v65, 16, v60
  global_load_dwordx4 v[88:91], v49, s[10:11]
  v_add_u32 v49, 245760, v49
  global_load_dwordx4 v[92:95], v49, s[10:11]
  v_add_u32 v49, 245760, v49
  global_load_dwordx4 v[96:99], v49, s[10:11]
  v_add_u32 v49, 245760, v49
  global_load_dwordx4 v[100:103], v49, s[10:11]
  v_add_u32 v49, 245760, v49
  global_load_dwordx4 v[104:107], v49, s[10:11]
  s_waitcnt vmcnt(10)
  v_dot2_f32_bf16 v238, v68, v56, 0
  v_dot2_f32_bf16 v239, v68, v61, 0
  v_dot2_f32_bf16 v240, v69, v56, 0
  v_dot2_f32_bf16 v241, v69, v61, 0
  v_dot2_f32_bf16 v242, v70, v56, 0
  v_dot2_f32_bf16 v243, v70, v61, 0
  v_dot2_f32_bf16 v244, v71, v56, 0
  v_dot2_f32_bf16 v245, v71, v61, 0
  s_waitcnt vmcnt(9)
  s_nop 0
  v_dot2_f32_bf16 v238, v72, v57, v238
  v_dot2_f32_bf16 v239, v72, v62, v239
  v_dot2_f32_bf16 v240, v73, v57, v240
  v_dot2_f32_bf16 v241, v73, v62, v241
  v_dot2_f32_bf16 v242, v74, v57, v242
  v_dot2_f32_bf16 v243, v74, v62, v243
  v_dot2_f32_bf16 v244, v75, v57, v244
  v_dot2_f32_bf16 v245, v75, v62, v245
  s_waitcnt vmcnt(8)
  s_nop 0
  v_dot2_f32_bf16 v238, v76, v58, v238
  v_dot2_f32_bf16 v239, v76, v63, v239
  v_dot2_f32_bf16 v240, v77, v58, v240
  v_dot2_f32_bf16 v241, v77, v63, v241
  v_dot2_f32_bf16 v242, v78, v58, v242
  v_dot2_f32_bf16 v243, v78, v63, v243
  v_dot2_f32_bf16 v244, v79, v58, v244
  v_dot2_f32_bf16 v245, v79, v63, v245
  s_waitcnt vmcnt(7)
  s_nop 0
  v_dot2_f32_bf16 v238, v80, v59, v238
  v_dot2_f32_bf16 v239, v80, v64, v239
  v_dot2_f32_bf16 v240, v81, v59, v240
  v_dot2_f32_bf16 v241, v81, v64, v241
  v_dot2_f32_bf16 v242, v82, v59, v242
  v_dot2_f32_bf16 v243, v82, v64, v243
  v_dot2_f32_bf16 v244, v83, v59, v244
  v_dot2_f32_bf16 v245, v83, v64, v245
  s_waitcnt vmcnt(6)
  s_nop 0
  v_dot2_f32_bf16 v238, v84, v60, v238
  v_dot2_f32_bf16 v239, v84, v65, v239
  v_dot2_f32_bf16 v240, v85, v60, v240
  v_dot2_f32_bf16 v241, v85, v65, v241
  v_dot2_f32_bf16 v242, v86, v60, v242
  v_dot2_f32_bf16 v243, v86, v65, v243
  v_dot2_f32_bf16 v244, v87, v60, v244
  v_dot2_f32_bf16 v245, v87, v65, v245
  v_permlane32_swap_b32 v238, v242
  v_permlane32_swap_b32 v239, v243
  v_permlane32_swap_b32 v240, v244
  v_permlane32_swap_b32 v241, v245
  v_add_f32 v238, v238, v242
  v_add_f32 v239, v239, v243
  v_add_f32 v240, v240, v244
  v_add_f32 v241, v241, v245
  s_nop 0
  v_permlane16_swap_b32 v238, v240
  v_permlane16_swap_b32 v239, v241
  v_add_f32 v238, v238, v240
  v_add_f32 v239, v239, v241
  s_nop 0
  v_add_f32_dpp v238, v238, v238 row_ror:8 row_mask:0xf bank_mask:0xf
  v_add_f32_dpp v239, v239, v239 row_ror:8 row_mask:0xf bank_mask:0xf
  ds_write_b64 v53, v[238:239] offset:43008
  v_add_u32 v242, s50, v55
  v_lshlrev_b32 v243, 1, v242
  v_add_u32 v243, 655360, v243
  s_waitcnt lgkmcnt(0)
  s_barrier
  ds_read_b32 v238, v54 offset:43008
  s_waitcnt vmcnt(5)
  v_readfirstlane_b32 s65, v248
  s_nop 0
  s_mul_i32 s65, s65, 0x9e3779b5
  s_add_u32 s65, s65, 0x7f4a7c15
  v_mov_b32 v248, s65
  s_waitcnt lgkmcnt(0)
  v_mov_b32 v239, v238
  s_nop 1
  v_permlane32_swap_b32 v238, v239
  v_add_f32 v238, v238, v239
  v_mov_b32 v239, v238
  s_nop 1
  v_permlane16_swap_b32 v238, v239
  v_add_f32 v238, v238, v239
  v_mov_b32 v239, s65
  s_mov_b64 exec, 0xffff
  global_store_dwordx2 v243, v[238:239], s[22:23] sc1
  global_store_dword v242, v238, s[22:23] sc1
  s_mov_b64 exec, -1
  s_add_u32 m0, s18, 0
  s_nop 0
  global_load_lds_dwordx4 v52, s[30:31]
  v_add_u32 v52, 49152, v52
  s_add_u32 m0, s18, 2048
  s_nop 0
  global_load_lds_dwordx4 v52, s[30:31]
  v_add_u32 v52, 49152, v52
  s_add_u32 m0, s18, 4096
  s_nop 0
  global_load_lds_dwordx4 v52, s[30:31]
  v_add_u32 v52, 49152, v52
  s_add_u32 m0, s18, 6144
  s_nop 0
  global_load_lds_dwordx4 v52, s[30:31]
  v_add_u32 v52, 49152, v52
  s_add_u32 m0, s18, 8192
  s_nop 0
  global_load_lds_dwordx4 v52, s[30:31]
  v_add_u32 v52, 49152, v52
  s_add_u32 m0, s18, 10240
  s_nop 0
  global_load_lds_dwordx4 v52, s[30:31]
  v_add_u32 v52, 49152, v52
  s_add_u32 m0, s18, 12288
  s_nop 0
  global_load_lds_dwordx4 v52, s[30:31]
  v_add_u32 v52, 49152, v52
  s_waitcnt vmcnt(13)
  v_dot2_f32_bf16 v238, v88, v56, 0
  v_dot2_f32_bf16 v239, v88, v61, 0
  v_dot2_f32_bf16 v240, v89, v56, 0
  v_dot2_f32_bf16 v241, v89, v61, 0
  v_dot2_f32_bf16 v242, v90, v56, 0
  v_dot2_f32_bf16 v243, v90, v61, 0
  v_dot2_f32_bf16 v244, v91, v56, 0
  v_dot2_f32_bf16 v245, v91, v61, 0
  s_waitcnt vmcnt(12)
  s_nop 0
  v_dot2_f32_bf16 v238, v92, v57, v238
  v_dot2_f32_bf16 v239, v92, v62, v239
  v_dot2_f32_bf16 v240, v93, v57, v240
  v_dot2_f32_bf16 v241, v93, v62, v241
  v_dot2_f32_bf16 v242, v94, v57, v242
  v_dot2_f32_bf16 v243, v94, v62, v243
  v_dot2_f32_bf16 v244, v95, v57, v244
  v_dot2_f32_bf16 v245, v95, v62, v245
  s_waitcnt vmcnt(11)
  s_nop 0
  v_dot2_f32_bf16 v238, v96, v58, v238
  v_dot2_f32_bf16 v239, v96, v63, v239
  v_dot2_f32_bf16 v240, v97, v58, v240
  v_dot2_f32_bf16 v241, v97, v63, v241
  v_dot2_f32_bf16 v242, v98, v58, v242
  v_dot2_f32_bf16 v243, v98, v63, v243
  v_dot2_f32_bf16 v244, v99, v58, v244
  v_dot2_f32_bf16 v245, v99, v63, v245
  s_waitcnt vmcnt(10)
  s_nop 0
  v_dot2_f32_bf16 v238, v100, v59, v238
  v_dot2_f32_bf16 v239, v100, v64, v239
  v_dot2_f32_bf16 v240, v101, v59, v240
  v_dot2_f32_bf16 v241, v101, v64, v241
  v_dot2_f32_bf16 v242, v102, v59, v242
  v_dot2_f32_bf16 v243, v102, v64, v243
  v_dot2_f32_bf16 v244, v103, v59, v244
  v_dot2_f32_bf16 v245, v103, v64, v245
  s_waitcnt vmcnt(9)
  s_nop 0
  v_dot2_f32_bf16 v238, v104, v60, v238
  v_dot2_f32_bf16 v239, v104, v65, v239
  v_dot2_f32_bf16 v240, v105, v60, v240
  v_dot2_f32_bf16 v241, v105, v65, v241
  v_dot2_f32_bf16 v242, v106, v60, v242
  v_dot2_f32_bf16 v243, v106, v65, v243
  v_dot2_f32_bf16 v244, v107, v60, v244
  v_dot2_f32_bf16 v245, v107, v65, v245
  v_permlane32_swap_b32 v238, v242
  v_permlane32_swap_b32 v239, v243
  v_permlane32_swap_b32 v240, v244
  v_permlane32_swap_b32 v241, v245
  v_add_f32 v238, v238, v242
  v_add_f32 v239, v239, v243
  v_add_f32 v240, v240, v244
  v_add_f32 v241, v241, v245
  s_nop 0
  v_permlane16_swap_b32 v238, v240
  v_permlane16_swap_b32 v239, v241
  v_add_f32 v238, v238, v240
  v_add_f32 v239, v239, v241
  s_nop 0
  v_add_f32_dpp v238, v238, v238 row_ror:8 row_mask:0xf bank_mask:0xf
  v_add_f32_dpp v239, v239, v239 row_ror:8 row_mask:0xf bank_mask:0xf
  ds_write_b64 v53, v[238:239] offset:44032
  v_add_u32 v242, s52, v55
  v_lshlrev_b32 v243, 1, v242
  v_add_u32 v243, 655360, v243
  s_waitcnt lgkmcnt(0)
  s_barrier
  ds_read_b32 v238, v54 offset:44032
  s_waitcnt lgkmcnt(0)
  v_mov_b32 v239, v238
  s_nop 1
  v_permlane32_swap_b32 v238, v239
  v_add_f32 v238, v238, v239
  v_mov_b32 v239, v238
  s_nop 1
  v_permlane16_swap_b32 v238, v239
  v_add_f32 v238, v238, v239
  v_mov_b32 v239, s65
  s_mov_b64 exec, 0xffff
  global_store_dwordx2 v243, v[238:239], s[22:23] sc1
  global_store_dword v242, v238, s[22:23] sc1
  s_mov_b64 exec, -1
  global_load_dwordx2 v[208:209], v44, s[22:23] offset:2560 sc1
  global_load_dwordx2 v[210:211], v45, s[22:23] offset:2560 sc1
  global_load_dwordx2 v[212:213], v46, s[22:23] offset:2560 sc1
  global_load_dwordx2 v[214:215], v47, s[22:23] offset:2560 sc1
  s_add_u32 m0, s18, 14336
  s_nop 0
  global_load_lds_dwordx4 v52, s[30:31]
  v_add_u32 v52, 49152, v52
  s_add_u32 m0, s18, 16384
  s_nop 0
  global_load_lds_dwordx4 v52, s[30:31]
  v_add_u32 v52, 49152, v52
  s_add_u32 m0, s18, 18432
  s_nop 0
  global_load_lds_dwordx4 v52, s[30:31]
  s_waitcnt vmcnt(6)
  v_xor_b32 v209, s65, v209
  s_waitcnt vmcnt(5)
  v_xor_b32 v211, s65, v211
  s_waitcnt vmcnt(4)
  v_xor_b32 v213, s65, v213
  s_waitcnt vmcnt(3)
  v_xor_b32 v215, s65, v215
  v_or3_b32 v209, v209, v211, v213
  v_or_b32 v209, v209, v215
  v_cmp_ne_u32 vcc, 0, v209
  s_cbranch_vccnz u_spinm
u_okm:
  v_mov_b32 v24, 0x3f803f80
  v_mov_b32 v25, 0x3f803f80
  v_mov_b32 v26, 0x3f803f80
  v_mov_b32 v27, 0x3f803f80
  v_add_f32 v208, v208, v210
  v_add_f32 v212, v212, v214
  v_add_f32 v208, v208, v212
  v_cvt_pk_bf16_f32 v208, v208, v208
  v_and_b32 v12, 0xffff0000, v208
  v_add_f32_e64 v12, 1.0, v12
  v_cvt_pk_bf16_f32 v12, v12, v12
  ds_write_b16 v5, v12 offset:40960
  s_waitcnt vmcnt(2)
  s_waitcnt lgkmcnt(0)
  s_barrier
  ds_read_b128 v[108:111], v18 offset:40960
  ds_read_b64_tr_b16 v[66:67], v16 offset:0
  ds_read_b64_tr_b16 v[68:69], v16 offset:512
  ds_read_b64_tr_b16 v[70:71], v17 offset:0
  ds_read_b64_tr_b16 v[72:73], v17 offset:512
  ds_read_b128 v[112:115], v18 offset:41024
  ds_read_b64_tr_b16 v[74:75], v16 offset:4096
  ds_read_b64_tr_b16 v[76:77], v16 offset:4608
  ds_read_b64_tr_b16 v[78:79], v17 offset:4096
  ds_read_b64_tr_b16 v[80:81], v17 offset:4608
  ds_read_b128 v[116:119], v18 offset:41088
  ds_read_b64_tr_b16 v[82:83], v16 offset:8192
  ds_read_b64_tr_b16 v[84:85], v16 offset:8704
  ds_read_b64_tr_b16 v[86:87], v17 offset:8192
  ds_read_b64_tr_b16 v[88:89], v17 offset:8704
  ds_read_b128 v[120:123], v18 offset:41152
  ds_read_b64_tr_b16 v[90:91], v16 offset:12288
  ds_read_b64_tr_b16 v[92:93], v16 offset:12800
  ds_read_b64_tr_b16 v[94:95], v17 offset:12288
  ds_read_b64_tr_b16 v[96:97], v17 offset:12800
  s_waitcnt lgkmcnt(15)
  v_and_b32 v8, 0xffff, v108
  v_and_b32 v9, 0xffff0000, v108
  v_and_b32 v10, 0xffff, v109
  v_and_b32 v11, 0xffff0000, v109
  v_and_b32 v12, 0xffff, v110
  v_and_b32 v13, 0xffff0000, v110
  v_and_b32 v14, 0xffff, v111
  v_and_b32 v15, 0xffff0000, v111
  v_dot2_f32_bf16 v28, v66, v8, 0
  v_dot2_f32_bf16 v29, v66, v9, 0
  v_dot2_f32_bf16 v30, v67, v10, 0
  v_dot2_f32_bf16 v31, v67, v11, 0
  v_dot2_f32_bf16 v32, v68, v12, 0
  v_dot2_f32_bf16 v33, v68, v13, 0
  v_dot2_f32_bf16 v34, v69, v14, 0
  v_dot2_f32_bf16 v35, v69, v15, 0
  v_dot2_f32_bf16 v36, v70, v8, 0
  v_dot2_f32_bf16 v37, v70, v9, 0
  v_dot2_f32_bf16 v38, v71, v10, 0
  v_dot2_f32_bf16 v39, v71, v11, 0
  v_dot2_f32_bf16 v40, v72, v12, 0
  v_dot2_f32_bf16 v41, v72, v13, 0
  v_dot2_f32_bf16 v42, v73, v14, 0
  v_dot2_f32_bf16 v43, v73, v15, 0
  v_cvt_pk_bf16_f32 v148, v28, v29
  v_cvt_pk_bf16_f32 v149, v30, v31
  v_cvt_pk_bf16_f32 v150, v32, v33
  v_cvt_pk_bf16_f32 v151, v34, v35
  global_store_dwordx4 v19, v[148:151], s[22:23] sc1
  v_add_u32 v19, 3072, v19
  v_cvt_pk_bf16_f32 v152, v36, v37
  v_cvt_pk_bf16_f32 v153, v38, v39
  v_cvt_pk_bf16_f32 v154, v40, v41
  v_cvt_pk_bf16_f32 v155, v42, v43
  global_store_dwordx4 v20, v[152:155], s[22:23] sc1
  v_add_u32 v20, 3072, v20
  s_waitcnt lgkmcnt(14)
  s_nop 0
  v_and_b32 v8, 0xffff, v112
  v_and_b32 v9, 0xffff0000, v112
  v_and_b32 v10, 0xffff, v113
  v_and_b32 v11, 0xffff0000, v113
  v_and_b32 v12, 0xffff, v114
  v_and_b32 v13, 0xffff0000, v114
  v_and_b32 v14, 0xffff, v115
  v_and_b32 v15, 0xffff0000, v115
  s_waitcnt lgkmcnt(13)
  v_dot2_f32_bf16 v28, v74, v8, 0
  v_dot2_f32_bf16 v29, v74, v9, 0
  v_dot2_f32_bf16 v30, v75, v10, 0
  v_dot2_f32_bf16 v31, v75, v11, 0
  s_waitcnt lgkmcnt(12)
  v_dot2_f32_bf16 v32, v76, v12, 0
  v_dot2_f32_bf16 v33, v76, v13, 0
  v_dot2_f32_bf16 v34, v77, v14, 0
  v_dot2_f32_bf16 v35, v77, v15, 0
  s_waitcnt lgkmcnt(11)
  v_dot2_f32_bf16 v36, v78, v8, 0
  v_dot2_f32_bf16 v37, v78, v9, 0
  v_dot2_f32_bf16 v38, v79, v10, 0
  v_dot2_f32_bf16 v39, v79, v11, 0
  s_waitcnt lgkmcnt(10)
  v_dot2_f32_bf16 v40, v80, v12, 0
  v_dot2_f32_bf16 v41, v80, v13, 0
  v_dot2_f32_bf16 v42, v81, v14, 0
  v_dot2_f32_bf16 v43, v81, v15, 0
  v_cvt_pk_bf16_f32 v156, v28, v29
  v_cvt_pk_bf16_f32 v157, v30, v31
  v_cvt_pk_bf16_f32 v158, v32, v33
  v_cvt_pk_bf16_f32 v159, v34, v35
  global_store_dwordx4 v19, v[156:159], s[22:23] sc1
  v_add_u32 v19, 3072, v19
  v_cvt_pk_bf16_f32 v160, v36, v37
  v_cvt_pk_bf16_f32 v161, v38, v39
  v_cvt_pk_bf16_f32 v162, v40, v41
  v_cvt_pk_bf16_f32 v163, v42, v43
  global_store_dwordx4 v20, v[160:163], s[22:23] sc1
  v_add_u32 v20, 3072, v20
  s_waitcnt lgkmcnt(3)
  s_nop 0
  v_and_b32 v8, 0xffff, v116
  v_and_b32 v9, 0xffff0000, v116
  v_and_b32 v10, 0xffff, v117
  v_and_b32 v11, 0xffff0000, v117
  v_and_b32 v12, 0xffff, v118
  v_and_b32 v13, 0xffff0000, v118
  v_and_b32 v14, 0xffff, v119
  v_and_b32 v15, 0xffff0000, v119
  v_dot2_f32_bf16 v28, v82, v8, 0
  v_dot2_f32_bf16 v29, v82, v9, 0
  v_dot2_f32_bf16 v30, v83, v10, 0
  v_dot2_f32_bf16 v31, v83, v11, 0
  v_dot2_f32_bf16 v32, v84, v12, 0
  v_dot2_f32_bf16 v33, v84, v13, 0
  v_dot2_f32_bf16 v34, v85, v14, 0
  v_dot2_f32_bf16 v35, v85, v15, 0
  v_dot2_f32_bf16 v36, v86, v8, 0
  v_dot2_f32_bf16 v37, v86, v9, 0
  v_dot2_f32_bf16 v38, v87, v10, 0
  v_dot2_f32_bf16 v39, v87, v11, 0
  v_dot2_f32_bf16 v40, v88, v12, 0
  v_dot2_f32_bf16 v41, v88, v13, 0
  v_dot2_f32_bf16 v42, v89, v14, 0
  v_dot2_f32_bf16 v43, v89, v15, 0
  v_cvt_pk_bf16_f32 v164, v28, v29
  v_cvt_pk_bf16_f32 v165, v30, v31
  v_cvt_pk_bf16_f32 v166, v32, v33
  v_cvt_pk_bf16_f32 v167, v34, v35
  global_store_dwordx4 v19, v[164:167], s[22:23] sc1
  v_add_u32 v19, 3072, v19
  v_cvt_pk_bf16_f32 v168, v36, v37
  v_cvt_pk_bf16_f32 v169, v38, v39
  v_cvt_pk_bf16_f32 v170, v40, v41
  v_cvt_pk_bf16_f32 v171, v42, v43
  global_store_dwordx4 v20, v[168:171], s[22:23] sc1
  v_add_u32 v20, 3072, v20
  v_and_b32 v8, 0xffff, v120
  v_and_b32 v9, 0xffff0000, v120
  v_and_b32 v10, 0xffff, v121
  v_and_b32 v11, 0xffff0000, v121
  v_and_b32 v12, 0xffff, v122
  v_and_b32 v13, 0xffff0000, v122
  v_and_b32 v14, 0xffff, v123
  v_and_b32 v15, 0xffff0000, v123
  v_dot2_f32_bf16 v28, v90, v8, 0
  v_dot2_f32_bf16 v29, v90, v9, 0
  v_dot2_f32_bf16 v30, v91, v10, 0
  v_dot2_f32_bf16 v31, v91, v11, 0
  s_waitcnt lgkmcnt(0)
  s_nop 0
  v_dot2_f32_bf16 v32, v92, v12, 0
  v_dot2_f32_bf16 v33, v92, v13, 0
  v_dot2_f32_bf16 v34, v93, v14, 0
  v_dot2_f32_bf16 v35, v93, v15, 0
  v_dot2_f32_bf16 v36, v94, v8, 0
  v_dot2_f32_bf16 v37, v94, v9, 0
  v_dot2_f32_bf16 v38, v95, v10, 0
  v_dot2_f32_bf16 v39, v95, v11, 0
  v_dot2_f32_bf16 v40, v96, v12, 0
  v_dot2_f32_bf16 v41, v96, v13, 0
  v_dot2_f32_bf16 v42, v97, v14, 0
  v_dot2_f32_bf16 v43, v97, v15, 0
  v_cvt_pk_bf16_f32 v172, v28, v29
  v_cvt_pk_bf16_f32 v173, v30, v31
  v_cvt_pk_bf16_f32 v174, v32, v33
  v_cvt_pk_bf16_f32 v175, v34, v35
  global_store_dwordx4 v19, v[172:175], s[22:23] sc1
warm1:
  s_cbranch_execz warm5
  s_nop 0
  v_add_u32 v19, 3072, v19
  v_cvt_pk_bf16_f32 v176, v36, v37
  v_cvt_pk_bf16_f32 v177, v38, v39
  v_cvt_pk_bf16_f32 v178, v40, v41
  v_cvt_pk_bf16_f32 v179, v42, v43
  global_store_dwordx4 v20, v[176:179], s[22:23] sc1
  v_add_u32 v20, 3072, v20
  s_waitcnt vmcnt(8)
  s_barrier
  ds_read_b128 v[124:127], v18 offset:41216
  ds_read_b64_tr_b16 v[98:99], v16 offset:16384
  ds_read_b64_tr_b16 v[100:101], v16 offset:16896
  ds_read_b64_tr_b16 v[102:103], v17 offset:16384
  ds_read_b64_tr_b16 v[104:105], v17 offset:16896
  s_waitcnt lgkmcnt(4)
  s_nop 0
  v_and_b32 v8, 0xffff, v124
  v_and_b32 v9, 0xffff0000, v124
  v_and_b32 v10, 0xffff, v125
  v_and_b32 v11, 0xffff0000, v125
  v_and_b32 v12, 0xffff, v126
  v_and_b32 v13, 0xffff0000, v126
  v_and_b32 v14, 0xffff, v127
  v_and_b32 v15, 0xffff0000, v127
  s_waitcnt lgkmcnt(3)
  v_dot2_f32_bf16 v28, v98, v8, 0
  v_dot2_f32_bf16 v29, v98, v9, 0
  v_dot2_f32_bf16 v30, v99, v10, 0
  v_dot2_f32_bf16 v31, v99, v11, 0
  s_waitcnt lgkmcnt(2)
  v_dot2_f32_bf16 v32, v100, v12, 0
  v_dot2_f32_bf16 v33, v100, v13, 0
  v_dot2_f32_bf16 v34, v101, v14, 0
  v_dot2_f32_bf16 v35, v101, v15, 0
  s_waitcnt lgkmcnt(1)
  v_dot2_f32_bf16 v36, v102, v8, 0
  v_dot2_f32_bf16 v37, v102, v9, 0
  v_dot2_f32_bf16 v38, v103, v10, 0
  v_dot2_f32_bf16 v39, v103, v11, 0
  s_waitcnt lgkmcnt(0)
  v_dot2_f32_bf16 v40, v104, v12, 0
  v_dot2_f32_bf16 v41, v104, v13, 0
  v_dot2_f32_bf16 v42, v105, v14, 0
  v_dot2_f32_bf16 v43, v105, v15, 0
  v_cvt_pk_bf16_f32 v180, v28, v29
  v_cvt_pk_bf16_f32 v181, v30, v31
  v_cvt_pk_bf16_f32 v182, v32, v33
  v_cvt_pk_bf16_f32 v183, v34, v35
  global_store_dwordx4 v19, v[180:183], s[22:23] sc1
  v_cvt_pk_bf16_f32 v184, v36, v37
  v_cvt_pk_bf16_f32 v185, v38, v39
  v_cvt_pk_bf16_f32 v186, v40, v41
  v_cvt_pk_bf16_f32 v187, v42, v43
  global_store_dwordx4 v20, v[184:187], s[22:23] sc1
  global_load_dwordx4 v[216:219], v236, s[10:11]
  v_add_u32 v236, 245760, v236
  global_load_dwordx4 v[220:223], v236, s[10:11]
  v_add_u32 v236, 245760, v236
  global_load_dwordx4 v[224:227], v236, s[10:11]
  v_add_u32 v236, 245760, v236
  global_load_dwordx4 v[228:231], v236, s[10:11]
  v_add_u32 v236, 245760, v236
  global_load_dwordx4 v[232:235], v236, s[10:11]
  s_lshl_b32 s7, s20, 11
  s_add_u32 m0, s7, 155648
  s_nop 0
  global_load_lds_dwordx4 v250, s[38:39]
  v_add_u32 v250, 19456, v250
  global_load_lds_dwordx4 v250, s[38:39] offset:1024
  v_mfma_f32_16x16x32_bf16 v[188:191], v[24:27], v[148:151], 0
  v_mfma_f32_16x16x32_bf16 v[196:199], v[24:27], v[152:155], 0
  v_mfma_f32_16x16x32_bf16 v[188:191], v[24:27], v[156:159], v[188:191]
  v_mfma_f32_16x16x32_bf16 v[196:199], v[24:27], v[160:163], v[196:199]
  v_mfma_f32_16x16x32_bf16 v[188:191], v[24:27], v[164:167], v[188:191]
  v_mfma_f32_16x16x32_bf16 v[196:199], v[24:27], v[168:171], v[196:199]
  v_mfma_f32_16x16x32_bf16 v[188:191], v[24:27], v[172:175], v[188:191]
  v_mfma_f32_16x16x32_bf16 v[196:199], v[24:27], v[176:179], v[196:199]
  v_mfma_f32_16x16x32_bf16 v[188:191], v[24:27], v[180:183], v[188:191]
  v_mfma_f32_16x16x32_bf16 v[196:199], v[24:27], v[184:187], v[196:199]
  s_and_b32 s4, s2, 7
  s_lshr_b32 s5, s2, 3
  s_and_b32 s60, s4, 3
  s_mul_i32 s60, s60, 4
  s_and_b32 s6, s5, 3
  s_add_u32 s60, s60, s6
  s_lshr_b32 s61, s4, 2
  s_mul_i32 s61, s61, 8
  s_lshr_b32 s6, s5, 2
  s_add_u32 s61, s61, s6
  s_lshl_b32 s62, s60, 2
  s_add_u32 s62, s62, s20
  s_mul_i32 s6, s62, 3
  v_bfe_u32 v10, v1, 2, 2
  v_min_u32 v10, 2, v10
  v_add_u32 v10, s6, v10
  v_lshrrev_b32 v10, 3, v10
  v_lshlrev_b32 v10, 9, v10
  v_and_b32 v11, 3, v1
  v_lshl_add_u32 v10, v11, 7, v10
  s_add_u32 s6, s100, 4096
  v_add_u32 v10, s6, v10
  s_mul_i32 s4, s62, 64512
  s_add_u32 s4, s4, 25169920
  v_lshl_add_u32 v3, v1, 4, s4
  s_waitcnt vmcnt(7)
  s_barrier
  s_cmp_lg_u32 s20, 0
  s_cbranch_scc1 f_nafw
  global_store_dwordx4 v23, v[248:251], s[22:23] sc1
f_nafw:
  s_waitcnt vmcnt(6)
  v_dot2_f32_bf16 v238, v216, v56, 0
  v_dot2_f32_bf16 v239, v216, v61, 0
  v_dot2_f32_bf16 v240, v217, v56, 0
  v_dot2_f32_bf16 v241, v217, v61, 0
  v_dot2_f32_bf16 v242, v218, v56, 0
  v_dot2_f32_bf16 v243, v218, v61, 0
  v_dot2_f32_bf16 v244, v219, v56, 0
  v_dot2_f32_bf16 v245, v219, v61, 0
  s_waitcnt vmcnt(5)
  s_nop 0
  v_dot2_f32_bf16 v238, v220, v57, v238
  v_dot2_f32_bf16 v239, v220, v62, v239
  v_dot2_f32_bf16 v240, v221, v57, v240
  v_dot2_f32_bf16 v241, v221, v62, v241
  v_dot2_f32_bf16 v242, v222, v57, v242
  v_dot2_f32_bf16 v243, v222, v62, v243
  v_dot2_f32_bf16 v244, v223, v57, v244
  v_dot2_f32_bf16 v245, v223, v62, v245
  s_waitcnt vmcnt(4)
  s_nop 0
  v_dot2_f32_bf16 v238, v224, v58, v238
  v_dot2_f32_bf16 v239, v224, v63, v239
  v_dot2_f32_bf16 v240, v225, v58, v240
  v_dot2_f32_bf16 v241, v225, v63, v241
  v_dot2_f32_bf16 v242, v226, v58, v242
  v_dot2_f32_bf16 v243, v226, v63, v243
  v_dot2_f32_bf16 v244, v227, v58, v244
  v_dot2_f32_bf16 v245, v227, v63, v245
  s_waitcnt vmcnt(3)
  s_nop 0
  v_dot2_f32_bf16 v238, v228, v59, v238
  v_dot2_f32_bf16 v239, v228, v64, v239
  v_dot2_f32_bf16 v240, v229, v59, v240
  v_dot2_f32_bf16 v241, v229, v64, v241
  v_dot2_f32_bf16 v242, v230, v59, v242
  v_dot2_f32_bf16 v243, v230, v64, v243
  v_dot2_f32_bf16 v244, v231, v59, v244
  v_dot2_f32_bf16 v245, v231, v64, v245
  s_waitcnt vmcnt(2)
  s_nop 0
  v_dot2_f32_bf16 v238, v232, v60, v238
  v_dot2_f32_bf16 v239, v232, v65, v239
  v_dot2_f32_bf16 v240, v233, v60, v240
  v_dot2_f32_bf16 v241, v233, v65, v241
  v_dot2_f32_bf16 v242, v234, v60, v242
  v_dot2_f32_bf16 v243, v234, v65, v243
  v_dot2_f32_bf16 v244, v235, v60, v244
  v_dot2_f32_bf16 v245, v235, v65, v245
  v_permlane32_swap_b32 v238, v242
  v_permlane32_swap_b32 v239, v243
  v_permlane32_swap_b32 v240, v244
  v_permlane32_swap_b32 v241, v245
  v_add_f32 v238, v238, v242
  v_add_f32 v239, v239, v243
  v_add_f32 v240, v240, v244
  v_add_f32 v241, v241, v245
  s_nop 0
  v_permlane16_swap_b32 v238, v240
  v_permlane16_swap_b32 v239, v241
  v_add_f32 v238, v238, v240
  v_add_f32 v239, v239, v241
  s_nop 0
  v_add_f32_dpp v238, v238, v238 row_ror:8 row_mask:0xf bank_mask:0xf
  v_add_f32_dpp v239, v239, v239 row_ror:8 row_mask:0xf bank_mask:0xf
  ds_write_b64 v53, v[238:239] offset:45056
  v_add_u32 v242, s54, v55
  v_lshlrev_b32 v243, 1, v242
  v_add_u32 v243, 655360, v243
  s_waitcnt lgkmcnt(0)
  s_barrier
  ds_read_b32 v238, v54 offset:45056
  s_waitcnt lgkmcnt(0)
  v_mov_b32 v239, v238
  s_nop 1
  v_permlane32_swap_b32 v238, v239
  v_add_f32 v238, v238, v239
  v_mov_b32 v239, v238
  s_nop 1
  v_permlane16_swap_b32 v238, v239
  v_add_f32 v238, v238, v239
  v_mov_b32 v239, s65
  s_mov_b64 exec, 0xffff
  global_store_dwordx2 v243, v[238:239], s[22:23] sc1
  global_store_dword v242, v238, s[22:23] sc1
  s_mov_b64 exec, -1
  v_bfe_u32 v28, v1, 2, 2
  v_lshrrev_b32 v29, 4, v1
  v_lshl_add_u32 v28, v29, 3, v28
  v_and_b32 v29, 3, v1
  v_lshlrev_b32 v29, 3, v29
  v_lshl_add_u32 v28, v28, 6, v29
  s_lshl_b32 s7, s20, 11
  s_add_u32 s7, s7, 155648
  v_add_u32 v28, s7, v28
  s_waitcnt vmcnt(2)
  ds_read_b64_tr_b16 v[148:149], v28 offset:0
  ds_read_b64_tr_b16 v[150:151], v28 offset:256
  ds_read_b64_tr_b16 v[152:153], v28 offset:32
  ds_read_b64_tr_b16 v[154:155], v28 offset:288
  v_lshl_add_u32 v28, v1, 4, s40
  v_lshl_add_u32 v29, v1, 4, s41
  s_mov_b64 exec, 0xfff
  global_load_dword v11, v10, s[22:23] sc1
  s_mov_b64 exec, -1
  s_waitcnt lgkmcnt(2)
  global_store_dwordx4 v28, v[148:151], s[22:23] sc1
  s_waitcnt lgkmcnt(0)
  global_store_dwordx4 v29, v[152:155], s[22:23] sc1
  s_waitcnt vmcnt(2)
  v_cmp_ne_u32 vcc, s65, v11
  s_nop 0
  s_and_b64 vcc, vcc, 0xfff
  s_cbranch_vccnz u_spinw
u_okw:
  v_add_u32 v112, 90112, v5
  v_add_u32 v113, 90112, v18
  v_mov_b32 v114, v21
  v_mov_b32 v115, v22
  s_lshl_b32 s4, s2, 9
  s_lshl_b32 s5, s20, 7
  s_add_u32 s4, s4, s5
  s_add_u32 s4, s4, 5046272
  v_mov_b32 v107, s4
  s_and_b32 s4, s2, 7
  s_lshl_b32 s4, s4, 8
  s_add_u32 s4, s4, 4980736
  v_lshl_add_u32 v108, v1, 2, s4
  global_load_dwordx4 a[0:3], v3, s[22:23] offset:-4096 sc1
  global_load_dwordx4 a[4:7], v3, s[22:23] offset:-3072 sc1
  global_load_dwordx4 a[8:11], v3, s[22:23] offset:-2048 sc1
  global_load_dwordx4 a[12:15], v3, s[22:23] offset:-1024 sc1
  global_load_dwordx4 a[16:19], v3, s[22:23] offset:0 sc1
  global_load_dwordx4 a[20:23], v3, s[22:23] offset:1024 sc1
  global_load_dwordx4 a[24:27], v3, s[22:23] offset:2048 sc1
  global_load_dwordx4 a[28:31], v3, s[22:23] offset:3072 sc1
  v_add_u32 v3, 8192, v3
  global_load_dwordx4 a[32:35], v3, s[22:23] offset:-4096 sc1
  global_load_dwordx4 a[36:39], v3, s[22:23] offset:-3072 sc1
  global_load_dwordx4 a[40:43], v3, s[22:23] offset:-2048 sc1
  global_load_dwordx4 a[44:47], v3, s[22:23] offset:-1024 sc1
  global_load_dwordx4 a[48:51], v3, s[22:23] offset:0 sc1
  global_load_dwordx4 a[52:55], v3, s[22:23] offset:1024 sc1
  global_load_dwordx4 a[56:59], v3, s[22:23] offset:2048 sc1
  global_load_dwordx4 a[60:63], v3, s[22:23] offset:3072 sc1
  v_add_u32 v3, 8192, v3
  global_load_dwordx4 a[64:67], v3, s[22:23] offset:-4096 sc1
  global_load_dwordx4 a[68:71], v3, s[22:23] offset:-3072 sc1
  global_load_dwordx4 a[72:75], v3, s[22:23] offset:-2048 sc1
  global_load_dwordx4 a[76:79], v3, s[22:23] offset:-1024 sc1
  global_load_dwordx4 a[80:83], v3, s[22:23] offset:0 sc1
  global_load_dwordx4 a[84:87], v3, s[22:23] offset:1024 sc1
  global_load_dwordx4 a[88:91], v3, s[22:23] offset:2048 sc1
  global_load_dwordx4 a[92:95], v3, s[22:23] offset:3072 sc1
  v_add_u32 v3, 8192, v3
  global_load_dwordx4 a[96:99], v3, s[22:23] offset:-4096 sc1
  global_load_dwordx4 a[100:103], v3, s[22:23] offset:-3072 sc1
  global_load_dwordx4 a[104:107], v3, s[22:23] offset:-2048 sc1
  global_load_dwordx2 v[208:209], v44, s[22:23] offset:-2560 sc1
  global_load_dwordx2 v[210:211], v45, s[22:23] offset:-2560 sc1
  global_load_dwordx2 v[212:213], v46, s[22:23] offset:-2560 sc1
  global_load_dwordx2 v[214:215], v47, s[22:23] offset:-2560 sc1
  s_mov_b64 exec, 0xfffff
  global_load_dword v109, v108, s[22:23] sc1
  s_mov_b64 exec, -1
  s_waitcnt vmcnt(0)
  v_cmp_ne_u32 vcc, s65, v109
  s_nop 0
  s_and_b64 vcc, vcc, 0xfffff
  s_cbranch_vccnz u_hint2
u_hint2_ok:
  s_waitcnt lgkmcnt(0)
  s_barrier
  s_branch f_join
body_conv:
  s_waitcnt lgkmcnt(0)
  s_cmp_ge_u32 s2, 128
  s_cbranch_scc1 u_w0
  s_waitcnt vmcnt(16)
  s_branch u_w1
u_w0:
  s_waitcnt vmcnt(11)
u_w1:
  s_and_b32 s33, s48, 1
  s_lshl_b32 s33, s33, 4
  s_lshr_b32 s27, s27, s33
  s_lshl_b32 s27, s27, 16
  s_lshr_b32 s28, s28, s33
  s_lshl_b32 s28, s28, 16
  v_mov_b32 v126, 1069066811
  v_mul_f32 v126, s27, v126
  v_exp_f32 v126, v126
  v_writelane_b32 v224, s28, 0
  v_cvt_pk_bf16_f32 v126, v126, v126
  v_and_b32 v126, 0xffff0000, v126
  s_mov_b32 s14, 0x05040100
  s_mov_b32 s15, 0x07060302
  v_lshlrev_b32 v128, 16, v112
  v_lshlrev_b32 v129, 16, v113
  v_pk_mul_f32 v[128:129], v[128:129], v[126:127] op_sel_hi:[1,0]
  v_pk_mul_f32 v[128:129], v[128:129], s[34:35]
  v_mul_f32 v140, 0x41000000, v128
  v_mul_f32 v141, 0x41000000, v129
  v_exp_f32 v140, v140
  v_fract_f32 v141, v141
  v_cos_f32 v150, v141
  v_sin_f32 v151, v141
  v_exp_f32 v142, v128
  v_fract_f32 v143, v129
  v_cos_f32 v134, v143
  v_sin_f32_e64 v135, v143
  v_pk_mul_f32 v[150:151], v[150:151], v[140:141] op_sel_hi:[1,0] neg_hi:[1,0]
  v_pk_mul_f32 v[134:135], v[134:135], v[142:143] op_sel_hi:[1,0]
  v_pk_mul_f32 v[138:139], v[150:151], v[150:151] op_sel:[0,0] op_sel_hi:[0,1]
  v_pk_fma_f32 v[152:153], v[150:151], v[150:151], v[138:139] op_sel:[1,1,0] op_sel_hi:[1,0,1] neg_lo:[1,0,0]
  v_pk_mul_f32 v[138:139], v[152:153], v[150:151] op_sel:[0,0] op_sel_hi:[0,1]
  v_pk_fma_f32 v[154:155], v[152:153], v[150:151], v[138:139] op_sel:[1,1,0] op_sel_hi:[1,0,1] neg_lo:[1,0,0]
  v_cvt_pk_bf16_f32 v145, v150, v151
  v_cvt_pk_bf16_f32 v146, v152, v153
  v_cvt_pk_bf16_f32 v147, v154, v155
  ds_write_addtid_b32 v127 offset:0
  ds_write_addtid_b32 v145 offset:272
  ds_write_addtid_b32 v146 offset:544
  ds_write_addtid_b32 v147 offset:816
  v_pk_mul_f32 v[138:139], v[154:155], v[150:151] op_sel:[0,0] op_sel_hi:[0,1]
  v_pk_fma_f32 v[156:157], v[154:155], v[150:151], v[138:139] op_sel:[1,1,0] op_sel_hi:[1,0,1] neg_lo:[1,0,0]
  v_pk_mul_f32 v[138:139], v[156:157], v[150:151] op_sel:[0,0] op_sel_hi:[0,1]
  v_pk_fma_f32 v[158:159], v[156:157], v[150:151], v[138:139] op_sel:[1,1,0] op_sel_hi:[1,0,1] neg_lo:[1,0,0]
  v_pk_mul_f32 v[138:139], v[158:159], v[150:151] op_sel:[0,0] op_sel_hi:[0,1]
  v_pk_fma_f32 v[160:161], v[158:159], v[150:151], v[138:139] op_sel:[1,1,0] op_sel_hi:[1,0,1] neg_lo:[1,0,0]
  v_pk_mul_f32 v[138:139], v[160:161], v[150:151] op_sel:[0,0] op_sel_hi:[0,1]
  v_pk_fma_f32 v[162:163], v[160:161], v[150:151], v[138:139] op_sel:[1,1,0] op_sel_hi:[1,0,1] neg_lo:[1,0,0]
  v_cvt_pk_bf16_f32 v144, v156, v157
  v_cvt_pk_bf16_f32 v145, v158, v159
  v_cvt_pk_bf16_f32 v146, v160, v161
  v_cvt_pk_bf16_f32 v147, v162, v163
  ds_write_addtid_b32 v144 offset:1088
  ds_write_addtid_b32 v145 offset:1360
  ds_write_addtid_b32 v146 offset:1632
  ds_write_addtid_b32 v147 offset:1904
  v_pk_mul_f32 v[138:139], v[162:163], v[150:151] op_sel:[0,0] op_sel_hi:[0,1]
  v_pk_fma_f32 v[164:165], v[162:163], v[150:151], v[138:139] op_sel:[1,1,0] op_sel_hi:[1,0,1] neg_lo:[1,0,0]
  v_pk_mul_f32 v[138:139], v[150:151], v[164:165] op_sel:[0,0] op_sel_hi:[0,1]
  v_pk_fma_f32 v[150:151], v[150:151], v[164:165], v[138:139] op_sel:[1,1,0] op_sel_hi:[1,0,1] neg_lo:[1,0,0]
  v_pk_mul_f32 v[138:139], v[152:153], v[164:165] op_sel:[0,0] op_sel_hi:[0,1]
  v_pk_fma_f32 v[152:153], v[152:153], v[164:165], v[138:139] op_sel:[1,1,0] op_sel_hi:[1,0,1] neg_lo:[1,0,0]
  v_pk_mul_f32 v[138:139], v[154:155], v[164:165] op_sel:[0,0] op_sel_hi:[0,1]
  v_pk_fma_f32 v[154:155], v[154:155], v[164:165], v[138:139] op_sel:[1,1,0] op_sel_hi:[1,0,1] neg_lo:[1,0,0]
  v_cvt_pk_bf16_f32 v144, v164, v165
  v_cvt_pk_bf16_f32 v145, v150, v151
  v_cvt_pk_bf16_f32 v146, v152, v153
  v_cvt_pk_bf16_f32 v147, v154, v155
  ds_write_addtid_b32 v144 offset:2176
  ds_write_addtid_b32 v145 offset:2448
  ds_write_addtid_b32 v146 offset:2720
  ds_write_addtid_b32 v147 offset:2992
  v_pk_mul_f32 v[138:139], v[156:157], v[164:165] op_sel:[0,0] op_sel_hi:[0,1]
  v_pk_fma_f32 v[156:157], v[156:157], v[164:165], v[138:139] op_sel:[1,1,0] op_sel_hi:[1,0,1] neg_lo:[1,0,0]
  v_pk_mul_f32 v[138:139], v[158:159], v[164:165] op_sel:[0,0] op_sel_hi:[0,1]
  v_pk_fma_f32 v[158:159], v[158:159], v[164:165], v[138:139] op_sel:[1,1,0] op_sel_hi:[1,0,1] neg_lo:[1,0,0]
  v_pk_mul_f32 v[138:139], v[160:161], v[164:165] op_sel:[0,0] op_sel_hi:[0,1]
  v_pk_fma_f32 v[160:161], v[160:161], v[164:165], v[138:139] op_sel:[1,1,0] op_sel_hi:[1,0,1] neg_lo:[1,0,0]
  v_pk_mul_f32 v[138:139], v[162:163], v[164:165] op_sel:[0,0] op_sel_hi:[0,1]
  v_pk_fma_f32 v[162:163], v[162:163], v[164:165], v[138:139] op_sel:[1,1,0] op_sel_hi:[1,0,1] neg_lo:[1,0,0]
  v_cvt_pk_bf16_f32 v144, v156, v157
  v_cvt_pk_bf16_f32 v145, v158, v159
  v_cvt_pk_bf16_f32 v146, v160, v161
  v_cvt_pk_bf16_f32 v147, v162, v163
  ds_write_addtid_b32 v144 offset:3264
  ds_write_addtid_b32 v145 offset:3536
  ds_write_addtid_b32 v146 offset:3808
  ds_write_addtid_b32 v147 offset:4080
  v_pk_mul_f32 v[138:139], v[164:165], v[164:165] op_sel:[0,0] op_sel_hi:[0,1]
  v_pk_fma_f32 v[148:149], v[164:165], v[164:165], v[138:139] op_sel:[1,1,0] op_sel_hi:[1,0,1] neg_lo:[1,0,0]
  v_pk_mul_f32 v[138:139], v[148:149], v[148:149] op_sel:[0,0] op_sel_hi:[0,1] neg_hi:[1,0]
  v_pk_fma_f32 v[136:137], v[148:149], v[148:149], v[138:139] op_sel:[1,1,0] op_sel_hi:[1,0,1] neg_lo:[1,0,0] neg_hi:[1,0,0]
  v_pk_mul_f32 v[138:139], v[150:151], v[164:165] op_sel:[0,0] op_sel_hi:[0,1]
  v_pk_fma_f32 v[150:151], v[150:151], v[164:165], v[138:139] op_sel:[1,1,0] op_sel_hi:[1,0,1] neg_lo:[1,0,0]
  v_pk_mul_f32 v[138:139], v[152:153], v[164:165] op_sel:[0,0] op_sel_hi:[0,1]
  v_pk_fma_f32 v[152:153], v[152:153], v[164:165], v[138:139] op_sel:[1,1,0] op_sel_hi:[1,0,1] neg_lo:[1,0,0]
  v_pk_mul_f32 v[138:139], v[154:155], v[164:165] op_sel:[0,0] op_sel_hi:[0,1]
  v_pk_fma_f32 v[154:155], v[154:155], v[164:165], v[138:139] op_sel:[1,1,0] op_sel_hi:[1,0,1] neg_lo:[1,0,0]
  v_cvt_pk_bf16_f32 v144, v148, v149
  v_cvt_pk_bf16_f32 v145, v150, v151
  v_cvt_pk_bf16_f32 v146, v152, v153
  v_cvt_pk_bf16_f32 v147, v154, v155
  ds_write_addtid_b32 v144 offset:4352
  ds_write_addtid_b32 v145 offset:4624
  ds_write_addtid_b32 v146 offset:4896
  ds_write_addtid_b32 v147 offset:5168
  v_pk_mul_f32 v[138:139], v[156:157], v[164:165] op_sel:[0,0] op_sel_hi:[0,1]
  v_pk_fma_f32 v[156:157], v[156:157], v[164:165], v[138:139] op_sel:[1,1,0] op_sel_hi:[1,0,1] neg_lo:[1,0,0]
  v_pk_mul_f32 v[138:139], v[158:159], v[164:165] op_sel:[0,0] op_sel_hi:[0,1]
  v_pk_fma_f32 v[158:159], v[158:159], v[164:165], v[138:139] op_sel:[1,1,0] op_sel_hi:[1,0,1] neg_lo:[1,0,0]
  v_pk_mul_f32 v[138:139], v[160:161], v[164:165] op_sel:[0,0] op_sel_hi:[0,1]
  v_pk_fma_f32 v[160:161], v[160:161], v[164:165], v[138:139] op_sel:[1,1,0] op_sel_hi:[1,0,1] neg_lo:[1,0,0]
  v_pk_mul_f32 v[138:139], v[162:163], v[164:165] op_sel:[0,0] op_sel_hi:[0,1]
  v_pk_fma_f32 v[162:163], v[162:163], v[164:165], v[138:139] op_sel:[1,1,0] op_sel_hi:[1,0,1] neg_lo:[1,0,0]
  v_cvt_pk_bf16_f32 v144, v156, v157
  v_cvt_pk_bf16_f32 v145, v158, v159
  v_cvt_pk_bf16_f32 v146, v160, v161
  v_cvt_pk_bf16_f32 v147, v162, v163
  ds_write_addtid_b32 v144 offset:5440
  ds_write_addtid_b32 v145 offset:5712
  ds_write_addtid_b32 v146 offset:5984
  ds_write_addtid_b32 v147 offset:6256
  v_pk_mul_f32 v[138:139], v[148:149], v[164:165] op_sel:[0,0] op_sel_hi:[0,1]
  v_pk_fma_f32 v[148:149], v[148:149], v[164:165], v[138:139] op_sel:[1,1,0] op_sel_hi:[1,0,1] neg_lo:[1,0,0]
  v_pk_mul_f32 v[138:139], v[150:151], v[164:165] op_sel:[0,0] op_sel_hi:[0,1]
  v_pk_fma_f32 v[150:151], v[150:151], v[164:165], v[138:139] op_sel:[1,1,0] op_sel_hi:[1,0,1] neg_lo:[1,0,0]
  v_pk_mul_f32 v[138:139], v[152:153], v[164:165] op_sel:[0,0] op_sel_hi:[0,1]
  v_pk_fma_f32 v[152:153], v[152:153], v[164:165], v[138:139] op_sel:[1,1,0] op_sel_hi:[1,0,1] neg_lo:[1,0,0]
  v_pk_mul_f32 v[138:139], v[154:155], v[164:165] op_sel:[0,0] op_sel_hi:[0,1]
  v_pk_fma_f32 v[154:155], v[154:155], v[164:165], v[138:139] op_sel:[1,1,0] op_sel_hi:[1,0,1] neg_lo:[1,0,0]
  v_cvt_pk_bf16_f32 v144, v148, v149
  v_cvt_pk_bf16_f32 v145, v150, v151
  v_cvt_pk_bf16_f32 v146, v152, v153
  v_cvt_pk_bf16_f32 v147, v154, v155
  ds_write_addtid_b32 v144 offset:6528
  ds_write_addtid_b32 v145 offset:6800
  ds_write_addtid_b32 v146 offset:7072
  ds_write_addtid_b32 v147 offset:7344
  v_pk_mul_f32 v[138:139], v[156:157], v[164:165] op_sel:[0,0] op_sel_hi:[0,1]
  v_pk_fma_f32 v[156:157], v[156:157], v[164:165], v[138:139] op_sel:[1,1,0] op_sel_hi:[1,0,1] neg_lo:[1,0,0]
  v_pk_mul_f32 v[138:139], v[158:159], v[164:165] op_sel:[0,0] op_sel_hi:[0,1]
  v_pk_fma_f32 v[158:159], v[158:159], v[164:165], v[138:139] op_sel:[1,1,0] op_sel_hi:[1,0,1] neg_lo:[1,0,0]
  v_pk_mul_f32 v[138:139], v[160:161], v[164:165] op_sel:[0,0] op_sel_hi:[0,1]
  v_pk_fma_f32 v[160:161], v[160:161], v[164:165], v[138:139] op_sel:[1,1,0] op_sel_hi:[1,0,1] neg_lo:[1,0,0]
  v_pk_mul_f32 v[138:139], v[162:163], v[164:165] op_sel:[0,0] op_sel_hi:[0,1]
  v_pk_fma_f32 v[162:163], v[162:163], v[164:165], v[138:139] op_sel:[1,1,0] op_sel_hi:[1,0,1] neg_lo:[1,0,0]
  v_cvt_pk_bf16_f32 v144, v156, v157
  v_cvt_pk_bf16_f32 v145, v158, v159
  v_cvt_pk_bf16_f32 v146, v160, v161
  v_cvt_pk_bf16_f32 v147, v162, v163
  ds_write_addtid_b32 v144 offset:7616
  ds_write_addtid_b32 v145 offset:7888
  ds_write_addtid_b32 v146 offset:8160
  ds_write_addtid_b32 v147 offset:8432
  s_cmp_ge_u32 s2, 128
  s_cbranch_scc1 u_w2
  s_waitcnt vmcnt(12)
  s_branch u_w3
u_w2:
  s_waitcnt vmcnt(7)
u_w3:
  v_lshlrev_b32 v130, 16, v114
  v_lshlrev_b32 v131, 16, v115
  v_lshlrev_b32 v132, 16, v116
  v_lshlrev_b32 v133, 16, v117
  v_pk_mul_f32 v[130:131], v[130:131], v[126:127] op_sel_hi:[1,0]
  v_pk_mul_f32 v[138:139], v[132:133], v[130:131] op_sel:[0,0] op_sel_hi:[0,1]
  v_pk_fma_f32 v[148:149], v[132:133], v[130:131], v[138:139] op_sel:[1,1,0] op_sel_hi:[1,0,1] neg_lo:[1,0,0]
  v_pk_mul_f32 v[138:139], v[148:149], v[134:135] op_sel:[0,0] op_sel_hi:[0,1]
  v_pk_fma_f32 v[150:151], v[148:149], v[134:135], v[138:139] op_sel:[1,1,0] op_sel_hi:[1,0,1] neg_lo:[1,0,0]
  v_pk_mul_f32 v[138:139], v[150:151], v[134:135] op_sel:[0,0] op_sel_hi:[0,1]
  v_pk_fma_f32 v[152:153], v[150:151], v[134:135], v[138:139] op_sel:[1,1,0] op_sel_hi:[1,0,1] neg_lo:[1,0,0]
  v_pk_mul_f32 v[138:139], v[152:153], v[134:135] op_sel:[0,0] op_sel_hi:[0,1]
  v_pk_fma_f32 v[154:155], v[152:153], v[134:135], v[138:139] op_sel:[1,1,0] op_sel_hi:[1,0,1] neg_lo:[1,0,0]
  v_cvt_pk_bf16_f32 v144, v148, v149
  v_cvt_pk_bf16_f32 v145, v150, v151
  v_cvt_pk_bf16_f32 v146, v152, v153
  v_cvt_pk_bf16_f32 v147, v154, v155
  ds_read_b128 a[0:3], v124 offset:0
  ds_read_b128 a[4:7], v124 offset:32
  ds_write_addtid_b32 v144 offset:8704
  ds_write_addtid_b32 v145 offset:8976
  ds_write_addtid_b32 v146 offset:9248
  ds_write_addtid_b32 v147 offset:9520
  v_pk_mul_f32 v[138:139], v[154:155], v[134:135] op_sel:[0,0] op_sel_hi:[0,1]
  v_pk_fma_f32 v[156:157], v[154:155], v[134:135], v[138:139] op_sel:[1,1,0] op_sel_hi:[1,0,1] neg_lo:[1,0,0]
  v_pk_mul_f32 v[138:139], v[156:157], v[134:135] op_sel:[0,0] op_sel_hi:[0,1]
  v_pk_fma_f32 v[158:159], v[156:157], v[134:135], v[138:139] op_sel:[1,1,0] op_sel_hi:[1,0,1] neg_lo:[1,0,0]
  v_pk_mul_f32 v[138:139], v[158:159], v[134:135] op_sel:[0,0] op_sel_hi:[0,1]
  v_pk_fma_f32 v[160:161], v[158:159], v[134:135], v[138:139] op_sel:[1,1,0] op_sel_hi:[1,0,1] neg_lo:[1,0,0]
  v_pk_mul_f32 v[138:139], v[160:161], v[134:135] op_sel:[0,0] op_sel_hi:[0,1]
  v_pk_fma_f32 v[162:163], v[160:161], v[134:135], v[138:139] op_sel:[1,1,0] op_sel_hi:[1,0,1] neg_lo:[1,0,0]
  v_cvt_pk_bf16_f32 v144, v156, v157
  v_cvt_pk_bf16_f32 v145, v158, v159
  v_cvt_pk_bf16_f32 v146, v160, v161
  v_cvt_pk_bf16_f32 v147, v162, v163
  ds_read_b128 a[8:11], v124 offset:64
  ds_read_b128 a[12:15], v124 offset:96
  ds_write_addtid_b32 v144 offset:9792
  ds_write_addtid_b32 v145 offset:10064
  ds_write_addtid_b32 v146 offset:10336
  ds_write_addtid_b32 v147 offset:10608
  s_cmp_ge_u32 s2, 128
  s_cbranch_scc1 u_norow
  s_waitcnt vmcnt(7)
  ds_write_b64 v28, v[8:9] offset:0
  ds_write_b64 v28, v[10:11] offset:11520
  ds_write_b64 v28, v[12:13] offset:2304
  ds_write_b64 v28, v[14:15] offset:13824
  ds_write_b64 v28, v[16:17] offset:4608
  ds_write_b64 v28, v[18:19] offset:16128
  ds_write_b64 v28, v[20:21] offset:6912
  ds_write_b64 v28, v[22:23] offset:18432
  ds_write_b64 v28, v[24:25] offset:9216
  ds_write_b64 v28, v[26:27] offset:20736
  v_dot2_f32_bf16 v32, v8, s45, 0
  v_dot2_f32_bf16 v34, v8, v8, 0
  v_dot2_f32_bf16 v33, v9, s45, 0
  v_dot2_f32_bf16 v35, v9, v9, 0
  v_dot2_f32_bf16 v32, v10, s45, v32
  v_dot2_f32_bf16 v34, v10, v10, v34
  v_dot2_f32_bf16 v33, v11, s45, v33
  v_dot2_f32_bf16 v35, v11, v11, v35
  v_dot2_f32_bf16 v32, v12, s45, v32
  v_dot2_f32_bf16 v34, v12, v12, v34
  v_dot2_f32_bf16 v33, v13, s45, v33
  v_dot2_f32_bf16 v35, v13, v13, v35
  s_waitcnt lgkmcnt(0)
  s_barrier
  ds_read_b128 v[84:87], v29 offset:0
  ds_read_b128 v[88:91], v29 offset:1152
  ds_read_b128 v[92:95], v29 offset:2304
  ds_read_b128 v[96:99], v29 offset:3456
  ds_read_b128 v[40:43], v29 offset:4608
  v_dot2_f32_bf16 v32, v14, s45, v32
  v_dot2_f32_bf16 v34, v14, v14, v34
  v_dot2_f32_bf16 v33, v15, s45, v33
  v_dot2_f32_bf16 v35, v15, v15, v35
  v_dot2_f32_bf16 v32, v16, s45, v32
  v_dot2_f32_bf16 v34, v16, v16, v34
  v_dot2_f32_bf16 v33, v17, s45, v33
  v_dot2_f32_bf16 v35, v17, v17, v35
  v_dot2_f32_bf16 v32, v18, s45, v32
  v_dot2_f32_bf16 v34, v18, v18, v34
  v_dot2_f32_bf16 v33, v19, s45, v33
  v_dot2_f32_bf16 v35, v19, v19, v35
  v_dot2_f32_bf16 v32, v20, s45, v32
  v_dot2_f32_bf16 v34, v20, v20, v34
  v_dot2_f32_bf16 v33, v21, s45, v33
  v_dot2_f32_bf16 v35, v21, v21, v35
  s_waitcnt lgkmcnt(4)
  s_nop 0
  global_store_dwordx4 v30, v[84:87], s[22:23] sc1
  v_dot2_f32_bf16 v32, v22, s45, v32
  v_dot2_f32_bf16 v34, v22, v22, v34
  v_dot2_f32_bf16 v33, v23, s45, v33
  v_add_u32 v30, 266240, v30
  v_dot2_f32_bf16 v35, v23, v23, v35
  v_dot2_f32_bf16 v32, v24, s45, v32
  v_dot2_f32_bf16 v34, v24, v24, v34
  s_waitcnt lgkmcnt(3)
  s_nop 0
  global_store_dwordx4 v30, v[88:91], s[22:23] sc1
  v_dot2_f32_bf16 v33, v25, s45, v33
  v_dot2_f32_bf16 v35, v25, v25, v35
  v_add_u32 v30, 266240, v30
  v_dot2_f32_bf16 v32, v26, s45, v32
  v_dot2_f32_bf16 v34, v26, v26, v34
  v_dot2_f32_bf16 v33, v27, s45, v33
  s_waitcnt lgkmcnt(2)
  global_store_dwordx4 v30, v[92:95], s[22:23] sc1
  v_dot2_f32_bf16 v35, v27, v27, v35
  s_nop 1
  v_add_u32 v30, 266240, v30
  v_add_f32 v32, v32, v33
  v_add_f32 v33, v34, v35
  s_nop 0
  v_add_f32_dpp v32, v32, v32 row_ror:8 row_mask:0xf bank_mask:0xf
  s_waitcnt lgkmcnt(1)
  global_store_dwordx4 v30, v[96:99], s[22:23] sc1
  v_add_f32_dpp v33, v33, v33 row_ror:8 row_mask:0xf bank_mask:0xf
  v_add_f32_dpp v32, v32, v32 row_ror:4 row_mask:0xf bank_mask:0xf
  v_add_u32 v30, 266240, v30
  v_add_f32_dpp v33, v33, v33 row_ror:4 row_mask:0xf bank_mask:0xf
  v_add_f32_dpp v32, v32, v32 row_ror:2 row_mask:0xf bank_mask:0xf
  s_nop 0
  v_add_f32_dpp v33, v33, v33 row_ror:2 row_mask:0xf bank_mask:0xf
  s_waitcnt lgkmcnt(0)
  global_store_dwordx4 v30, v[40:43], s[22:23] sc1
  v_add_f32_dpp v32, v32, v32 row_ror:1 row_mask:0xf bank_mask:0xf
  v_add_f32_dpp v33, v33, v33 row_ror:1 row_mask:0xf bank_mask:0xf
  v_mul_f32 v32, 0x3acccccd, v32
  v_mul_f32 v33, 0x3acccccd, v33
  v_fma_f32 v33, -v32, v32, v33
  v_max_f32 v33, 0, v33
  v_add_f32 v33, 0x3727c5ac, v33
  v_rsq_f32 v34, v33
  s_mov_b64 exec, s[46:47]
  v_mul_f32 v35, -v32, v34
  global_store_dwordx2 v31, v[34:35], s[22:23] sc1
warm2:
  s_cbranch_execz warm6
  s_mov_b64 exec, -1
  global_store_dwordx2 v80, v[82:83], s[22:23] sc1
  s_waitcnt lgkmcnt(0)
u_norow:
  v_pk_mul_f32 v[138:139], v[162:163], v[134:135] op_sel:[0,0] op_sel_hi:[0,1]
  v_pk_fma_f32 v[164:165], v[162:163], v[134:135], v[138:139] op_sel:[1,1,0] op_sel_hi:[1,0,1] neg_lo:[1,0,0]
  v_pk_mul_f32 v[138:139], v[148:149], v[136:137] op_sel:[0,0] op_sel_hi:[0,1]
  v_pk_fma_f32 v[166:167], v[148:149], v[136:137], v[138:139] op_sel:[1,1,0] op_sel_hi:[1,0,1] neg_lo:[1,0,0]
  v_pk_mul_f32 v[138:139], v[152:153], v[136:137] op_sel:[0,0] op_sel_hi:[0,1]
  v_pk_fma_f32 v[168:169], v[152:153], v[136:137], v[138:139] op_sel:[1,1,0] op_sel_hi:[1,0,1] neg_lo:[1,0,0]
  v_pk_mul_f32 v[138:139], v[156:157], v[136:137] op_sel:[0,0] op_sel_hi:[0,1]
  v_pk_fma_f32 v[170:171], v[156:157], v[136:137], v[138:139] op_sel:[1,1,0] op_sel_hi:[1,0,1] neg_lo:[1,0,0]
  v_cvt_pk_bf16_f32 v144, v164, v165
  v_cvt_pk_bf16_f32 v145, v166, v167
  v_cvt_pk_bf16_f32 v146, v168, v169
  v_cvt_pk_bf16_f32 v147, v170, v171
  ds_read_b128 a[16:19], v124 offset:128
  ds_read_b128 a[20:23], v124 offset:160
  ds_write_addtid_b32 v144 offset:10880
  ds_write_addtid_b32 v145 offset:11152
  ds_write_addtid_b32 v146 offset:11424
  ds_write_addtid_b32 v147 offset:11696
  v_pk_mul_f32 v[138:139], v[160:161], v[136:137] op_sel:[0,0] op_sel_hi:[0,1]
  v_pk_fma_f32 v[172:173], v[160:161], v[136:137], v[138:139] op_sel:[1,1,0] op_sel_hi:[1,0,1] neg_lo:[1,0,0]
  v_pk_mul_f32 v[138:139], v[164:165], v[136:137] op_sel:[0,0] op_sel_hi:[0,1]
  v_pk_fma_f32 v[174:175], v[164:165], v[136:137], v[138:139] op_sel:[1,1,0] op_sel_hi:[1,0,1] neg_lo:[1,0,0]
  v_pk_mul_f32 v[138:139], v[170:171], v[136:137] op_sel:[0,0] op_sel_hi:[0,1]
  v_pk_fma_f32 v[176:177], v[170:171], v[136:137], v[138:139] op_sel:[1,1,0] op_sel_hi:[1,0,1] neg_lo:[1,0,0]
  v_pk_mul_f32 v[138:139], v[174:175], v[136:137] op_sel:[0,0] op_sel_hi:[0,1]
  v_pk_fma_f32 v[178:179], v[174:175], v[136:137], v[138:139] op_sel:[1,1,0] op_sel_hi:[1,0,1] neg_lo:[1,0,0]
  v_cvt_pk_bf16_f32 v144, v172, v173
  v_cvt_pk_bf16_f32 v145, v174, v175
  v_cvt_pk_bf16_f32 v146, v176, v177
  v_cvt_pk_bf16_f32 v147, v178, v179
  ds_read_b128 a[24:27], v124 offset:192
  ds_read_b128 a[28:31], v124 offset:224
  ds_write_addtid_b32 v144 offset:11968
  ds_write_addtid_b32 v145 offset:12240
  ds_write_addtid_b32 v146 offset:12512
  ds_write_addtid_b32 v147 offset:12784
  v_pk_mul_f32 v[138:139], v[176:177], v[136:137] op_sel:[0,0] op_sel_hi:[0,1]
  v_pk_fma_f32 v[180:181], v[176:177], v[136:137], v[138:139] op_sel:[1,1,0] op_sel_hi:[1,0,1] neg_lo:[1,0,0]
  v_pk_mul_f32 v[138:139], v[178:179], v[136:137] op_sel:[0,0] op_sel_hi:[0,1]
  v_pk_fma_f32 v[182:183], v[178:179], v[136:137], v[138:139] op_sel:[1,1,0] op_sel_hi:[1,0,1] neg_lo:[1,0,0]
  v_pk_mul_f32 v[138:139], v[182:183], v[136:137] op_sel:[0,0] op_sel_hi:[0,1]
  v_pk_fma_f32 v[184:185], v[182:183], v[136:137], v[138:139] op_sel:[1,1,0] op_sel_hi:[1,0,1] neg_lo:[1,0,0]
  v_pk_mul_f32 v[138:139], v[184:185], v[136:137] op_sel:[0,0] op_sel_hi:[0,1]
  v_pk_fma_f32 v[186:187], v[184:185], v[136:137], v[138:139] op_sel:[1,1,0] op_sel_hi:[1,0,1] neg_lo:[1,0,0]
  v_cvt_pk_bf16_f32 v144, v180, v181
  v_cvt_pk_bf16_f32 v145, v182, v183
  v_cvt_pk_bf16_f32 v146, v184, v185
  v_cvt_pk_bf16_f32 v147, v186, v187
  ds_write_addtid_b32 v144 offset:13056
  ds_write_addtid_b32 v145 offset:13328
  ds_write_addtid_b32 v146 offset:13600
  ds_write_addtid_b32 v147 offset:13872
  v_pk_mul_f32 v[138:139], v[186:187], v[136:137] op_sel:[0,0] op_sel_hi:[0,1]
  v_pk_fma_f32 v[188:189], v[186:187], v[136:137], v[138:139] op_sel:[1,1,0] op_sel_hi:[1,0,1] neg_lo:[1,0,0]
  v_pk_mul_f32 v[138:139], v[188:189], v[136:137] op_sel:[0,0] op_sel_hi:[0,1]
  v_pk_fma_f32 v[190:191], v[188:189], v[136:137], v[138:139] op_sel:[1,1,0] op_sel_hi:[1,0,1] neg_lo:[1,0,0]
  v_cvt_pk_bf16_f32 v144, v188, v189
  v_cvt_pk_bf16_f32 v145, v190, v191
  ds_write_addtid_b32 v144 offset:14144
  ds_write_addtid_b32 v145 offset:14416
  v_and_b32 v128, 0xffff0000, v112
  v_and_b32 v129, 0xffff0000, v113
  v_pk_mul_f32 v[128:129], v[128:129], v[126:127] op_sel_hi:[1,0]
  v_pk_mul_f32 v[128:129], v[128:129], s[34:35]
  v_mul_f32 v140, 0x41000000, v128
  v_mul_f32 v141, 0x41000000, v129
  v_exp_f32 v140, v140
  v_fract_f32 v141, v141
  v_cos_f32 v150, v141
  v_sin_f32 v151, v141
  v_exp_f32 v142, v128
  v_fract_f32 v143, v129
  v_cos_f32 v134, v143
  v_sin_f32 v135, v143
  v_pk_mul_f32 v[150:151], v[150:151], v[140:141] op_sel_hi:[1,0] neg_hi:[1,0]
  v_pk_mul_f32 v[134:135], v[134:135], v[142:143] op_sel_hi:[1,0]
  v_pk_mul_f32 v[138:139], v[150:151], v[150:151] op_sel:[0,0] op_sel_hi:[0,1]
  v_pk_fma_f32 v[152:153], v[150:151], v[150:151], v[138:139] op_sel:[1,1,0] op_sel_hi:[1,0,1] neg_lo:[1,0,0]
  v_pk_mul_f32 v[138:139], v[152:153], v[150:151] op_sel:[0,0] op_sel_hi:[0,1]
  v_pk_fma_f32 v[154:155], v[152:153], v[150:151], v[138:139] op_sel:[1,1,0] op_sel_hi:[1,0,1] neg_lo:[1,0,0]
  v_cvt_pk_bf16_f32 v145, v150, v151
  v_cvt_pk_bf16_f32 v146, v152, v153
  v_cvt_pk_bf16_f32 v147, v154, v155
  ds_read_b128 a[32:35], v125 offset:8704
  ds_read_b128 a[36:39], v125 offset:8736
  ds_write_addtid_b32 v127 offset:0
  ds_write_addtid_b32 v145 offset:272
  ds_write_addtid_b32 v146 offset:544
  ds_write_addtid_b32 v147 offset:816
  v_pk_mul_f32 v[138:139], v[154:155], v[150:151] op_sel:[0,0] op_sel_hi:[0,1]
  v_pk_fma_f32 v[156:157], v[154:155], v[150:151], v[138:139] op_sel:[1,1,0] op_sel_hi:[1,0,1] neg_lo:[1,0,0]
  v_pk_mul_f32 v[138:139], v[156:157], v[150:151] op_sel:[0,0] op_sel_hi:[0,1]
  v_pk_fma_f32 v[158:159], v[156:157], v[150:151], v[138:139] op_sel:[1,1,0] op_sel_hi:[1,0,1] neg_lo:[1,0,0]
  v_pk_mul_f32 v[138:139], v[158:159], v[150:151] op_sel:[0,0] op_sel_hi:[0,1]
  v_pk_fma_f32 v[160:161], v[158:159], v[150:151], v[138:139] op_sel:[1,1,0] op_sel_hi:[1,0,1] neg_lo:[1,0,0]
  v_pk_mul_f32 v[138:139], v[160:161], v[150:151] op_sel:[0,0] op_sel_hi:[0,1]
  v_pk_fma_f32 v[162:163], v[160:161], v[150:151], v[138:139] op_sel:[1,1,0] op_sel_hi:[1,0,1] neg_lo:[1,0,0]
  v_cvt_pk_bf16_f32 v144, v156, v157
  v_cvt_pk_bf16_f32 v145, v158, v159
  v_cvt_pk_bf16_f32 v146, v160, v161
  v_cvt_pk_bf16_f32 v147, v162, v163
  ds_read_b128 a[40:43], v125 offset:8768
  ds_read_b128 a[44:47], v125 offset:8800
  ds_write_addtid_b32 v144 offset:1088
  ds_write_addtid_b32 v145 offset:1360
  ds_write_addtid_b32 v146 offset:1632
  ds_write_addtid_b32 v147 offset:1904
  v_pk_mul_f32 v[138:139], v[162:163], v[150:151] op_sel:[0,0] op_sel_hi:[0,1]
  v_pk_fma_f32 v[164:165], v[162:163], v[150:151], v[138:139] op_sel:[1,1,0] op_sel_hi:[1,0,1] neg_lo:[1,0,0]
  v_pk_mul_f32 v[138:139], v[150:151], v[164:165] op_sel:[0,0] op_sel_hi:[0,1]
  v_pk_fma_f32 v[150:151], v[150:151], v[164:165], v[138:139] op_sel:[1,1,0] op_sel_hi:[1,0,1] neg_lo:[1,0,0]
  v_pk_mul_f32 v[138:139], v[152:153], v[164:165] op_sel:[0,0] op_sel_hi:[0,1]
  v_pk_fma_f32 v[152:153], v[152:153], v[164:165], v[138:139] op_sel:[1,1,0] op_sel_hi:[1,0,1] neg_lo:[1,0,0]
  v_pk_mul_f32 v[138:139], v[154:155], v[164:165] op_sel:[0,0] op_sel_hi:[0,1]
  v_pk_fma_f32 v[154:155], v[154:155], v[164:165], v[138:139] op_sel:[1,1,0] op_sel_hi:[1,0,1] neg_lo:[1,0,0]
  v_cvt_pk_bf16_f32 v144, v164, v165
  v_cvt_pk_bf16_f32 v145, v150, v151
  v_cvt_pk_bf16_f32 v146, v152, v153
  v_cvt_pk_bf16_f32 v147, v154, v155
  ds_read_b128 a[48:51], v125 offset:8832
  ds_read_b128 a[52:55], v125 offset:8864
  ds_write_addtid_b32 v144 offset:2176
  ds_write_addtid_b32 v145 offset:2448
  ds_write_addtid_b32 v146 offset:2720
  ds_write_addtid_b32 v147 offset:2992
  v_pk_mul_f32 v[138:139], v[156:157], v[164:165] op_sel:[0,0] op_sel_hi:[0,1]
  v_pk_fma_f32 v[156:157], v[156:157], v[164:165], v[138:139] op_sel:[1,1,0] op_sel_hi:[1,0,1] neg_lo:[1,0,0]
  v_pk_mul_f32 v[138:139], v[158:159], v[164:165] op_sel:[0,0] op_sel_hi:[0,1]
  v_pk_fma_f32 v[158:159], v[158:159], v[164:165], v[138:139] op_sel:[1,1,0] op_sel_hi:[1,0,1] neg_lo:[1,0,0]
  v_pk_mul_f32 v[138:139], v[160:161], v[164:165] op_sel:[0,0] op_sel_hi:[0,1]
  v_pk_fma_f32 v[160:161], v[160:161], v[164:165], v[138:139] op_sel:[1,1,0] op_sel_hi:[1,0,1] neg_lo:[1,0,0]
  v_pk_mul_f32 v[138:139], v[162:163], v[164:165] op_sel:[0,0] op_sel_hi:[0,1]
  v_pk_fma_f32 v[162:163], v[162:163], v[164:165], v[138:139] op_sel:[1,1,0] op_sel_hi:[1,0,1] neg_lo:[1,0,0]
  v_cvt_pk_bf16_f32 v144, v156, v157
  v_cvt_pk_bf16_f32 v145, v158, v159
  v_cvt_pk_bf16_f32 v146, v160, v161
  v_cvt_pk_bf16_f32 v147, v162, v163
  ds_read_b128 a[56:59], v125 offset:8896
  ds_read_b128 a[60:63], v125 offset:8928
  ds_write_addtid_b32 v144 offset:3264
  ds_write_addtid_b32 v145 offset:3536
  ds_write_addtid_b32 v146 offset:3808
  ds_write_addtid_b32 v147 offset:4080
  v_pk_mul_f32 v[138:139], v[164:165], v[164:165] op_sel:[0,0] op_sel_hi:[0,1]
  v_pk_fma_f32 v[148:149], v[164:165], v[164:165], v[138:139] op_sel:[1,1,0] op_sel_hi:[1,0,1] neg_lo:[1,0,0]
  v_pk_mul_f32 v[138:139], v[148:149], v[148:149] op_sel:[0,0] op_sel_hi:[0,1] neg_hi:[1,0]
  v_pk_fma_f32 v[136:137], v[148:149], v[148:149], v[138:139] op_sel:[1,1,0] op_sel_hi:[1,0,1] neg_lo:[1,0,0] neg_hi:[1,0,0]
  v_pk_mul_f32 v[138:139], v[150:151], v[164:165] op_sel:[0,0] op_sel_hi:[0,1]
  v_pk_fma_f32 v[150:151], v[150:151], v[164:165], v[138:139] op_sel:[1,1,0] op_sel_hi:[1,0,1] neg_lo:[1,0,0]
  v_pk_mul_f32 v[138:139], v[152:153], v[164:165] op_sel:[0,0] op_sel_hi:[0,1]
  v_pk_fma_f32 v[152:153], v[152:153], v[164:165], v[138:139] op_sel:[1,1,0] op_sel_hi:[1,0,1] neg_lo:[1,0,0]
  v_pk_mul_f32 v[138:139], v[154:155], v[164:165] op_sel:[0,0] op_sel_hi:[0,1]
  v_pk_fma_f32 v[154:155], v[154:155], v[164:165], v[138:139] op_sel:[1,1,0] op_sel_hi:[1,0,1] neg_lo:[1,0,0]
  v_cvt_pk_bf16_f32 v144, v148, v149
  v_cvt_pk_bf16_f32 v145, v150, v151
  v_cvt_pk_bf16_f32 v146, v152, v153
  v_cvt_pk_bf16_f32 v147, v154, v155
  ds_write_addtid_b32 v144 offset:4352
  ds_write_addtid_b32 v145 offset:4624
  ds_write_addtid_b32 v146 offset:4896
  ds_write_addtid_b32 v147 offset:5168
  v_pk_mul_f32 v[138:139], v[156:157], v[164:165] op_sel:[0,0] op_sel_hi:[0,1]
  v_pk_fma_f32 v[156:157], v[156:157], v[164:165], v[138:139] op_sel:[1,1,0] op_sel_hi:[1,0,1] neg_lo:[1,0,0]
  v_pk_mul_f32 v[138:139], v[158:159], v[164:165] op_sel:[0,0] op_sel_hi:[0,1]
  v_pk_fma_f32 v[158:159], v[158:159], v[164:165], v[138:139] op_sel:[1,1,0] op_sel_hi:[1,0,1] neg_lo:[1,0,0]
  v_pk_mul_f32 v[138:139], v[160:161], v[164:165] op_sel:[0,0] op_sel_hi:[0,1]
  v_pk_fma_f32 v[160:161], v[160:161], v[164:165], v[138:139] op_sel:[1,1,0] op_sel_hi:[1,0,1] neg_lo:[1,0,0]
  v_pk_mul_f32 v[138:139], v[162:163], v[164:165] op_sel:[0,0] op_sel_hi:[0,1]
  v_pk_fma_f32 v[162:163], v[162:163], v[164:165], v[138:139] op_sel:[1,1,0] op_sel_hi:[1,0,1] neg_lo:[1,0,0]
  s_waitcnt lgkmcnt(15)
  s_nop 0
  v_mfma_f32_32x32x16_bf16 v[204:219], a[32:35], a[0:3], 0
  v_cvt_pk_bf16_f32 v144, v156, v157
  v_cvt_pk_bf16_f32 v145, v158, v159
  v_cvt_pk_bf16_f32 v146, v160, v161
  v_cvt_pk_bf16_f32 v147, v162, v163
  ds_write_addtid_b32 v144 offset:5440
  ds_write_addtid_b32 v145 offset:5712
  ds_write_addtid_b32 v146 offset:5984
  ds_write_addtid_b32 v147 offset:6256
  v_pk_mul_f32 v[138:139], v[148:149], v[164:165] op_sel:[0,0] op_sel_hi:[0,1]
  v_pk_fma_f32 v[148:149], v[148:149], v[164:165], v[138:139] op_sel:[1,1,0] op_sel_hi:[1,0,1] neg_lo:[1,0,0]
  v_pk_mul_f32 v[138:139], v[150:151], v[164:165] op_sel:[0,0] op_sel_hi:[0,1]
  v_pk_fma_f32 v[150:151], v[150:151], v[164:165], v[138:139] op_sel:[1,1,0] op_sel_hi:[1,0,1] neg_lo:[1,0,0]
  v_pk_mul_f32 v[138:139], v[152:153], v[164:165] op_sel:[0,0] op_sel_hi:[0,1]
  v_pk_fma_f32 v[152:153], v[152:153], v[164:165], v[138:139] op_sel:[1,1,0] op_sel_hi:[1,0,1] neg_lo:[1,0,0]
  v_pk_mul_f32 v[138:139], v[154:155], v[164:165] op_sel:[0,0] op_sel_hi:[0,1]
  v_pk_fma_f32 v[154:155], v[154:155], v[164:165], v[138:139] op_sel:[1,1,0] op_sel_hi:[1,0,1] neg_lo:[1,0,0]
  v_mfma_f32_32x32x16_bf16 v[204:219], a[36:39], a[4:7], v[204:219]
  v_cvt_pk_bf16_f32 v144, v148, v149
  v_cvt_pk_bf16_f32 v145, v150, v151
  v_cvt_pk_bf16_f32 v146, v152, v153
  v_cvt_pk_bf16_f32 v147, v154, v155
  ds_write_addtid_b32 v144 offset:6528
  ds_write_addtid_b32 v145 offset:6800
  ds_write_addtid_b32 v146 offset:7072
  ds_write_addtid_b32 v147 offset:7344
  v_pk_mul_f32 v[138:139], v[156:157], v[164:165] op_sel:[0,0] op_sel_hi:[0,1]
  v_pk_fma_f32 v[156:157], v[156:157], v[164:165], v[138:139] op_sel:[1,1,0] op_sel_hi:[1,0,1] neg_lo:[1,0,0]
  v_pk_mul_f32 v[138:139], v[158:159], v[164:165] op_sel:[0,0] op_sel_hi:[0,1]
  v_pk_fma_f32 v[158:159], v[158:159], v[164:165], v[138:139] op_sel:[1,1,0] op_sel_hi:[1,0,1] neg_lo:[1,0,0]
  v_pk_mul_f32 v[138:139], v[160:161], v[164:165] op_sel:[0,0] op_sel_hi:[0,1]
  v_pk_fma_f32 v[160:161], v[160:161], v[164:165], v[138:139] op_sel:[1,1,0] op_sel_hi:[1,0,1] neg_lo:[1,0,0]
  v_pk_mul_f32 v[138:139], v[162:163], v[164:165] op_sel:[0,0] op_sel_hi:[0,1]
  v_pk_fma_f32 v[162:163], v[162:163], v[164:165], v[138:139] op_sel:[1,1,0] op_sel_hi:[1,0,1] neg_lo:[1,0,0]
  v_mfma_f32_32x32x16_bf16 v[204:219], a[40:43], a[8:11], v[204:219]
  v_cvt_pk_bf16_f32 v144, v156, v157
  v_cvt_pk_bf16_f32 v145, v158, v159
  v_cvt_pk_bf16_f32 v146, v160, v161
  v_cvt_pk_bf16_f32 v147, v162, v163
  ds_write_addtid_b32 v144 offset:7616
  ds_write_addtid_b32 v145 offset:7888
  ds_write_addtid_b32 v146 offset:8160
  ds_write_addtid_b32 v147 offset:8432
  s_waitcnt vmcnt(0)
  v_readfirstlane_b32 s65, v248
  s_nop 0
  s_mul_i32 s65, s65, 0x9e3779b5
  s_add_u32 s65, s65, 0x7f4a7c15
  v_mov_b32 v248, s65
  v_mov_b32 v44, s65
  s_cmp_ge_u32 s2, 128
  s_cbranch_scc1 f_naa
  s_barrier
  s_cmp_lg_u32 s20, 0
  s_cbranch_scc1 f_naa
  s_mov_b64 exec, 0xff
  global_store_dwordx4 v246, v[248:251], s[22:23] sc1
  s_mov_b64 exec, -1
  s_mov_b64 exec, 1
  global_store_dword v243, v248, s[22:23]
  s_mov_b64 exec, -1
f_naa:
  v_lshrrev_b32 v111, 2, v1
  v_mul_u32_u24 v111, 1216, v111
  v_lshl_add_u32 v111, v1, 4, v111
  v_add_u32 v111, s6, v111
  s_mul_i32 s5, s5, 5
  s_lshl_b32 s4, s4, 1
  s_mul_i32 s6, s4, 13108
  s_lshr_b32 s6, s6, 16
  s_mul_i32 s6, s6, 235
  s_add_u32 s6, s6, s4
  s_add_u32 s6, s6, s5
  s_lshl_b32 s6, s6, 10
  s_add_u32 s59, s6, 6291456
  s_add_u32 s4, s4, 1
  s_mul_i32 s6, s4, 13108
  s_lshr_b32 s6, s6, 16
  s_mul_i32 s6, s6, 235
  s_add_u32 s6, s6, s4
  s_add_u32 s6, s6, s5
  s_lshl_b32 s6, s6, 10
  s_add_u32 s51, s6, 6291456
  s_add_u32 s4, s4, 1
  s_and_b32 s4, s2, 7
  s_lshr_b32 s5, s2, 3
  s_and_b32 s60, s4, 3
  s_mul_i32 s60, s60, 4
  s_and_b32 s6, s5, 3
  s_add_u32 s60, s60, s6
  s_lshr_b32 s61, s4, 2
  s_mul_i32 s61, s61, 8
  s_lshr_b32 s6, s5, 2
  s_add_u32 s61, s61, s6
  s_lshl_b32 s62, s60, 2
  s_add_u32 s62, s62, s20
  s_mul_i32 s6, s62, 3
  v_bfe_u32 v110, v1, 2, 2
  v_min_u32 v110, 2, v110
  v_add_u32 v110, s6, v110
  v_lshrrev_b32 v110, 3, v110
  v_lshlrev_b32 v110, 9, v110
  v_and_b32 v76, 3, v1
  v_lshl_add_u32 v110, v76, 7, v110
  s_add_u32 s6, s100, 4096
  v_add_u32 v110, s6, v110
  s_lshr_b32 s4, s48, 1
  s_and_b32 s4, s4, 1
  s_lshr_b32 s5, s48, 2
  s_and_b32 s5, s5, 2
  s_or_b32 s4, s4, s5
  v_and_b32 v107, 3, v5
  v_xor_b32 v107, s4, v107
  v_lshrrev_b32 v76, 1, v6
  v_lshl_add_u32 v107, v76, 2, v107
  v_and_b32 v76, 1, v6
  v_lshrrev_b32 v77, 2, v5
  v_lshl_add_u32 v76, v76, 2, v77
  v_mul_u32_u24 v76, 81920, v76
  v_lshl_add_u32 v107, v107, 4, v76
  s_lshl_b32 s4, s48, 7
  s_add_u32 s4, s4, 12582912
  v_add_u32 v107, s4, v107
  s_mov_b32 s63, s21
  s_bfe_u32 s4, s63, 0x20002
  s_lshl_b32 s4, s4, 4
  s_lshr_b32 s5, s63, 4
  s_add_u32 s4, s4, s5
  s_lshl_b32 s4, s4, 2
  s_and_b32 s5, s63, 3
  s_add_u32 s4, s4, s5
  s_lshl_b32 s4, s4, 4
  s_add_u32 s4, s4, 4210688
  v_mul_u32_u24 v45, 73984, v1
  v_add_u32 v45, s4, v45
  s_and_b32 s4, s2, 7
  s_lshl_b32 s4, s4, 8
  s_add_u32 s4, s4, 4980736
  v_lshl_add_u32 v108, v1, 2, s4
  s_lshl_b32 s5, s3, 2
  s_add_u32 s4, s4, s5
  v_mov_b32 v46, s4
  v_mov_b32 v47, 0
  s_mul_i32 s4, s62, 64512
  s_add_u32 s4, s4, 25169920
  v_lshl_add_u32 v3, v1, 4, s4
  ds_write_b64 v106, v[228:229]
  v_and_b32 v130, 0xffff0000, v114
  v_and_b32 v131, 0xffff0000, v115
  v_and_b32 v132, 0xffff0000, v116
  v_and_b32 v133, 0xffff0000, v117
  v_pk_mul_f32 v[130:131], v[130:131], v[126:127] op_sel_hi:[1,0]
  v_pk_mul_f32 v[138:139], v[132:133], v[130:131] op_sel:[0,0] op_sel_hi:[0,1]
  v_pk_fma_f32 v[148:149], v[132:133], v[130:131], v[138:139] op_sel:[1,1,0] op_sel_hi:[1,0,1] neg_lo:[1,0,0]
  v_pk_mul_f32 v[138:139], v[148:149], v[134:135] op_sel:[0,0] op_sel_hi:[0,1]
  v_pk_fma_f32 v[150:151], v[148:149], v[134:135], v[138:139] op_sel:[1,1,0] op_sel_hi:[1,0,1] neg_lo:[1,0,0]
  v_pk_mul_f32 v[138:139], v[150:151], v[134:135] op_sel:[0,0] op_sel_hi:[0,1]
  v_pk_fma_f32 v[152:153], v[150:151], v[134:135], v[138:139] op_sel:[1,1,0] op_sel_hi:[1,0,1] neg_lo:[1,0,0]
  v_pk_mul_f32 v[138:139], v[152:153], v[134:135] op_sel:[0,0] op_sel_hi:[0,1]
  v_pk_fma_f32 v[154:155], v[152:153], v[134:135], v[138:139] op_sel:[1,1,0] op_sel_hi:[1,0,1] neg_lo:[1,0,0]
  v_mfma_f32_32x32x16_bf16 v[204:219], a[44:47], a[12:15], v[204:219]
  v_cvt_pk_bf16_f32 v144, v148, v149
  v_cvt_pk_bf16_f32 v145, v150, v151
  v_cvt_pk_bf16_f32 v146, v152, v153
  v_cvt_pk_bf16_f32 v147, v154, v155
  ds_read_b128 a[64:67], v124 offset:0
  ds_read_b128 a[68:71], v124 offset:32
  ds_write_addtid_b32 v144 offset:8704
  ds_write_addtid_b32 v145 offset:8976
  ds_write_addtid_b32 v146 offset:9248
  ds_write_addtid_b32 v147 offset:9520
  v_pk_mul_f32 v[138:139], v[154:155], v[134:135] op_sel:[0,0] op_sel_hi:[0,1]
  v_pk_fma_f32 v[156:157], v[154:155], v[134:135], v[138:139] op_sel:[1,1,0] op_sel_hi:[1,0,1] neg_lo:[1,0,0]
  v_pk_mul_f32 v[138:139], v[156:157], v[134:135] op_sel:[0,0] op_sel_hi:[0,1]
  v_pk_fma_f32 v[158:159], v[156:157], v[134:135], v[138:139] op_sel:[1,1,0] op_sel_hi:[1,0,1] neg_lo:[1,0,0]
  v_pk_mul_f32 v[138:139], v[158:159], v[134:135] op_sel:[0,0] op_sel_hi:[0,1]
  v_pk_fma_f32 v[160:161], v[158:159], v[134:135], v[138:139] op_sel:[1,1,0] op_sel_hi:[1,0,1] neg_lo:[1,0,0]
  v_pk_mul_f32 v[138:139], v[160:161], v[134:135] op_sel:[0,0] op_sel_hi:[0,1]
  v_pk_fma_f32 v[162:163], v[160:161], v[134:135], v[138:139] op_sel:[1,1,0] op_sel_hi:[1,0,1] neg_lo:[1,0,0]
  v_mfma_f32_32x32x16_bf16 v[204:219], a[48:51], a[16:19], v[204:219]
  v_cvt_pk_bf16_f32 v144, v156, v157
  v_cvt_pk_bf16_f32 v145, v158, v159
  v_cvt_pk_bf16_f32 v146, v160, v161
  v_cvt_pk_bf16_f32 v147, v162, v163
  ds_read_b128 a[72:75], v124 offset:64
  ds_read_b128 a[76:79], v124 offset:96
  ds_write_addtid_b32 v144 offset:9792
  ds_write_addtid_b32 v145 offset:10064
  ds_write_addtid_b32 v146 offset:10336
  ds_write_addtid_b32 v147 offset:10608
  v_pk_mul_f32 v[138:139], v[162:163], v[134:135] op_sel:[0,0] op_sel_hi:[0,1]
  v_pk_fma_f32 v[164:165], v[162:163], v[134:135], v[138:139] op_sel:[1,1,0] op_sel_hi:[1,0,1] neg_lo:[1,0,0]
  v_pk_mul_f32 v[138:139], v[148:149], v[136:137] op_sel:[0,0] op_sel_hi:[0,1]
  v_pk_fma_f32 v[166:167], v[148:149], v[136:137], v[138:139] op_sel:[1,1,0] op_sel_hi:[1,0,1] neg_lo:[1,0,0]
  v_pk_mul_f32 v[138:139], v[152:153], v[136:137] op_sel:[0,0] op_sel_hi:[0,1]
  v_pk_fma_f32 v[168:169], v[152:153], v[136:137], v[138:139] op_sel:[1,1,0] op_sel_hi:[1,0,1] neg_lo:[1,0,0]
  v_pk_mul_f32 v[138:139], v[156:157], v[136:137] op_sel:[0,0] op_sel_hi:[0,1]
  v_pk_fma_f32 v[170:171], v[156:157], v[136:137], v[138:139] op_sel:[1,1,0] op_sel_hi:[1,0,1] neg_lo:[1,0,0]
  s_waitcnt lgkmcnt(12)
  s_nop 0
  v_mfma_f32_32x32x16_bf16 v[204:219], a[52:55], a[20:23], v[204:219]
  v_cvt_pk_bf16_f32 v144, v164, v165
  v_cvt_pk_bf16_f32 v145, v166, v167
  v_cvt_pk_bf16_f32 v146, v168, v169
  v_cvt_pk_bf16_f32 v147, v170, v171
  ds_read_b128 a[80:83], v124 offset:128
  ds_read_b128 a[84:87], v124 offset:160
  ds_write_addtid_b32 v144 offset:10880
  ds_write_addtid_b32 v145 offset:11152
  ds_write_addtid_b32 v146 offset:11424
  ds_write_addtid_b32 v147 offset:11696
  v_pk_mul_f32 v[138:139], v[160:161], v[136:137] op_sel:[0,0] op_sel_hi:[0,1]
  v_pk_fma_f32 v[172:173], v[160:161], v[136:137], v[138:139] op_sel:[1,1,0] op_sel_hi:[1,0,1] neg_lo:[1,0,0]
  v_pk_mul_f32 v[138:139], v[164:165], v[136:137] op_sel:[0,0] op_sel_hi:[0,1]
  v_pk_fma_f32 v[174:175], v[164:165], v[136:137], v[138:139] op_sel:[1,1,0] op_sel_hi:[1,0,1] neg_lo:[1,0,0]
  v_pk_mul_f32 v[138:139], v[170:171], v[136:137] op_sel:[0,0] op_sel_hi:[0,1]
  v_pk_fma_f32 v[176:177], v[170:171], v[136:137], v[138:139] op_sel:[1,1,0] op_sel_hi:[1,0,1] neg_lo:[1,0,0]
  v_pk_mul_f32 v[138:139], v[174:175], v[136:137] op_sel:[0,0] op_sel_hi:[0,1]
  v_pk_fma_f32 v[178:179], v[174:175], v[136:137], v[138:139] op_sel:[1,1,0] op_sel_hi:[1,0,1] neg_lo:[1,0,0]
  v_mfma_f32_32x32x16_bf16 v[204:219], a[56:59], a[24:27], v[204:219]
  v_cvt_pk_bf16_f32 v144, v172, v173
  v_cvt_pk_bf16_f32 v145, v174, v175
  v_cvt_pk_bf16_f32 v146, v176, v177
  v_cvt_pk_bf16_f32 v147, v178, v179
  ds_read_b128 a[88:91], v124 offset:192
  ds_read_b128 a[92:95], v124 offset:224
  ds_write_addtid_b32 v144 offset:11968
  ds_write_addtid_b32 v145 offset:12240
  ds_write_addtid_b32 v146 offset:12512
  ds_write_addtid_b32 v147 offset:12784
  s_mov_b64 exec, 0xffff
  global_load_dword v237, v244, s[22:23] sc1
  s_mov_b64 exec, -1
  s_nop 0
  v_pk_mul_f32 v[138:139], v[176:177], v[136:137] op_sel:[0,0] op_sel_hi:[0,1]
  v_pk_fma_f32 v[180:181], v[176:177], v[136:137], v[138:139] op_sel:[1,1,0] op_sel_hi:[1,0,1] neg_lo:[1,0,0]
  v_pk_mul_f32 v[138:139], v[178:179], v[136:137] op_sel:[0,0] op_sel_hi:[0,1]
  v_pk_fma_f32 v[182:183], v[178:179], v[136:137], v[138:139] op_sel:[1,1,0] op_sel_hi:[1,0,1] neg_lo:[1,0,0]
  v_pk_mul_f32 v[138:139], v[182:183], v[136:137] op_sel:[0,0] op_sel_hi:[0,1]
  v_pk_fma_f32 v[184:185], v[182:183], v[136:137], v[138:139] op_sel:[1,1,0] op_sel_hi:[1,0,1] neg_lo:[1,0,0]
  v_pk_mul_f32 v[138:139], v[184:185], v[136:137] op_sel:[0,0] op_sel_hi:[0,1]
  v_pk_fma_f32 v[186:187], v[184:185], v[136:137], v[138:139] op_sel:[1,1,0] op_sel_hi:[1,0,1] neg_lo:[1,0,0]
  v_mfma_f32_32x32x16_bf16 v[204:219], a[60:63], a[28:31], v[204:219]
  v_cvt_pk_bf16_f32 v144, v180, v181
  v_cvt_pk_bf16_f32 v145, v182, v183
  v_cvt_pk_bf16_f32 v146, v184, v185
  v_cvt_pk_bf16_f32 v147, v186, v187
  ds_write_addtid_b32 v144 offset:13056
  ds_write_addtid_b32 v145 offset:13328
  ds_write_addtid_b32 v146 offset:13600
  ds_write_addtid_b32 v147 offset:13872
  v_pk_mul_f32 v[138:139], v[186:187], v[136:137] op_sel:[0,0] op_sel_hi:[0,1]
  v_pk_fma_f32 v[188:189], v[186:187], v[136:137], v[138:139] op_sel:[1,1,0] op_sel_hi:[1,0,1] neg_lo:[1,0,0]
  v_pk_mul_f32 v[138:139], v[188:189], v[136:137] op_sel:[0,0] op_sel_hi:[0,1]
  v_pk_fma_f32 v[190:191], v[188:189], v[136:137], v[138:139] op_sel:[1,1,0] op_sel_hi:[1,0,1] neg_lo:[1,0,0]
  v_cvt_pk_bf16_f32 v144, v188, v189
  v_cvt_pk_bf16_f32 v145, v190, v191
  ds_write_addtid_b32 v144 offset:14144
  ds_write_addtid_b32 v145 offset:14416
  v_lshlrev_b32 v128, 16, v118
  v_lshlrev_b32 v129, 16, v119
  v_pk_mul_f32 v[128:129], v[128:129], v[126:127] op_sel_hi:[1,0]
  v_pk_mul_f32 v[128:129], v[128:129], s[34:35]
  v_mul_f32 v140, 0x41000000, v128
  v_mul_f32 v141, 0x41000000, v129
  v_exp_f32 v140, v140
  v_fract_f32 v141, v141
  v_cos_f32 v150, v141
  v_sin_f32 v151, v141
  v_exp_f32 v142, v128
  v_fract_f32 v143, v129
  v_cos_f32 v134, v143
  v_sin_f32 v135, v143
  v_pk_mul_f32 v[150:151], v[150:151], v[140:141] op_sel_hi:[1,0] neg_hi:[1,0]
  v_pk_mul_f32 v[134:135], v[134:135], v[142:143] op_sel_hi:[1,0]
  v_pk_mul_f32 v[138:139], v[150:151], v[150:151] op_sel:[0,0] op_sel_hi:[0,1]
  v_pk_fma_f32 v[152:153], v[150:151], v[150:151], v[138:139] op_sel:[1,1,0] op_sel_hi:[1,0,1] neg_lo:[1,0,0]
  v_pk_mul_f32 v[138:139], v[152:153], v[150:151] op_sel:[0,0] op_sel_hi:[0,1]
  v_pk_fma_f32 v[154:155], v[152:153], v[150:151], v[138:139] op_sel:[1,1,0] op_sel_hi:[1,0,1] neg_lo:[1,0,0]
  v_cvt_pk_bf16_f32 v145, v150, v151
  v_cvt_pk_bf16_f32 v146, v152, v153
  v_cvt_pk_bf16_f32 v147, v154, v155
  ds_read_b128 a[96:99], v125 offset:8704
  ds_read_b128 a[100:103], v125 offset:8736
  ds_write_addtid_b32 v127 offset:0
  ds_write_addtid_b32 v145 offset:272
  ds_write_addtid_b32 v146 offset:544
  ds_write_addtid_b32 v147 offset:816
  v_pk_mul_f32 v[138:139], v[154:155], v[150:151] op_sel:[0,0] op_sel_hi:[0,1]
  v_pk_fma_f32 v[156:157], v[154:155], v[150:151], v[138:139] op_sel:[1,1,0] op_sel_hi:[1,0,1] neg_lo:[1,0,0]
  v_pk_mul_f32 v[138:139], v[156:157], v[150:151] op_sel:[0,0] op_sel_hi:[0,1]
  v_pk_fma_f32 v[158:159], v[156:157], v[150:151], v[138:139] op_sel:[1,1,0] op_sel_hi:[1,0,1] neg_lo:[1,0,0]
  v_pk_mul_f32 v[138:139], v[158:159], v[150:151] op_sel:[0,0] op_sel_hi:[0,1]
  v_pk_fma_f32 v[160:161], v[158:159], v[150:151], v[138:139] op_sel:[1,1,0] op_sel_hi:[1,0,1] neg_lo:[1,0,0]
  v_pk_mul_f32 v[138:139], v[160:161], v[150:151] op_sel:[0,0] op_sel_hi:[0,1]
  v_pk_fma_f32 v[162:163], v[160:161], v[150:151], v[138:139] op_sel:[1,1,0] op_sel_hi:[1,0,1] neg_lo:[1,0,0]
  v_cvt_pk_bf16_f32 v144, v156, v157
  v_cvt_pk_bf16_f32 v145, v158, v159
  v_cvt_pk_bf16_f32 v146, v160, v161
  v_cvt_pk_bf16_f32 v147, v162, v163
  ds_read_b128 a[104:107], v125 offset:8768
  ds_read_b128 a[108:111], v125 offset:8800
  ds_write_addtid_b32 v144 offset:1088
  ds_write_addtid_b32 v145 offset:1360
  ds_write_addtid_b32 v146 offset:1632
  ds_write_addtid_b32 v147 offset:1904
  v_pk_mul_f32 v[138:139], v[162:163], v[150:151] op_sel:[0,0] op_sel_hi:[0,1]
  v_pk_fma_f32 v[164:165], v[162:163], v[150:151], v[138:139] op_sel:[1,1,0] op_sel_hi:[1,0,1] neg_lo:[1,0,0]
  v_pk_mul_f32 v[138:139], v[150:151], v[164:165] op_sel:[0,0] op_sel_hi:[0,1]
  v_pk_fma_f32 v[150:151], v[150:151], v[164:165], v[138:139] op_sel:[1,1,0] op_sel_hi:[1,0,1] neg_lo:[1,0,0]
  v_pk_mul_f32 v[138:139], v[152:153], v[164:165] op_sel:[0,0] op_sel_hi:[0,1]
  v_pk_fma_f32 v[152:153], v[152:153], v[164:165], v[138:139] op_sel:[1,1,0] op_sel_hi:[1,0,1] neg_lo:[1,0,0]
  v_pk_mul_f32 v[138:139], v[154:155], v[164:165] op_sel:[0,0] op_sel_hi:[0,1]
  v_pk_fma_f32 v[154:155], v[154:155], v[164:165], v[138:139] op_sel:[1,1,0] op_sel_hi:[1,0,1] neg_lo:[1,0,0]
  v_cvt_pk_bf16_f32 v144, v164, v165
  v_cvt_pk_bf16_f32 v145, v150, v151
  v_cvt_pk_bf16_f32 v146, v152, v153
  v_cvt_pk_bf16_f32 v147, v154, v155
  ds_read_b128 a[112:115], v125 offset:8832
  ds_read_b128 a[116:119], v125 offset:8864
  ds_write_addtid_b32 v144 offset:2176
  ds_write_addtid_b32 v145 offset:2448
  ds_write_addtid_b32 v146 offset:2720
  ds_write_addtid_b32 v147 offset:2992
  s_waitcnt vmcnt(0)
  v_cmp_ne_u32 vcc, s65, v237
  s_nop 0
  s_and_b64 vcc, vcc, 0xffff
  s_cbranch_vccnz u_hinta
u_hinta_ok:
  v_pk_mul_f32 v[138:139], v[156:157], v[164:165] op_sel:[0,0] op_sel_hi:[0,1]
  v_pk_fma_f32 v[156:157], v[156:157], v[164:165], v[138:139] op_sel:[1,1,0] op_sel_hi:[1,0,1] neg_lo:[1,0,0]
  v_pk_mul_f32 v[138:139], v[158:159], v[164:165] op_sel:[0,0] op_sel_hi:[0,1]
  v_pk_fma_f32 v[158:159], v[158:159], v[164:165], v[138:139] op_sel:[1,1,0] op_sel_hi:[1,0,1] neg_lo:[1,0,0]
  v_pk_mul_f32 v[138:139], v[160:161], v[164:165] op_sel:[0,0] op_sel_hi:[0,1]
  v_pk_fma_f32 v[160:161], v[160:161], v[164:165], v[138:139] op_sel:[1,1,0] op_sel_hi:[1,0,1] neg_lo:[1,0,0]
  v_pk_mul_f32 v[138:139], v[162:163], v[164:165] op_sel:[0,0] op_sel_hi:[0,1]
  v_pk_fma_f32 v[162:163], v[162:163], v[164:165], v[138:139] op_sel:[1,1,0] op_sel_hi:[1,0,1] neg_lo:[1,0,0]
  v_cvt_pk_bf16_f32 v144, v156, v157
  v_cvt_pk_bf16_f32 v145, v158, v159
  v_cvt_pk_bf16_f32 v146, v160, v161
  v_cvt_pk_bf16_f32 v147, v162, v163
  ds_read_b128 a[120:123], v125 offset:8896
  ds_read_b128 a[124:127], v125 offset:8928
  ds_write_addtid_b32 v144 offset:3264
  ds_write_addtid_b32 v145 offset:3536
  ds_write_addtid_b32 v146 offset:3808
  ds_write_addtid_b32 v147 offset:4080
  s_mov_b64 exec, 0xffffffff
  global_load_dword v236, v225, s[22:23] sc1
  s_mov_b64 exec, -1
  s_nop 0
  v_pk_mul_f32 v[138:139], v[164:165], v[164:165] op_sel:[0,0] op_sel_hi:[0,1]
  v_pk_fma_f32 v[148:149], v[164:165], v[164:165], v[138:139] op_sel:[1,1,0] op_sel_hi:[1,0,1] neg_lo:[1,0,0]
  v_pk_mul_f32 v[138:139], v[148:149], v[148:149] op_sel:[0,0] op_sel_hi:[0,1] neg_hi:[1,0]
  v_pk_fma_f32 v[136:137], v[148:149], v[148:149], v[138:139] op_sel:[1,1,0] op_sel_hi:[1,0,1] neg_lo:[1,0,0] neg_hi:[1,0,0]
  v_pk_mul_f32 v[138:139], v[150:151], v[164:165] op_sel:[0,0] op_sel_hi:[0,1]
  v_pk_fma_f32 v[150:151], v[150:151], v[164:165], v[138:139] op_sel:[1,1,0] op_sel_hi:[1,0,1] neg_lo:[1,0,0]
  v_pk_mul_f32 v[138:139], v[152:153], v[164:165] op_sel:[0,0] op_sel_hi:[0,1]
  v_pk_fma_f32 v[152:153], v[152:153], v[164:165], v[138:139] op_sel:[1,1,0] op_sel_hi:[1,0,1] neg_lo:[1,0,0]
  v_pk_mul_f32 v[138:139], v[154:155], v[164:165] op_sel:[0,0] op_sel_hi:[0,1]
  v_pk_fma_f32 v[154:155], v[154:155], v[164:165], v[138:139] op_sel:[1,1,0] op_sel_hi:[1,0,1] neg_lo:[1,0,0]
  v_cvt_pk_bf16_f32 v144, v148, v149
  v_cvt_pk_bf16_f32 v145, v150, v151
  v_cvt_pk_bf16_f32 v146, v152, v153
  v_cvt_pk_bf16_f32 v147, v154, v155
  ds_write_addtid_b32 v144 offset:4352
  ds_write_addtid_b32 v145 offset:4624
  ds_write_addtid_b32 v146 offset:4896
  ds_write_addtid_b32 v147 offset:5168
  v_pk_mul_f32 v[138:139], v[156:157], v[164:165] op_sel:[0,0] op_sel_hi:[0,1]
  v_pk_fma_f32 v[156:157], v[156:157], v[164:165], v[138:139] op_sel:[1,1,0] op_sel_hi:[1,0,1] neg_lo:[1,0,0]
  v_pk_mul_f32 v[138:139], v[158:159], v[164:165] op_sel:[0,0] op_sel_hi:[0,1]
  v_pk_fma_f32 v[158:159], v[158:159], v[164:165], v[138:139] op_sel:[1,1,0] op_sel_hi:[1,0,1] neg_lo:[1,0,0]
  v_pk_mul_f32 v[138:139], v[160:161], v[164:165] op_sel:[0,0] op_sel_hi:[0,1]
  v_pk_fma_f32 v[160:161], v[160:161], v[164:165], v[138:139] op_sel:[1,1,0] op_sel_hi:[1,0,1] neg_lo:[1,0,0]
  v_pk_mul_f32 v[138:139], v[162:163], v[164:165] op_sel:[0,0] op_sel_hi:[0,1]
  v_pk_fma_f32 v[162:163], v[162:163], v[164:165], v[138:139] op_sel:[1,1,0] op_sel_hi:[1,0,1] neg_lo:[1,0,0]
  s_waitcnt lgkmcnt(15)
  s_nop 0
  v_mfma_f32_32x32x16_bf16 v[204:219], a[96:99], a[64:67], v[204:219]
  v_cvt_pk_bf16_f32 v144, v156, v157
  v_cvt_pk_bf16_f32 v145, v158, v159
  v_cvt_pk_bf16_f32 v146, v160, v161
  v_cvt_pk_bf16_f32 v147, v162, v163
  ds_write_addtid_b32 v144 offset:5440
  ds_write_addtid_b32 v145 offset:5712
  ds_write_addtid_b32 v146 offset:5984
  ds_write_addtid_b32 v147 offset:6256
  v_pk_mul_f32 v[138:139], v[148:149], v[164:165] op_sel:[0,0] op_sel_hi:[0,1]
  v_pk_fma_f32 v[148:149], v[148:149], v[164:165], v[138:139] op_sel:[1,1,0] op_sel_hi:[1,0,1] neg_lo:[1,0,0]
  v_pk_mul_f32 v[138:139], v[150:151], v[164:165] op_sel:[0,0] op_sel_hi:[0,1]
warm3:
  s_cbranch_execz warm7
  s_nop 0
  v_pk_fma_f32 v[150:151], v[150:151], v[164:165], v[138:139] op_sel:[1,1,0] op_sel_hi:[1,0,1] neg_lo:[1,0,0]
  v_pk_mul_f32 v[138:139], v[152:153], v[164:165] op_sel:[0,0] op_sel_hi:[0,1]
  v_pk_fma_f32 v[152:153], v[152:153], v[164:165], v[138:139] op_sel:[1,1,0] op_sel_hi:[1,0,1] neg_lo:[1,0,0]
  v_pk_mul_f32 v[138:139], v[154:155], v[164:165] op_sel:[0,0] op_sel_hi:[0,1]
  v_pk_fma_f32 v[154:155], v[154:155], v[164:165], v[138:139] op_sel:[1,1,0] op_sel_hi:[1,0,1] neg_lo:[1,0,0]
  v_mfma_f32_32x32x16_bf16 v[204:219], a[100:103], a[68:71], v[204:219]
  v_cvt_pk_bf16_f32 v144, v148, v149
  v_cvt_pk_bf16_f32 v145, v150, v151
  v_cvt_pk_bf16_f32 v146, v152, v153
  v_cvt_pk_bf16_f32 v147, v154, v155
  ds_write_addtid_b32 v144 offset:6528
  ds_write_addtid_b32 v145 offset:6800
  ds_write_addtid_b32 v146 offset:7072
  ds_write_addtid_b32 v147 offset:7344
  v_pk_mul_f32 v[138:139], v[156:157], v[164:165] op_sel:[0,0] op_sel_hi:[0,1]
  v_pk_fma_f32 v[156:157], v[156:157], v[164:165], v[138:139] op_sel:[1,1,0] op_sel_hi:[1,0,1] neg_lo:[1,0,0]
  v_pk_mul_f32 v[138:139], v[158:159], v[164:165] op_sel:[0,0] op_sel_hi:[0,1]
  v_pk_fma_f32 v[158:159], v[158:159], v[164:165], v[138:139] op_sel:[1,1,0] op_sel_hi:[1,0,1] neg_lo:[1,0,0]
  v_pk_mul_f32 v[138:139], v[160:161], v[164:165] op_sel:[0,0] op_sel_hi:[0,1]
  v_pk_fma_f32 v[160:161], v[160:161], v[164:165], v[138:139] op_sel:[1,1,0] op_sel_hi:[1,0,1] neg_lo:[1,0,0]
  v_pk_mul_f32 v[138:139], v[162:163], v[164:165] op_sel:[0,0] op_sel_hi:[0,1]
  v_pk_fma_f32 v[162:163], v[162:163], v[164:165], v[138:139] op_sel:[1,1,0] op_sel_hi:[1,0,1] neg_lo:[1,0,0]
  v_mfma_f32_32x32x16_bf16 v[204:219], a[104:107], a[72:75], v[204:219]
  v_cvt_pk_bf16_f32 v144, v156, v157
  v_cvt_pk_bf16_f32 v145, v158, v159
  v_cvt_pk_bf16_f32 v146, v160, v161
  v_cvt_pk_bf16_f32 v147, v162, v163
  ds_write_addtid_b32 v144 offset:7616
  ds_write_addtid_b32 v145 offset:7888
  ds_write_addtid_b32 v146 offset:8160
  ds_write_addtid_b32 v147 offset:8432
  v_lshlrev_b32 v130, 16, v120
  v_lshlrev_b32 v131, 16, v121
  v_lshlrev_b32 v132, 16, v122
  v_lshlrev_b32 v133, 16, v123
  v_pk_mul_f32 v[130:131], v[130:131], v[126:127] op_sel_hi:[1,0]
  v_pk_mul_f32 v[138:139], v[132:133], v[130:131] op_sel:[0,0] op_sel_hi:[0,1]
  v_pk_fma_f32 v[148:149], v[132:133], v[130:131], v[138:139] op_sel:[1,1,0] op_sel_hi:[1,0,1] neg_lo:[1,0,0]
  v_pk_mul_f32 v[138:139], v[148:149], v[134:135] op_sel:[0,0] op_sel_hi:[0,1]
  v_pk_fma_f32 v[150:151], v[148:149], v[134:135], v[138:139] op_sel:[1,1,0] op_sel_hi:[1,0,1] neg_lo:[1,0,0]
  v_pk_mul_f32 v[138:139], v[150:151], v[134:135] op_sel:[0,0] op_sel_hi:[0,1]
  v_pk_fma_f32 v[152:153], v[150:151], v[134:135], v[138:139] op_sel:[1,1,0] op_sel_hi:[1,0,1] neg_lo:[1,0,0]
  v_pk_mul_f32 v[138:139], v[152:153], v[134:135] op_sel:[0,0] op_sel_hi:[0,1]
  v_pk_fma_f32 v[154:155], v[152:153], v[134:135], v[138:139] op_sel:[1,1,0] op_sel_hi:[1,0,1] neg_lo:[1,0,0]
  v_mfma_f32_32x32x16_bf16 v[204:219], a[108:111], a[76:79], v[204:219]
  v_cvt_pk_bf16_f32 v144, v148, v149
  v_cvt_pk_bf16_f32 v145, v150, v151
  v_cvt_pk_bf16_f32 v146, v152, v153
  v_cvt_pk_bf16_f32 v147, v154, v155
  ds_read_b128 a[0:3], v124 offset:0
  ds_read_b128 a[4:7], v124 offset:32
  ds_write_addtid_b32 v144 offset:8704
  ds_write_addtid_b32 v145 offset:8976
  ds_write_addtid_b32 v146 offset:9248
  ds_write_addtid_b32 v147 offset:9520
  v_pk_mul_f32 v[138:139], v[154:155], v[134:135] op_sel:[0,0] op_sel_hi:[0,1]
  v_pk_fma_f32 v[156:157], v[154:155], v[134:135], v[138:139] op_sel:[1,1,0] op_sel_hi:[1,0,1] neg_lo:[1,0,0]
  v_pk_mul_f32 v[138:139], v[156:157], v[134:135] op_sel:[0,0] op_sel_hi:[0,1]
  v_pk_fma_f32 v[158:159], v[156:157], v[134:135], v[138:139] op_sel:[1,1,0] op_sel_hi:[1,0,1] neg_lo:[1,0,0]
  v_pk_mul_f32 v[138:139], v[158:159], v[134:135] op_sel:[0,0] op_sel_hi:[0,1]
  v_pk_fma_f32 v[160:161], v[158:159], v[134:135], v[138:139] op_sel:[1,1,0] op_sel_hi:[1,0,1] neg_lo:[1,0,0]
  v_pk_mul_f32 v[138:139], v[160:161], v[134:135] op_sel:[0,0] op_sel_hi:[0,1]
  v_pk_fma_f32 v[162:163], v[160:161], v[134:135], v[138:139] op_sel:[1,1,0] op_sel_hi:[1,0,1] neg_lo:[1,0,0]
  v_mfma_f32_32x32x16_bf16 v[204:219], a[112:115], a[80:83], v[204:219]
  v_cvt_pk_bf16_f32 v144, v156, v157
  v_cvt_pk_bf16_f32 v145, v158, v159
  v_cvt_pk_bf16_f32 v146, v160, v161
  v_cvt_pk_bf16_f32 v147, v162, v163
  ds_read_b128 a[8:11], v124 offset:64
  ds_read_b128 a[12:15], v124 offset:96
  ds_write_addtid_b32 v144 offset:9792
  ds_write_addtid_b32 v145 offset:10064
  ds_write_addtid_b32 v146 offset:10336
  ds_write_addtid_b32 v147 offset:10608
  v_pk_mul_f32 v[138:139], v[162:163], v[134:135] op_sel:[0,0] op_sel_hi:[0,1]
  v_pk_fma_f32 v[164:165], v[162:163], v[134:135], v[138:139] op_sel:[1,1,0] op_sel_hi:[1,0,1] neg_lo:[1,0,0]
  v_pk_mul_f32 v[138:139], v[148:149], v[136:137] op_sel:[0,0] op_sel_hi:[0,1]
  v_pk_fma_f32 v[166:167], v[148:149], v[136:137], v[138:139] op_sel:[1,1,0] op_sel_hi:[1,0,1] neg_lo:[1,0,0]
  v_pk_mul_f32 v[138:139], v[152:153], v[136:137] op_sel:[0,0] op_sel_hi:[0,1]
  v_pk_fma_f32 v[168:169], v[152:153], v[136:137], v[138:139] op_sel:[1,1,0] op_sel_hi:[1,0,1] neg_lo:[1,0,0]
  v_pk_mul_f32 v[138:139], v[156:157], v[136:137] op_sel:[0,0] op_sel_hi:[0,1]
  v_pk_fma_f32 v[170:171], v[156:157], v[136:137], v[138:139] op_sel:[1,1,0] op_sel_hi:[1,0,1] neg_lo:[1,0,0]
  s_waitcnt lgkmcnt(12)
  v_mfma_f32_32x32x16_bf16 v[204:219], a[116:119], a[84:87], v[204:219]
  v_cvt_pk_bf16_f32 v144, v164, v165
  v_cvt_pk_bf16_f32 v145, v166, v167
  v_cvt_pk_bf16_f32 v146, v168, v169
  v_cvt_pk_bf16_f32 v147, v170, v171
  ds_read_b128 a[16:19], v124 offset:128
  ds_read_b128 a[20:23], v124 offset:160
  ds_write_addtid_b32 v144 offset:10880
  ds_write_addtid_b32 v145 offset:11152
  ds_write_addtid_b32 v146 offset:11424
  ds_write_addtid_b32 v147 offset:11696
  s_waitcnt vmcnt(0)
  v_cmp_ne_u32 vcc, s65, v236
  s_nop 0
  s_and_b64 vcc, vcc, 0xffffffff
  s_cbranch_vccnz u_spina
u_oka:
  s_mov_b64 exec, s[56:57]
  global_load_dwordx2 v[240:241], v227, s[22:23] sc1
  s_mov_b64 exec, -1
  s_nop 0
  v_pk_mul_f32 v[138:139], v[160:161], v[136:137] op_sel:[0,0] op_sel_hi:[0,1]
  v_pk_fma_f32 v[172:173], v[160:161], v[136:137], v[138:139] op_sel:[1,1,0] op_sel_hi:[1,0,1] neg_lo:[1,0,0]
  v_pk_mul_f32 v[138:139], v[164:165], v[136:137] op_sel:[0,0] op_sel_hi:[0,1]
  v_pk_fma_f32 v[174:175], v[164:165], v[136:137], v[138:139] op_sel:[1,1,0] op_sel_hi:[1,0,1] neg_lo:[1,0,0]
  v_pk_mul_f32 v[138:139], v[170:171], v[136:137] op_sel:[0,0] op_sel_hi:[0,1]
  v_pk_fma_f32 v[176:177], v[170:171], v[136:137], v[138:139] op_sel:[1,1,0] op_sel_hi:[1,0,1] neg_lo:[1,0,0]
  v_pk_mul_f32 v[138:139], v[174:175], v[136:137] op_sel:[0,0] op_sel_hi:[0,1]
  v_pk_fma_f32 v[178:179], v[174:175], v[136:137], v[138:139] op_sel:[1,1,0] op_sel_hi:[1,0,1] neg_lo:[1,0,0]
  v_mfma_f32_32x32x16_bf16 v[204:219], a[120:123], a[88:91], v[204:219]
  v_cvt_pk_bf16_f32 v144, v172, v173
  v_cvt_pk_bf16_f32 v145, v174, v175
  v_cvt_pk_bf16_f32 v146, v176, v177
  v_cvt_pk_bf16_f32 v147, v178, v179
  ds_read_b128 a[24:27], v124 offset:192
  ds_read_b128 a[28:31], v124 offset:224
  ds_write_addtid_b32 v144 offset:11968
  ds_write_addtid_b32 v145 offset:12240
  ds_write_addtid_b32 v146 offset:12512
  ds_write_addtid_b32 v147 offset:12784
  global_load_dwordx4 v[8:11], v232, s[22:23] offset:0 sc1
  v_pk_mul_f32 v[138:139], v[176:177], v[136:137] op_sel:[0,0] op_sel_hi:[0,1]
  v_pk_fma_f32 v[180:181], v[176:177], v[136:137], v[138:139] op_sel:[1,1,0] op_sel_hi:[1,0,1] neg_lo:[1,0,0]
  v_pk_mul_f32 v[138:139], v[178:179], v[136:137] op_sel:[0,0] op_sel_hi:[0,1]
  v_pk_fma_f32 v[182:183], v[178:179], v[136:137], v[138:139] op_sel:[1,1,0] op_sel_hi:[1,0,1] neg_lo:[1,0,0]
  v_pk_mul_f32 v[138:139], v[182:183], v[136:137] op_sel:[0,0] op_sel_hi:[0,1]
  v_pk_fma_f32 v[184:185], v[182:183], v[136:137], v[138:139] op_sel:[1,1,0] op_sel_hi:[1,0,1] neg_lo:[1,0,0]
  v_pk_mul_f32 v[138:139], v[184:185], v[136:137] op_sel:[0,0] op_sel_hi:[0,1]
  v_pk_fma_f32 v[186:187], v[184:185], v[136:137], v[138:139] op_sel:[1,1,0] op_sel_hi:[1,0,1] neg_lo:[1,0,0]
  v_mfma_f32_32x32x16_bf16 v[204:219], a[124:127], a[92:95], v[204:219]
  v_cvt_pk_bf16_f32 v144, v180, v181
  v_cvt_pk_bf16_f32 v145, v182, v183
  v_cvt_pk_bf16_f32 v146, v184, v185
  v_cvt_pk_bf16_f32 v147, v186, v187
  ds_write_addtid_b32 v144 offset:13056
  ds_write_addtid_b32 v145 offset:13328
  ds_write_addtid_b32 v146 offset:13600
  ds_write_addtid_b32 v147 offset:13872
  global_load_dwordx4 v[24:27], v233, s[22:23] offset:0 sc1
  v_pk_mul_f32 v[138:139], v[186:187], v[136:137] op_sel:[0,0] op_sel_hi:[0,1]
  v_pk_fma_f32 v[188:189], v[186:187], v[136:137], v[138:139] op_sel:[1,1,0] op_sel_hi:[1,0,1] neg_lo:[1,0,0]
  v_pk_mul_f32 v[138:139], v[188:189], v[136:137] op_sel:[0,0] op_sel_hi:[0,1]
  v_pk_fma_f32 v[190:191], v[188:189], v[136:137], v[138:139] op_sel:[1,1,0] op_sel_hi:[1,0,1] neg_lo:[1,0,0]
  v_cvt_pk_bf16_f32 v144, v188, v189
  v_cvt_pk_bf16_f32 v145, v190, v191
  ds_write_addtid_b32 v144 offset:14144
  ds_write_addtid_b32 v145 offset:14416
  ds_read_b128 a[32:35], v125 offset:8704
  ds_read_b128 a[36:39], v125 offset:8736
  ds_read_b128 a[40:43], v125 offset:8768
  ds_read_b128 a[44:47], v125 offset:8800
  ds_read_b128 a[48:51], v125 offset:8832
  ds_read_b128 a[52:55], v125 offset:8864
  ds_read_b128 a[56:59], v125 offset:8896
  ds_read_b128 a[60:63], v125 offset:8928
  global_load_dwordx4 v[12:15], v232, s[22:23] offset:1024 sc1
  global_load_dwordx4 v[28:31], v233, s[22:23] offset:1024 sc1
  s_waitcnt lgkmcnt(7)
  v_mfma_f32_32x32x16_bf16 v[204:219], a[32:35], a[0:3], v[204:219]
  global_load_dwordx4 v[16:19], v232, s[22:23] offset:2048 sc1
  s_waitcnt lgkmcnt(6)
  v_mfma_f32_32x32x16_bf16 v[204:219], a[36:39], a[4:7], v[204:219]
  s_waitcnt lgkmcnt(5)
  v_mfma_f32_32x32x16_bf16 v[204:219], a[40:43], a[8:11], v[204:219]
  global_load_dwordx4 v[32:35], v233, s[22:23] offset:2048 sc1
  s_waitcnt lgkmcnt(4)
  v_mfma_f32_32x32x16_bf16 v[204:219], a[44:47], a[12:15], v[204:219]
  s_waitcnt lgkmcnt(3)
  v_mfma_f32_32x32x16_bf16 v[204:219], a[48:51], a[16:19], v[204:219]
  global_load_dwordx4 v[20:23], v232, s[22:23] offset:3072 sc1
  s_waitcnt lgkmcnt(0)
  v_mfma_f32_32x32x16_bf16 v[204:219], a[52:55], a[20:23], v[204:219]
  v_mfma_f32_32x32x16_bf16 v[204:219], a[56:59], a[24:27], v[204:219]
  global_load_dwordx4 v[36:39], v233, s[22:23] offset:3072 sc1
  v_mfma_f32_32x32x16_bf16 v[204:219], a[60:63], a[28:31], v[204:219]
  s_nop 11
  v_add_f32 v204, v204, v224
  v_cvt_pk_bf16_f32 v180, v212, v211
  v_cvt_pk_bf16_f32 v181, v210, v209
  v_cvt_pk_bf16_f32 v182, v208, v207
  v_cvt_pk_bf16_f32 v183, v206, v205
  v_cvt_pk_bf16_f32 v184, v211, v210
  v_cvt_pk_bf16_f32 v185, v209, v208
  v_cvt_pk_bf16_f32 v186, v207, v206
  v_cvt_pk_bf16_f32 v187, v205, v204
  ds_write_b128 v220, v[180:183] offset:1072
  v_cvt_pk_bf16_f32 v188, v214, v213
  v_cvt_pk_bf16_f32 v189, v215, v216
  v_readlane_b32 s8, v187, 0
  v_readlane_b32 s9, v180, 63
  v_readlane_b32 s11, v188, 63
  ds_write_b128 v220, v[184:187] offset:2176
  s_lshr_b32 s8, s8, 16
  s_lshl_b32 s10, s9, 16
  s_and_b32 s11, s11, 0xffff
  v_writelane_b32 v228, s8, 4
  v_writelane_b32 v231, s9, 3
  v_writelane_b32 v230, s10, 8
  v_writelane_b32 v231, s9, 8
  s_mov_b64 exec, 0xffffffff
  ds_write_b128 v221, v[228:231]
  s_mov_b64 exec, -1
  ds_write_b32 v222, v188 offset:2572
  ds_write_b16 v223, v189 offset:2958
  ds_write_b16_d16_hi v223, v189 offset:2830
  ds_read2_b32 a[112:113], v109 offset0:0 offset1:1
  ds_read2_b32 a[114:115], v109 offset0:2 offset1:3
  ds_read2_b32 a[116:117], v101 offset0:128 offset1:129
  ds_read2_b32 a[118:119], v101 offset0:130 offset1:131
  ds_read2_b32 a[108:109], v101 offset0:0 offset1:1
  ds_read2_b32 a[110:111], v101 offset0:2 offset1:3
  ds_read2_b32 a[120:121], v101 offset0:240 offset1:241
  ds_read2_b32 a[122:123], v101 offset0:242 offset1:243
  ds_read2_b32 a[124:125], v101 offset0:112 offset1:113
  ds_read2_b32 a[126:127], v101 offset0:114 offset1:115
  ds_read_b64 a[176:177], v102 offset:2568
  ds_read_b64 a[178:179], v102 offset:2576
  ds_read2_b32 a[128:129], v101 offset0:224 offset1:225
  ds_read2_b32 a[130:131], v101 offset0:226 offset1:227
  ds_read2_b32 a[132:133], v101 offset0:96 offset1:97
  ds_read2_b32 a[134:135], v101 offset0:98 offset1:99
  ds_read_b64 a[180:181], v102 offset:2584
  ds_read_b64 a[182:183], v102 offset:2592
  ds_read2_b32 a[136:137], v101 offset0:208 offset1:209
  ds_read2_b32 a[138:139], v101 offset0:210 offset1:211
  ds_read2_b32 a[140:141], v101 offset0:80 offset1:81
  ds_read2_b32 a[142:143], v101 offset0:82 offset1:83
  ds_read_b64 a[184:185], v102 offset:2440
  ds_read_b64 a[186:187], v102 offset:2448
  ds_read2_b32 a[144:145], v101 offset0:192 offset1:193
  ds_read2_b32 a[146:147], v101 offset0:194 offset1:195
  ds_read2_b32 a[148:149], v101 offset0:64 offset1:65
  ds_read2_b32 a[150:151], v101 offset0:66 offset1:67
  ds_read_b64 a[188:189], v102 offset:2456
  ds_read_b64 a[190:191], v102 offset:2464
  v_mul_u32_u24 v72, s11, v72
  v_mul_u32_u24 v73, s11, v73
  v_mul_u32_u24 v74, s11, v74
  v_mul_u32_u24 v75, s11, v75
  s_waitcnt vmcnt(8)
  v_cmp_ne_u32 vcc, s65, v241
  s_nop 0
  s_and_b64 vcc, vcc, s[56:57]
  s_cbranch_vccnz u_spinmd
u_okmd:
  v_add_f32_dpp v240, v240, v240 row_ror:4 row_mask:0xf bank_mask:0xf
  s_nop 1
  v_add_f32_dpp v240, v240, v240 row_ror:8 row_mask:0xf bank_mask:0xf
  v_cvt_pk_bf16_f32 v240, v240, v240
  v_and_b32 v240, 0xffff0000, v240
  v_add_f32_e64 v240, v240, v242
  v_cvt_pk_bf16_f32 v240, v240, v240
  v_and_b32 v240, 0xffff0000, v240
  s_nop 0
  v_readlane_b32 s8, v240, 0
  v_readlane_b32 s9, v240, 1
  v_readlane_b32 s10, v240, 2
  v_readlane_b32 s11, v240, 3
  v_readlane_b32 s52, v240, 16
  v_readlane_b32 s53, v240, 17
  v_readlane_b32 s54, v240, 18
  v_readlane_b32 s55, v240, 19
  v_mov_b32 v40, s8
  v_mov_b32 v41, s9
  v_mov_b32 v42, s10
  v_mov_b32 v43, s11
  v_readlane_b32 s50, v240, s58
u_have:
  s_waitcnt vmcnt(7)
  v_lshlrev_b32 v148, 16, v8
  v_and_b32 v149, 0xffff0000, v8
  v_lshlrev_b32 v150, 16, v9
  v_and_b32 v151, 0xffff0000, v9
  v_lshlrev_b32 v152, 16, v10
  v_and_b32 v153, 0xffff0000, v10
  v_lshlrev_b32 v154, 16, v11
  v_and_b32 v155, 0xffff0000, v11
  s_waitcnt vmcnt(6)
  v_pk_fma_f32 v[148:149], v[148:149], v[24:25], v[24:25] op_sel:[0,0,1] op_sel_hi:[1,0,1]
  v_pk_fma_f32 v[150:151], v[150:151], v[24:25], v[24:25] op_sel:[0,0,1] op_sel_hi:[1,0,1]
  v_pk_fma_f32 v[152:153], v[152:153], v[26:27], v[26:27] op_sel:[0,0,1] op_sel_hi:[1,0,1]
  v_pk_fma_f32 v[154:155], v[154:155], v[26:27], v[26:27] op_sel:[0,0,1] op_sel_hi:[1,0,1]
  s_waitcnt vmcnt(5)
  v_lshlrev_b32 v156, 16, v12
  v_and_b32 v157, 0xffff0000, v12
  v_lshlrev_b32 v158, 16, v13
  v_and_b32 v159, 0xffff0000, v13
  v_lshlrev_b32 v160, 16, v14
  v_and_b32 v161, 0xffff0000, v14
  v_lshlrev_b32 v162, 16, v15
  v_and_b32 v163, 0xffff0000, v15
  s_waitcnt vmcnt(4)
  v_pk_fma_f32 v[156:157], v[156:157], v[28:29], v[28:29] op_sel:[0,0,1] op_sel_hi:[1,0,1]
  v_pk_fma_f32 v[158:159], v[158:159], v[28:29], v[28:29] op_sel:[0,0,1] op_sel_hi:[1,0,1]
  v_pk_fma_f32 v[160:161], v[160:161], v[30:31], v[30:31] op_sel:[0,0,1] op_sel_hi:[1,0,1]
  v_pk_fma_f32 v[162:163], v[162:163], v[30:31], v[30:31] op_sel:[0,0,1] op_sel_hi:[1,0,1]
  s_waitcnt vmcnt(3)
  v_lshlrev_b32 v164, 16, v16
  v_and_b32 v165, 0xffff0000, v16
  v_lshlrev_b32 v166, 16, v17
  v_and_b32 v167, 0xffff0000, v17
  v_lshlrev_b32 v168, 16, v18
  v_and_b32 v169, 0xffff0000, v18
  v_lshlrev_b32 v170, 16, v19
  v_and_b32 v171, 0xffff0000, v19
  s_waitcnt vmcnt(2)
  v_pk_fma_f32 v[164:165], v[164:165], v[32:33], v[32:33] op_sel:[0,0,1] op_sel_hi:[1,0,1]
  v_pk_fma_f32 v[166:167], v[166:167], v[32:33], v[32:33] op_sel:[0,0,1] op_sel_hi:[1,0,1]
  v_pk_fma_f32 v[168:169], v[168:169], v[34:35], v[34:35] op_sel:[0,0,1] op_sel_hi:[1,0,1]
  v_pk_fma_f32 v[170:171], v[170:171], v[34:35], v[34:35] op_sel:[0,0,1] op_sel_hi:[1,0,1]
  s_waitcnt vmcnt(1)
  v_lshlrev_b32 v172, 16, v20
  v_and_b32 v173, 0xffff0000, v20
  v_lshlrev_b32 v174, 16, v21
  v_and_b32 v175, 0xffff0000, v21
  v_lshlrev_b32 v176, 16, v22
  v_and_b32 v177, 0xffff0000, v22
  v_lshlrev_b32 v178, 16, v23
  v_and_b32 v179, 0xffff0000, v23
  s_waitcnt vmcnt(0)
  v_pk_fma_f32 v[172:173], v[172:173], v[36:37], v[36:37] op_sel:[0,0,1] op_sel_hi:[1,0,1]
  v_pk_fma_f32 v[174:175], v[174:175], v[36:37], v[36:37] op_sel:[0,0,1] op_sel_hi:[1,0,1]
  v_pk_fma_f32 v[176:177], v[176:177], v[38:39], v[38:39] op_sel:[0,0,1] op_sel_hi:[1,0,1]
  v_pk_fma_f32 v[178:179], v[178:179], v[38:39], v[38:39] op_sel:[0,0,1] op_sel_hi:[1,0,1]
  v_pk_fma_f32 v[148:149], v[148:149], s[52:53], v[40:41]
  v_pk_fma_f32 v[152:153], v[152:153], s[52:53], v[40:41]
  v_pk_fma_f32 v[156:157], v[156:157], s[52:53], v[40:41]
  v_pk_fma_f32 v[160:161], v[160:161], s[52:53], v[40:41]
  v_pk_fma_f32 v[164:165], v[164:165], s[52:53], v[40:41]
  v_pk_fma_f32 v[168:169], v[168:169], s[52:53], v[40:41]
  v_pk_fma_f32 v[172:173], v[172:173], s[52:53], v[40:41]
  v_pk_fma_f32 v[176:177], v[176:177], s[52:53], v[40:41]
  v_cvt_pk_bf16_f32 v84, v148, v152
  v_cvt_pk_bf16_f32 v85, v156, v160
  v_cvt_pk_bf16_f32 v86, v164, v168
  v_cvt_pk_bf16_f32 v87, v172, v176
  ds_write_b128 v105, v[84:87] offset:512
  v_cvt_pk_bf16_f32 v88, v149, v153
  v_cvt_pk_bf16_f32 v89, v157, v161
  v_cvt_pk_bf16_f32 v90, v165, v169
  v_cvt_pk_bf16_f32 v91, v173, v177
  ds_write_b128 v105, v[88:91] offset:5120
  v_pk_fma_f32 v[150:151], v[150:151], s[54:55], v[42:43]
  v_pk_fma_f32 v[154:155], v[154:155], s[54:55], v[42:43]
  v_pk_fma_f32 v[158:159], v[158:159], s[54:55], v[42:43]
  v_pk_fma_f32 v[162:163], v[162:163], s[54:55], v[42:43]
  v_pk_fma_f32 v[166:167], v[166:167], s[54:55], v[42:43]
  v_pk_fma_f32 v[170:171], v[170:171], s[54:55], v[42:43]
  v_pk_fma_f32 v[174:175], v[174:175], s[54:55], v[42:43]
  v_pk_fma_f32 v[178:179], v[178:179], s[54:55], v[42:43]
  v_cvt_pk_bf16_f32 v92, v150, v154
  v_cvt_pk_bf16_f32 v93, v158, v162
  v_cvt_pk_bf16_f32 v94, v166, v170
  v_cvt_pk_bf16_f32 v95, v174, v178
  ds_write_b128 v105, v[92:95] offset:9728
  v_cvt_pk_bf16_f32 v96, v151, v155
  v_cvt_pk_bf16_f32 v97, v159, v163
  v_cvt_pk_bf16_f32 v98, v167, v171
  v_cvt_pk_bf16_f32 v99, v175, v179
  ds_write_b128 v105, v[96:99] offset:14336
  s_waitcnt lgkmcnt(0)
  s_barrier
  ds_read_b128 a[216:219], v100 offset:480
  ds_read_b128 a[220:223], v100 offset:464
  ds_read_b128 a[224:227], v100 offset:992
  v_perm_b32 v24, v10, v8, s14
  v_perm_b32 v25, v14, v12, s14
  v_perm_b32 v26, v18, v16, s14
  v_perm_b32 v27, v22, v20, s14
  v_perm_b32 v28, v10, v8, s15
  v_perm_b32 v29, v14, v12, s15
  v_perm_b32 v30, v18, v16, s15
  v_perm_b32 v31, v22, v20, s15
  v_perm_b32 v32, v11, v9, s14
  v_perm_b32 v33, v15, v13, s14
  v_perm_b32 v34, v19, v17, s14
  v_perm_b32 v35, v23, v21, s14
  v_perm_b32 v36, v11, v9, s15
  v_perm_b32 v37, v15, v13, s15
  v_perm_b32 v38, v19, v17, s15
  v_perm_b32 v39, v23, v21, s15
  s_waitcnt lgkmcnt(2)
  v_mfma_f32_16x16x32_bf16 v[212:215], a[216:219], v[52:55], 0
  v_mfma_f32_16x16x32_bf16 v[216:219], a[216:219], v[48:51], 0
  v_mfma_f32_16x16x32_bf16 v[220:223], a[216:219], v[60:63], 0
  ds_read_b128 a[228:231], v100 offset:976
  s_lshl_b32 s7, s20, 11
  s_add_u32 m0, s7, 155648
  s_nop 0
  global_load_lds_dwordx4 v111, s[38:39]
  s_waitcnt lgkmcnt(2)
  v_mfma_f32_16x16x32_bf16 v[208:211], a[220:223], v[48:51], 0
  ds_read_b128 a[232:235], v100 offset:1504
  v_mfma_f32_16x16x32_bf16 v[112:115], a[112:115], a[216:219], 0
  ds_read_b128 a[236:239], v100 offset:2016
  v_mfma_f32_16x16x32_bf16 v[116:119], a[116:119], a[216:219], 0
  v_add_u32 v111, 19456, v111
  ds_read_b128 a[240:243], v100 offset:416
  v_mfma_f32_16x16x32_bf16 v[120:123], a[108:111], a[216:219], 0
  ds_read_b128 a[244:247], v100 offset:928
  v_cvt_pk_bf16_f32 v160, v208, v212
  s_waitcnt lgkmcnt(5)
  v_mfma_f32_16x16x32_bf16 v[236:239], a[224:227], v[52:55], 0
  ds_read_b128 a[248:251], v100 offset:1440
  v_cvt_pk_bf16_f32 v161, v216, v220
  v_mfma_f32_16x16x32_bf16 v[240:243], a[224:227], v[48:51], 0
  global_load_lds_dwordx4 v111, s[38:39] offset:1024
  v_cvt_pk_bf16_f32 v162, v209, v213
  v_mfma_f32_16x16x32_bf16 v[244:247], a[224:227], v[60:63], 0
  v_cvt_pk_bf16_f32 v163, v217, v221
  v_cvt_pk_bf16_f32 v164, v210, v214
  s_waitcnt lgkmcnt(5)
  v_mfma_f32_16x16x32_bf16 v[232:235], a[228:231], v[48:51], 0
  v_cvt_pk_bf16_f32 v165, v218, v222
  v_cvt_pk_bf16_f32 v166, v211, v215
  v_mfma_f32_16x16x32_bf16 v[116:119], a[112:115], a[224:227], v[116:119]
  v_cvt_pk_bf16_f32 v167, v219, v223
  ds_read_b128 a[252:255], v100 offset:1952
  v_mfma_f32_16x16x32_bf16 v[120:123], a[116:119], a[224:227], v[120:123]
  ds_read_b128 a[216:219], v100 offset:352
  v_mfma_f32_16x16x32_bf16 v[124:127], a[108:111], a[224:227], 0
  ds_read_b128 a[220:223], v100 offset:864
  v_cvt_pk_bf16_f32 v168, v232, v236
  s_waitcnt lgkmcnt(5)
  v_mfma_f32_16x16x32_bf16 v[120:123], a[112:115], a[232:235], v[120:123]
  v_cvt_pk_bf16_f32 v169, v240, v244
  v_cvt_pk_bf16_f32 v170, v233, v237
  v_mfma_f32_16x16x32_bf16 v[124:127], a[116:119], a[232:235], v[124:127]
  v_cvt_pk_bf16_f32 v171, v241, v245
  v_cvt_pk_bf16_f32 v172, v234, v238
  v_mfma_f32_16x16x32_bf16 v[124:127], a[112:115], a[236:239], v[124:127]
  v_cvt_pk_bf16_f32 v173, v242, v246
  v_cvt_pk_bf16_f32 v174, v235, v239
  v_mfma_f32_16x16x32_bf16 v[128:131], a[116:119], a[236:239], 0
  v_cvt_pk_bf16_f32 v175, v243, v247
  ds_read_b128 a[224:227], v100 offset:1376
  v_mfma_f32_16x16x32_bf16 v[112:115], a[120:123], a[240:243], v[112:115]
  ds_read_b128 a[228:231], v100 offset:1888
  v_mfma_f32_16x16x32_bf16 v[116:119], a[124:127], a[240:243], v[116:119]
  ds_write_b128 v105, v[24:27] offset:18432
  s_waitcnt lgkmcnt(5)
  v_mfma_f32_16x16x32_bf16 v[116:119], a[120:123], a[244:247], v[116:119]
  v_mfma_f32_16x16x32_bf16 v[120:123], a[124:127], a[244:247], v[120:123]
  v_mfma_f32_16x16x32_bf16 v[120:123], a[120:123], a[248:251], v[120:123]
  ds_write_b128 v105, v[28:31] offset:22592
  v_mfma_f32_16x16x32_bf16 v[124:127], a[124:127], a[248:251], v[124:127]
  v_mfma_f32_16x16x32_bf16 v[124:127], a[120:123], a[252:255], v[124:127]
  v_mfma_f32_16x16x32_bf16 v[128:131], a[124:127], a[252:255], v[128:131]
  ds_write_b128 v105, v[32:35] offset:26752
  v_mfma_f32_16x16x32_bf16 v[120:123], v[160:163], a[176:179], v[120:123]
  ds_write_b128 v105, v[36:39] offset:30912
  s_waitcnt lgkmcnt(5)
  v_mfma_f32_16x16x32_bf16 v[112:115], a[128:131], a[216:219], v[112:115]
  v_mfma_f32_16x16x32_bf16 v[116:119], a[132:135], a[216:219], v[116:119]
  ds_read_b128 a[232:235], v100 offset:288
  v_mfma_f32_16x16x32_bf16 v[116:119], a[128:131], a[220:223], v[116:119]
  v_mfma_f32_16x16x32_bf16 v[120:123], a[132:135], a[220:223], v[120:123]
  ds_read_b128 a[236:239], v100 offset:800
  v_mfma_f32_16x16x32_bf16 v[120:123], a[128:131], a[224:227], v[120:123]
  v_mfma_f32_16x16x32_bf16 v[124:127], a[132:135], a[224:227], v[124:127]
  ds_read_b128 a[240:243], v100 offset:1312
  s_waitcnt lgkmcnt(5)
  v_mfma_f32_16x16x32_bf16 v[124:127], a[128:131], a[228:231], v[124:127]
  v_mfma_f32_16x16x32_bf16 v[128:131], a[132:135], a[228:231], v[128:131]
  ds_read_b128 a[244:247], v100 offset:1824
  v_mfma_f32_16x16x32_bf16 v[124:127], v[160:163], a[184:187], v[124:127]
  ds_read_b128 a[248:251], v100 offset:224
  s_waitcnt lgkmcnt(4)
  v_mfma_f32_16x16x32_bf16 v[112:115], a[136:139], a[232:235], v[112:115]
  ds_read_b128 a[252:255], v100 offset:736
  v_mfma_f32_16x16x32_bf16 v[116:119], a[140:143], a[232:235], v[116:119]
  ds_read_b128 a[216:219], v100 offset:1248
  s_waitcnt lgkmcnt(5)
  v_mfma_f32_16x16x32_bf16 v[116:119], a[136:139], a[236:239], v[116:119]
  s_waitcnt lgkmcnt(7)
  s_barrier
  v_mfma_f32_16x16x32_bf16 v[120:123], a[140:143], a[236:239], v[120:123]
  ds_read_b128 a[220:223], v100 offset:1760
  s_waitcnt lgkmcnt(5)
  v_mfma_f32_16x16x32_bf16 v[120:123], a[136:139], a[240:243], v[120:123]
  ds_read_b128 a[224:227], v100 offset:160
  v_mfma_f32_16x16x32_bf16 v[124:127], a[140:143], a[240:243], v[124:127]
  ds_read2_b32 a[152:153], v101 offset0:176 offset1:177
  s_waitcnt lgkmcnt(6)
  v_mfma_f32_16x16x32_bf16 v[124:127], a[136:139], a[244:247], v[124:127]
  ds_read2_b32 a[154:155], v101 offset0:178 offset1:179
  v_mfma_f32_16x16x32_bf16 v[128:131], a[140:143], a[244:247], v[128:131]
  ds_read2_b32 a[156:157], v101 offset0:48 offset1:49
  v_mfma_f32_16x16x32_bf16 v[120:123], v[164:167], a[180:183], v[120:123]
  ds_read2_b32 a[158:159], v101 offset0:50 offset1:51
  s_waitcnt lgkmcnt(8)
  v_mfma_f32_16x16x32_bf16 v[112:115], a[144:147], a[248:251], v[112:115]
  ds_read_b128 a[228:231], v100 offset:672
  v_mfma_f32_16x16x32_bf16 v[116:119], a[148:151], a[248:251], v[116:119]
  ds_read_b128 a[232:235], v100 offset:1184
  s_waitcnt lgkmcnt(8)
  v_mfma_f32_16x16x32_bf16 v[116:119], a[144:147], a[252:255], v[116:119]
  ds_read_b128 a[236:239], v100 offset:1696
  v_mfma_f32_16x16x32_bf16 v[120:123], a[148:151], a[252:255], v[120:123]
  ds_read_b64 v[8:9], v104 offset:0
  v_mfma_f32_16x16x32_bf16 v[120:123], a[144:147], a[216:219], v[120:123]
  ds_read_b64 v[10:11], v104 offset:512
  v_mfma_f32_16x16x32_bf16 v[124:127], a[148:151], a[216:219], v[124:127]
  ds_read_b64 v[12:13], v104 offset:1024
  s_waitcnt lgkmcnt(9)
  v_mfma_f32_16x16x32_bf16 v[124:127], a[144:147], a[220:223], v[124:127]
  ds_read_b64 v[14:15], v104 offset:1536
  v_mfma_f32_16x16x32_bf16 v[128:131], a[148:151], a[220:223], v[128:131]
  ds_read_b128 a[240:243], v100 offset:96
  v_mfma_f32_16x16x32_bf16 v[124:127], v[164:167], a[188:191], v[124:127]
  ds_read2_b32 a[160:161], v101 offset0:160 offset1:161
  s_waitcnt lgkmcnt(9)
  v_mfma_f32_16x16x32_bf16 v[112:115], a[152:155], a[224:227], v[112:115]
  ds_read2_b32 a[162:163], v101 offset0:162 offset1:163
  v_mfma_f32_16x16x32_bf16 v[116:119], a[156:159], a[224:227], v[116:119]
  ds_read2_b32 a[164:165], v101 offset0:32 offset1:33
  s_waitcnt lgkmcnt(9)
  v_mfma_f32_16x16x32_bf16 v[116:119], a[152:155], a[228:231], v[116:119]
  ds_read2_b32 a[166:167], v101 offset0:34 offset1:35
  s_waitcnt lgkmcnt(8)
  v_lshlrev_b32 v24, 16, v8
  v_mfma_f32_16x16x32_bf16 v[120:123], a[156:159], a[228:231], v[120:123]
  ds_read_b128 a[244:247], v100 offset:608
  v_and_b32 v25, 0xffff0000, v8
  v_mfma_f32_16x16x32_bf16 v[120:123], a[152:155], a[232:235], v[120:123]
  ds_read_b128 a[248:251], v100 offset:1120
  v_lshlrev_b32 v26, 16, v9
  v_mfma_f32_16x16x32_bf16 v[124:127], a[156:159], a[232:235], v[124:127]
  ds_read_b128 a[252:255], v100 offset:1632
  v_and_b32 v27, 0xffff0000, v9
  v_mfma_f32_16x16x32_bf16 v[124:127], a[152:155], a[236:239], v[124:127]
  ds_read_b128 a[216:219], v100 offset:32
  s_waitcnt lgkmcnt(8)
  v_lshlrev_b32 v28, 16, v10
  v_mfma_f32_16x16x32_bf16 v[128:131], a[156:159], a[236:239], v[128:131]
  ds_read2_b32 a[168:169], v101 offset0:144 offset1:145
  v_and_b32 v29, 0xffff0000, v10
  v_mfma_f32_16x16x32_bf16 v[124:127], v[168:171], a[176:179], v[124:127]
  ds_read2_b32 a[170:171], v101 offset0:146 offset1:147
  v_lshlrev_b32 v30, 16, v11
  s_waitcnt lgkmcnt(8)
  v_mfma_f32_16x16x32_bf16 v[112:115], a[160:163], a[240:243], v[112:115]
  ds_read2_b32 a[172:173], v101 offset0:16 offset1:17
  v_and_b32 v31, 0xffff0000, v11
  s_waitcnt lgkmcnt(7)
  v_mfma_f32_16x16x32_bf16 v[116:119], a[164:167], a[240:243], v[116:119]
  ds_read2_b32 a[174:175], v101 offset0:18 offset1:19
  v_lshlrev_b32 v32, 16, v12
  s_waitcnt lgkmcnt(7)
  v_mfma_f32_16x16x32_bf16 v[116:119], a[160:163], a[244:247], v[116:119]
  ds_read_b128 a[220:223], v100 offset:544
  v_and_b32 v33, 0xffff0000, v12
  v_mfma_f32_16x16x32_bf16 v[120:123], a[164:167], a[244:247], v[120:123]
  ds_read_b128 a[224:227], v100 offset:1056
  v_lshlrev_b32 v34, 16, v13
  s_waitcnt lgkmcnt(8)
  v_mfma_f32_16x16x32_bf16 v[120:123], a[160:163], a[248:251], v[120:123]
  ds_read_b128 a[228:231], v100 offset:1568
  v_and_b32 v35, 0xffff0000, v13
  v_mfma_f32_16x16x32_bf16 v[124:127], a[164:167], a[248:251], v[124:127]
warm4:
  s_cbranch_execz warm8
  ds_read_b128 a[232:235], v100 offset:2464
  v_lshlrev_b32 v36, 16, v14
  s_waitcnt lgkmcnt(8)
  v_mfma_f32_16x16x32_bf16 v[124:127], a[160:163], a[252:255], v[124:127]
  v_and_b32 v37, 0xffff0000, v14
  v_lshlrev_b32 v38, 16, v15
  v_mfma_f32_16x16x32_bf16 v[128:131], a[164:167], a[252:255], v[128:131]
  v_and_b32 v39, 0xffff0000, v15
  ds_read_b128 a[236:239], v100 offset:2976
  v_mfma_f32_16x16x32_bf16 v[124:127], v[172:175], a[180:183], v[124:127]
  ds_read_b128 a[240:243], v100 offset:3488
  s_waitcnt lgkmcnt(7)
  v_mfma_f32_16x16x32_bf16 v[112:115], a[168:171], a[216:219], v[112:115]
  ds_read_b128 a[244:247], v100 offset:4000
  s_waitcnt lgkmcnt(7)
  v_mfma_f32_16x16x32_bf16 v[116:119], a[172:175], a[216:219], v[116:119]
  ds_read_b128 a[248:251], v100 offset:2400
  s_waitcnt lgkmcnt(7)
  v_mfma_f32_16x16x32_bf16 v[116:119], a[168:171], a[220:223], v[116:119]
  s_mov_b64 exec, 0xfff
  global_load_dword v106, v110, s[22:23] sc1
  s_mov_b64 exec, -1
  v_mfma_f32_16x16x32_bf16 v[120:123], a[172:175], a[220:223], v[120:123]
  ds_read_b128 a[252:255], v100 offset:2912
  v_fma_f32 v112, v112, s50, v24
  s_waitcnt lgkmcnt(6)
  v_mfma_f32_16x16x32_bf16 v[120:123], a[168:171], a[224:227], v[120:123]
  ds_read_b128 a[216:219], v100 offset:3424
  v_fma_f32 v113, v113, s50, v25
  v_mfma_f32_16x16x32_bf16 v[124:127], a[172:175], a[224:227], v[124:127]
  ds_read_b128 a[220:223], v100 offset:3936
  v_fma_f32 v114, v114, s50, v26
  v_mfma_f32_16x16x32_bf16 v[124:127], a[168:171], a[228:231], v[124:127]
  ds_read_b128 a[224:227], v100 offset:3552
  v_fma_f32 v115, v115, s50, v27
  v_mfma_f32_16x16x32_bf16 v[128:131], a[172:175], a[228:231], v[128:131]
  v_cvt_pk_bf16_f32 v84, v112, v113
  v_cvt_pk_bf16_f32 v85, v114, v115
  s_waitcnt lgkmcnt(6)
  v_mfma_f32_16x16x32_bf16 v[128:131], a[120:123], a[232:235], v[128:131]
  ds_read_b128 a[228:231], v100 offset:4064
  v_fma_f32 v116, v116, s50, v28
  v_mfma_f32_16x16x32_bf16 v[132:135], a[124:127], a[232:235], 0
  v_fma_f32 v117, v117, s50, v29
  v_fma_f32 v118, v118, s50, v30
  v_mfma_f32_16x16x32_bf16 v[132:135], a[120:123], a[236:239], v[132:135]
  v_fma_f32 v119, v119, s50, v31
  v_cvt_pk_bf16_f32 v86, v116, v117
  v_mfma_f32_16x16x32_bf16 v[136:139], a[124:127], a[236:239], 0
  v_cvt_pk_bf16_f32 v87, v118, v119
  ds_read_b128 a[232:235], v100 offset:1504
  v_mfma_f32_16x16x32_bf16 v[136:139], a[120:123], a[240:243], v[136:139]
  v_permlane16_swap_b32 v84, v86
  v_mfma_f32_16x16x32_bf16 v[140:143], a[124:127], a[240:243], 0
  v_permlane16_swap_b32 v85, v87
  s_waitcnt lgkmcnt(3)
  v_mfma_f32_16x16x32_bf16 v[140:143], a[120:123], a[244:247], v[140:143]
  global_store_dwordx4 v107, v[84:87], s[22:23] sc1
  v_add_u32 v107, 655360, v107
  v_mfma_f32_16x16x32_bf16 v[128:131], a[128:131], a[248:251], v[128:131]
  v_fma_f32 v120, v120, s50, v32
  v_fma_f32 v121, v121, s50, v33
  v_mfma_f32_16x16x32_bf16 v[132:135], a[132:135], a[248:251], v[132:135]
  v_fma_f32 v122, v122, s50, v34
  v_fma_f32 v123, v123, s50, v35
  v_mfma_f32_16x16x32_bf16 v[132:135], a[128:131], a[252:255], v[132:135]
  v_cvt_pk_bf16_f32 v88, v120, v121
  v_cvt_pk_bf16_f32 v89, v122, v123
  v_mfma_f32_16x16x32_bf16 v[136:139], a[132:135], a[252:255], v[136:139]
  ds_read_b128 a[236:239], v100 offset:1488
  v_fma_f32 v124, v124, s50, v36
  v_mfma_f32_16x16x32_bf16 v[136:139], a[128:131], a[216:219], v[136:139]
  v_fma_f32 v125, v125, s50, v37
  v_fma_f32 v126, v126, s50, v38
  v_mfma_f32_16x16x32_bf16 v[140:143], a[132:135], a[216:219], v[140:143]
  v_fma_f32 v127, v127, s50, v39
  v_cvt_pk_bf16_f32 v90, v124, v125
  v_cvt_pk_bf16_f32 v91, v126, v127
  s_nop 0
  v_permlane16_swap_b32 v88, v90
  v_permlane16_swap_b32 v89, v91
  global_store_dwordx4 v107, v[88:91], s[22:23] sc1
  v_add_u32 v107, 655360, v107
  v_mfma_f32_16x16x32_bf16 v[140:143], a[128:131], a[220:223], v[140:143]
  ds_read_b128 a[240:243], v100 offset:2336
  s_waitcnt lgkmcnt(2)
  v_mfma_f32_16x16x32_bf16 v[136:139], a[112:115], a[224:227], v[136:139]
  ds_read_b128 a[244:247], v100 offset:2848
  v_mfma_f32_16x16x32_bf16 v[140:143], a[116:119], a[224:227], v[140:143]
  ds_read_b128 a[248:251], v100 offset:3360
  v_mfma_f32_16x16x32_bf16 v[140:143], a[112:115], a[228:231], v[140:143]
  ds_read_b128 a[252:255], v100 offset:3872
  v_mfma_f32_16x16x32_bf16 v[212:215], a[232:235], v[52:55], 0
  ds_read_b128 a[216:219], v100 offset:2016
  v_mfma_f32_16x16x32_bf16 v[216:219], a[232:235], v[48:51], 0
  ds_read_b128 a[220:223], v100 offset:2000
  v_mfma_f32_16x16x32_bf16 v[220:223], a[232:235], v[60:63], 0
  ds_read_b128 a[224:227], v100 offset:2272
  s_waitcnt lgkmcnt(7)
  v_mfma_f32_16x16x32_bf16 v[208:211], a[236:239], v[48:51], 0
  ds_read_b128 a[228:231], v100 offset:2784
  v_mfma_f32_16x16x32_bf16 v[224:227], a[236:239], v[64:67], 0
  ds_read_b64 v[16:17], v104 offset:2048
  v_mfma_f32_16x16x32_bf16 v[228:231], a[232:235], v[68:71], 0
  ds_read_b64 v[18:19], v104 offset:2560
  v_mfma_f32_16x16x32_bf16 v[128:131], a[108:111], a[232:235], v[128:131]
  ds_read_b64 v[20:21], v104 offset:3072
  v_mfma_f32_16x16x32_bf16 v[136:139], v[72:75], a[232:235], v[136:139]
  ds_read_b128 a[232:235], v100 offset:3296
  s_waitcnt lgkmcnt(9)
  v_mfma_f32_16x16x32_bf16 v[128:131], a[136:139], a[240:243], v[128:131]
  v_cvt_pk_bf16_f32 v176, v208, v212
  v_cvt_pk_bf16_f32 v177, v216, v220
  v_mfma_f32_16x16x32_bf16 v[132:135], a[140:143], a[240:243], v[132:135]
  v_cvt_pk_bf16_f32 v178, v209, v213
  v_cvt_pk_bf16_f32 v179, v217, v221
  v_mfma_f32_16x16x32_bf16 v[132:135], a[136:139], a[244:247], v[132:135]
  v_cvt_pk_bf16_f32 v180, v210, v214
  v_cvt_pk_bf16_f32 v181, v218, v222
  v_mfma_f32_16x16x32_bf16 v[136:139], a[140:143], a[244:247], v[136:139]
  v_cvt_pk_bf16_f32 v182, v211, v215
  v_cvt_pk_bf16_f32 v183, v219, v223
  v_mfma_f32_16x16x32_bf16 v[136:139], a[136:139], a[248:251], v[136:139]
  v_cvt_pk_bf16_f32 v152, v224, v228
  v_cvt_pk_bf16_f32 v153, v225, v229
  v_mfma_f32_16x16x32_bf16 v[140:143], a[140:143], a[248:251], v[140:143]
  s_waitcnt vmcnt(2)
  v_cmp_ne_u32 vcc, s65, v106
  s_nop 0
  s_and_b64 vcc, vcc, 0xfff
  s_cbranch_vccnz f_spinw
f_okw:
  s_waitcnt lgkmcnt(2)
  v_mfma_f32_16x16x32_bf16 v[140:143], a[136:139], a[252:255], v[140:143]
  global_load_dwordx4 a[0:3], v3, s[22:23] offset:-4096 sc1
  v_cvt_pk_bf16_f32 v154, v226, v230
  v_mfma_f32_16x16x32_bf16 v[236:239], a[216:219], v[52:55], 0
  v_cvt_pk_bf16_f32 v155, v227, v231
  ds_read_b128 a[236:239], v100 offset:3808
  v_mfma_f32_16x16x32_bf16 v[240:243], a[216:219], v[48:51], 0
  ds_read_b128 a[240:243], v100 offset:464
  v_bfe_u32 v2, v1, 2, 2
  v_mfma_f32_16x16x32_bf16 v[244:247], a[216:219], v[60:63], 0
  global_load_dwordx4 a[4:7], v3, s[22:23] offset:-3072 sc1
  ds_read_b128 a[244:247], v100 offset:480
  v_mfma_f32_16x16x32_bf16 v[232:235], a[220:223], v[48:51], 0
  ds_read_b128 a[248:251], v100 offset:2528
  v_lshrrev_b32 v4, 4, v1
  v_mfma_f32_16x16x32_bf16 v[248:251], a[220:223], v[64:67], 0
  ds_read_b128 a[252:255], v100 offset:2512
  v_lshl_add_u32 v2, v4, 3, v2
  v_mfma_f32_16x16x32_bf16 v[252:255], a[216:219], v[68:71], 0
  global_load_dwordx4 a[8:11], v3, s[22:23] offset:-2048 sc1
  v_and_b32 v4, 3, v1
  v_mfma_f32_16x16x32_bf16 v[132:135], a[108:111], a[216:219], v[132:135]
  s_waitcnt vmcnt(3)
  s_barrier
  s_cmp_lg_u32 s20, 0
  s_cbranch_scc1 f_nab0
  s_mov_b64 exec, 0xff
  global_store_dwordx4 v45, v[44:47], s[22:23] sc1
  s_mov_b64 exec, -1
f_nab0:
  v_mfma_f32_16x16x32_bf16 v[140:143], v[72:75], a[216:219], v[140:143]
  v_lshlrev_b32 v4, 3, v4
  v_lshl_add_u32 v2, v2, 6, v4
  v_mfma_f32_16x16x32_bf16 v[128:131], a[144:147], a[224:227], v[128:131]
  global_load_dwordx4 a[12:15], v3, s[22:23] offset:-1024 sc1
  s_lshl_b32 s7, s20, 11
  v_mfma_f32_16x16x32_bf16 v[132:135], a[148:151], a[224:227], v[132:135]
  s_add_u32 s7, s7, 155648
  v_add_u32 v2, s7, v2
  v_mfma_f32_16x16x32_bf16 v[132:135], a[144:147], a[228:231], v[132:135]
  ds_read_b64_tr_b16 v[76:77], v2 offset:0
  v_mfma_f32_16x16x32_bf16 v[136:139], a[148:151], a[228:231], v[136:139]
  ds_read_b64_tr_b16 v[78:79], v2 offset:256
  v_cvt_pk_bf16_f32 v184, v232, v236
  s_waitcnt lgkmcnt(3)
  v_mfma_f32_16x16x32_bf16 v[136:139], a[144:147], a[232:235], v[136:139]
  global_load_dwordx4 a[16:19], v3, s[22:23] offset:0 sc1
  ds_read_b64_tr_b16 v[80:81], v2 offset:32
  v_mfma_f32_16x16x32_bf16 v[140:143], a[148:151], a[232:235], v[140:143]
  ds_read_b64_tr_b16 v[82:83], v2 offset:288
  v_lshl_add_u32 v2, v1, 4, s59
  v_mfma_f32_16x16x32_bf16 v[140:143], a[144:147], a[236:239], v[140:143]
  v_lshl_add_u32 v4, v1, 4, s51
  ds_read_b128 a[216:219], v100 offset:2208
  v_mfma_f32_16x16x32_bf16 v[224:227], a[240:243], v[64:67], 0
  v_cvt_pk_bf16_f32 v185, v240, v244
  v_cvt_pk_bf16_f32 v186, v233, v237
  v_mfma_f32_16x16x32_bf16 v[228:231], a[244:247], v[68:71], 0
  s_cmp_lg_u32 s20, 0
  s_cbranch_scc1 f_nahe
  s_mov_b64 exec, 1
  global_store_dword v46, v44, s[22:23]
  s_mov_b64 exec, -1
f_nahe:
  v_mfma_f32_16x16x32_bf16 v[128:131], v[72:75], a[244:247], v[128:131]
  v_cvt_pk_bf16_f32 v187, v241, v245
  v_cvt_pk_bf16_f32 v188, v234, v238
  v_cvt_pk_bf16_f32 v189, v242, v246
  v_cvt_pk_bf16_f32 v190, v235, v239
  v_cvt_pk_bf16_f32 v191, v243, v247
  v_cvt_pk_bf16_f32 v156, v248, v252
  v_cvt_pk_bf16_f32 v157, v249, v253
  v_cvt_pk_bf16_f32 v158, v250, v254
  v_cvt_pk_bf16_f32 v159, v251, v255
  global_load_dwordx4 a[20:23], v3, s[22:23] offset:1024 sc1
  v_mfma_f32_16x16x32_bf16 v[236:239], a[248:251], v[52:55], 0
  ds_read_b128 a[220:223], v100 offset:2720
  global_load_dwordx4 a[24:27], v3, s[22:23] offset:2048 sc1
  v_mfma_f32_16x16x32_bf16 v[240:243], a[248:251], v[48:51], 0
  ds_read_b128 a[224:227], v100 offset:3232
  v_cvt_pk_bf16_f32 v144, v224, v228
  v_mfma_f32_16x16x32_bf16 v[244:247], a[248:251], v[60:63], 0
  ds_read_b128 a[228:231], v100 offset:3744
  v_cvt_pk_bf16_f32 v145, v225, v229
  s_waitcnt lgkmcnt(4)
  v_mfma_f32_16x16x32_bf16 v[232:235], a[252:255], v[48:51], 0
  ds_read_b128 a[232:235], v100 offset:976
  v_cvt_pk_bf16_f32 v146, v226, v230
  v_mfma_f32_16x16x32_bf16 v[128:131], a[112:115], a[248:251], v[128:131]
  global_load_dwordx4 a[28:31], v3, s[22:23] offset:3072 sc1
  v_add_u32 v3, 8192, v3
  v_mfma_f32_16x16x32_bf16 v[132:135], a[116:119], a[248:251], v[132:135]
  ds_read_b128 a[236:239], v100 offset:992
  global_store_dwordx4 v2, v[76:79], s[22:23] sc1
  v_mfma_f32_16x16x32_bf16 v[136:139], a[108:111], a[248:251], v[136:139]
  ds_read_b128 a[240:243], v100 offset:3040
  v_cvt_pk_bf16_f32 v147, v227, v231
  s_waitcnt lgkmcnt(6)
  v_mfma_f32_16x16x32_bf16 v[128:131], a[152:155], a[216:219], v[128:131]
  global_load_dwordx4 a[32:35], v3, s[22:23] offset:-4096 sc1
  ds_read_b64 v[22:23], v104 offset:3584
  v_mfma_f32_16x16x32_bf16 v[132:135], a[156:159], a[216:219], v[132:135]
  ds_read_b128 a[244:247], v100 offset:3024
  v_cvt_pk_bf16_f32 v192, v232, v236
  s_waitcnt lgkmcnt(7)
  v_mfma_f32_16x16x32_bf16 v[132:135], a[152:155], a[220:223], v[132:135]
  global_store_dwordx4 v4, v[80:83], s[22:23] sc1
  v_cvt_pk_bf16_f32 v193, v240, v244
  v_mfma_f32_16x16x32_bf16 v[136:139], a[156:159], a[220:223], v[136:139]
  global_load_dwordx4 a[36:39], v3, s[22:23] offset:-3072 sc1
  v_cvt_pk_bf16_f32 v194, v233, v237
  s_waitcnt lgkmcnt(5)
  v_mfma_f32_16x16x32_bf16 v[136:139], a[152:155], a[224:227], v[136:139]
  v_cvt_pk_bf16_f32 v195, v241, v245
  v_cvt_pk_bf16_f32 v196, v234, v238
  v_mfma_f32_16x16x32_bf16 v[140:143], a[156:159], a[224:227], v[140:143]
  v_cvt_pk_bf16_f32 v197, v242, v246
  v_cvt_pk_bf16_f32 v198, v235, v239
  v_mfma_f32_16x16x32_bf16 v[140:143], a[152:155], a[228:231], v[140:143]
  v_cvt_pk_bf16_f32 v199, v243, v247
  global_load_dwordx4 a[40:43], v3, s[22:23] offset:-2048 sc1
  s_waitcnt lgkmcnt(3)
  v_mfma_f32_16x16x32_bf16 v[224:227], a[232:235], v[64:67], 0
  ds_read_b128 a[248:251], v100 offset:2144
  v_mfma_f32_16x16x32_bf16 v[228:231], a[236:239], v[68:71], 0
  ds_read_b128 a[252:255], v100 offset:2656
  v_mfma_f32_16x16x32_bf16 v[132:135], v[72:75], a[236:239], v[132:135]
  ds_read_b128 a[216:219], v100 offset:3168
  s_waitcnt lgkmcnt(3)
  v_mfma_f32_16x16x32_bf16 v[236:239], a[240:243], v[52:55], 0
  global_load_dwordx4 a[44:47], v3, s[22:23] offset:-1024 sc1
  ds_read_b128 a[220:223], v100 offset:3680
  v_mfma_f32_16x16x32_bf16 v[240:243], a[240:243], v[48:51], 0
  ds_read_b128 a[224:227], v100 offset:2080
  v_cvt_pk_bf16_f32 v148, v224, v228
  v_mfma_f32_16x16x32_bf16 v[244:247], a[240:243], v[60:63], 0
  ds_read_b128 a[228:231], v100 offset:2592
  v_cvt_pk_bf16_f32 v149, v225, v229
  v_mfma_f32_16x16x32_bf16 v[232:235], a[244:247], v[48:51], 0
  global_load_dwordx4 a[48:51], v3, s[22:23] offset:0 sc1
  ds_read_b128 a[232:235], v100 offset:3104
  v_mfma_f32_16x16x32_bf16 v[132:135], a[112:115], a[240:243], v[132:135]
  v_cvt_pk_bf16_f32 v150, v226, v230
  v_cvt_pk_bf16_f32 v151, v227, v231
  v_mfma_f32_16x16x32_bf16 v[136:139], a[116:119], a[240:243], v[136:139]
  ds_read_b128 a[236:239], v100 offset:3616
  v_lshlrev_b32 v24, 16, v16
  v_mfma_f32_16x16x32_bf16 v[140:143], a[108:111], a[240:243], v[140:143]
  global_load_dwordx4 a[52:55], v3, s[22:23] offset:1024 sc1
  ds_read_b64 a[192:193], v102 offset:2312
  s_waitcnt lgkmcnt(7)
  v_mfma_f32_16x16x32_bf16 v[128:131], a[160:163], a[248:251], v[128:131]
  ds_read_b64 a[194:195], v102 offset:2320
  v_cvt_pk_bf16_f32 v200, v232, v236
  v_mfma_f32_16x16x32_bf16 v[132:135], a[164:167], a[248:251], v[132:135]
  ds_read_b64 a[196:197], v102 offset:2328
  v_cvt_pk_bf16_f32 v201, v240, v244
  v_mfma_f32_16x16x32_bf16 v[132:135], a[160:163], a[252:255], v[132:135]
  ds_read_b64 a[198:199], v102 offset:2336
  v_cvt_pk_bf16_f32 v202, v233, v237
  v_mfma_f32_16x16x32_bf16 v[136:139], a[164:167], a[252:255], v[136:139]
  global_load_dwordx4 a[56:59], v3, s[22:23] offset:2048 sc1
  v_cvt_pk_bf16_f32 v203, v241, v245
  s_waitcnt lgkmcnt(6)
  v_mfma_f32_16x16x32_bf16 v[136:139], a[160:163], a[216:219], v[136:139]
  v_cvt_pk_bf16_f32 v204, v234, v238
  v_cvt_pk_bf16_f32 v205, v242, v246
  v_mfma_f32_16x16x32_bf16 v[140:143], a[164:167], a[216:219], v[140:143]
  v_cvt_pk_bf16_f32 v206, v235, v239
  v_cvt_pk_bf16_f32 v207, v243, v247
  v_mfma_f32_16x16x32_bf16 v[140:143], a[160:163], a[220:223], v[140:143]
  global_load_dwordx4 a[60:63], v3, s[22:23] offset:3072 sc1
  v_add_u32 v3, 8192, v3
  v_mfma_f32_16x16x32_bf16 v[128:131], a[168:171], a[224:227], v[128:131]
  ds_read2_b32 a[200:201], v103 offset0:48 offset1:49
  v_and_b32 v25, 0xffff0000, v16
  v_mfma_f32_16x16x32_bf16 v[132:135], a[172:175], a[224:227], v[132:135]
  ds_read2_b32 a[202:203], v103 offset0:50 offset1:51
  v_lshlrev_b32 v26, 16, v17
  v_mfma_f32_16x16x32_bf16 v[132:135], a[168:171], a[228:231], v[132:135]
  global_load_dwordx4 a[64:67], v3, s[22:23] offset:-4096 sc1
  ds_read2_b32 a[204:205], v103 offset0:32 offset1:33
  v_mfma_f32_16x16x32_bf16 v[136:139], a[172:175], a[228:231], v[136:139]
  ds_read2_b32 a[206:207], v103 offset0:34 offset1:35
  v_and_b32 v27, 0xffff0000, v17
  s_waitcnt lgkmcnt(4)
  v_mfma_f32_16x16x32_bf16 v[136:139], a[168:171], a[232:235], v[136:139]
  v_lshlrev_b32 v28, 16, v18
  v_and_b32 v29, 0xffff0000, v18
  v_mfma_f32_16x16x32_bf16 v[140:143], a[172:175], a[232:235], v[140:143]
  v_lshlrev_b32 v30, 16, v19
  v_and_b32 v31, 0xffff0000, v19
  v_mfma_f32_16x16x32_bf16 v[140:143], a[168:171], a[236:239], v[140:143]
  global_load_dwordx4 a[68:71], v3, s[22:23] offset:-3072 sc1
  v_lshlrev_b32 v32, 16, v20
  v_mfma_f32_16x16x32_bf16 v[128:131], v[160:163], a[192:195], v[128:131]
  v_and_b32 v33, 0xffff0000, v20
  v_lshlrev_b32 v34, 16, v21
  v_mfma_f32_16x16x32_bf16 v[128:131], v[164:167], a[196:199], v[128:131]
  v_and_b32 v35, 0xffff0000, v21
  v_lshlrev_b32 v36, 16, v22
  v_mfma_f32_16x16x32_bf16 v[128:131], v[168:171], a[184:187], v[128:131]
  s_mov_b64 exec, 0xfffff
  global_load_dword v109, v108, s[22:23] sc1
  s_mov_b64 exec, -1
  v_mfma_f32_16x16x32_bf16 v[128:131], v[172:175], a[188:191], v[128:131]
  global_load_dwordx4 a[72:75], v3, s[22:23] offset:-2048 sc1
  v_and_b32 v37, 0xffff0000, v22
  v_mfma_f32_16x16x32_bf16 v[128:131], v[176:179], a[176:179], v[128:131]
  v_lshlrev_b32 v38, 16, v23
  v_and_b32 v39, 0xffff0000, v23
  v_mfma_f32_16x16x32_bf16 v[128:131], v[180:183], a[180:183], v[128:131]
  global_load_dwordx4 a[76:79], v3, s[22:23] offset:-1024 sc1
  ds_read2_b32 a[208:209], v103 offset0:16 offset1:17
  s_waitcnt lgkmcnt(1)
  v_mfma_f32_16x16x32_bf16 v[128:131], v[144:147], a[200:203], v[128:131]
  ds_read2_b32 a[210:211], v103 offset0:18 offset1:19
  v_mfma_f32_16x16x32_bf16 v[132:135], v[168:171], a[192:195], v[132:135]
  ds_read2_b32 a[212:213], v103 offset0:0 offset1:1
  v_mfma_f32_16x16x32_bf16 v[132:135], v[172:175], a[196:199], v[132:135]
  global_load_dwordx4 a[80:83], v3, s[22:23] offset:0 sc1
  ds_read2_b32 a[214:215], v103 offset0:2 offset1:3
  v_mfma_f32_16x16x32_bf16 v[132:135], v[176:179], a[184:187], v[132:135]
  s_nop 0
  v_fma_f32 v128, v128, s50, v24
  v_fma_f32 v129, v129, s50, v25
  v_mfma_f32_16x16x32_bf16 v[132:135], v[180:183], a[188:191], v[132:135]
  v_fma_f32 v130, v130, s50, v26
  v_fma_f32 v131, v131, s50, v27
  v_mfma_f32_16x16x32_bf16 v[132:135], v[184:187], a[176:179], v[132:135]
  v_cvt_pk_bf16_f32 v92, v128, v129
  v_cvt_pk_bf16_f32 v93, v130, v131
  v_mfma_f32_16x16x32_bf16 v[132:135], v[188:191], a[180:183], v[132:135]
  global_load_dwordx4 a[84:87], v3, s[22:23] offset:1024 sc1
  v_mfma_f32_16x16x32_bf16 v[132:135], v[144:147], a[204:207], v[132:135]
  v_mfma_f32_16x16x32_bf16 v[132:135], v[148:151], a[200:203], v[132:135]
  v_mfma_f32_16x16x32_bf16 v[136:139], v[176:179], a[192:195], v[136:139]
  global_load_dwordx4 a[88:91], v3, s[22:23] offset:2048 sc1
  v_mfma_f32_16x16x32_bf16 v[136:139], v[180:183], a[196:199], v[136:139]
  v_mfma_f32_16x16x32_bf16 v[136:139], v[184:187], a[184:187], v[136:139]
  s_nop 3
  v_fma_f32 v132, v132, s50, v28
  v_fma_f32 v133, v133, s50, v29
  v_mfma_f32_16x16x32_bf16 v[136:139], v[188:191], a[188:191], v[136:139]
  global_load_dwordx4 a[92:95], v3, s[22:23] offset:3072 sc1
  v_add_u32 v3, 8192, v3
  s_waitcnt lgkmcnt(0)
  v_mfma_f32_16x16x32_bf16 v[136:139], v[144:147], a[208:211], v[136:139]
  v_fma_f32 v134, v134, s50, v30
  v_fma_f32 v135, v135, s50, v31
  v_mfma_f32_16x16x32_bf16 v[136:139], v[148:151], a[204:207], v[136:139]
  v_cvt_pk_bf16_f32 v94, v132, v133
  v_cvt_pk_bf16_f32 v95, v134, v135
  v_mfma_f32_16x16x32_bf16 v[136:139], v[152:155], a[200:203], v[136:139]
  v_permlane16_swap_b32 v92, v94
  v_mfma_f32_16x16x32_bf16 v[136:139], v[192:195], a[176:179], v[136:139]
  global_load_dwordx4 a[96:99], v3, s[22:23] offset:-4096 sc1
  v_mfma_f32_16x16x32_bf16 v[136:139], v[196:199], a[180:183], v[136:139]
  v_permlane16_swap_b32 v93, v95
  v_mfma_f32_16x16x32_bf16 v[140:143], v[184:187], a[192:195], v[140:143]
  v_mfma_f32_16x16x32_bf16 v[140:143], v[188:191], a[196:199], v[140:143]
  global_load_dwordx4 a[100:103], v3, s[22:23] offset:-3072 sc1
  v_mfma_f32_16x16x32_bf16 v[140:143], v[144:147], a[212:215], v[140:143]
  s_nop 2
  v_fma_f32 v136, v136, s50, v32
  v_fma_f32 v137, v137, s50, v33
  v_mfma_f32_16x16x32_bf16 v[140:143], v[148:151], a[208:211], v[140:143]
  v_fma_f32 v138, v138, s50, v34
  v_fma_f32 v139, v139, s50, v35
  v_mfma_f32_16x16x32_bf16 v[140:143], v[152:155], a[204:207], v[140:143]
  global_load_dwordx4 a[104:107], v3, s[22:23] offset:-2048 sc1
  v_cvt_pk_bf16_f32 v96, v136, v137
  v_mfma_f32_16x16x32_bf16 v[140:143], v[156:159], a[200:203], v[140:143]
  v_cvt_pk_bf16_f32 v97, v138, v139
  v_mfma_f32_16x16x32_bf16 v[140:143], v[192:195], a[184:187], v[140:143]
  v_mfma_f32_16x16x32_bf16 v[140:143], v[196:199], a[188:191], v[140:143]
  v_mfma_f32_16x16x32_bf16 v[140:143], v[200:203], a[176:179], v[140:143]
  v_mfma_f32_16x16x32_bf16 v[140:143], v[204:207], a[180:183], v[140:143]
  s_nop 7
  v_fma_f32 v140, v140, s50, v36
  v_fma_f32 v141, v141, s50, v37
  v_fma_f32 v142, v142, s50, v38
  v_fma_f32 v143, v143, s50, v39
  v_cvt_pk_bf16_f32 v98, v140, v141
  v_cvt_pk_bf16_f32 v99, v142, v143
  s_nop 0
  v_permlane16_swap_b32 v96, v98
  v_permlane16_swap_b32 v97, v99
  s_waitcnt vmcnt(9)
  v_cmp_ne_u32 vcc, s65, v109
  s_nop 0
  s_and_b64 vcc, vcc, 0xfffff
  s_cbranch_vccnz u_hint1
u_hint1_ok:
f_join:
  v_and_b32 v6, 15, v1
  v_lshrrev_b32 v7, 4, v1
  v_lshrrev_b32 v21, 2, v1
  v_and_b32 v20, 3, v1
  v_lshl_add_u32 v20, v21, 4, v20
  s_lshl_b32 s4, s20, 2
  v_add_u32 v20, s4, v20
  s_mul_i32 s4, s60, 10
  s_sub_u32 s4, s4, 40
  v_min_u32 v21, 49, v1
  v_add_u32 v21, s4, v21
  v_cmp_gt_u32 vcc, 40, v1
  s_add_u32 s4, s100, 40960
  v_lshl_add_u32 v25, v20, 7, s4
  v_cndmask_b32 v20, v21, v20, vcc
  s_add_u32 s4, s100, 16384
  v_lshl_add_u32 v5, v20, 7, s4
  v_bfe_u32 v21, v20, 2, 2
  v_lshrrev_b32 v22, 4, v20
  v_lshl_add_u32 v21, v21, 4, v22
  v_and_b32 v20, 3, v20
  v_lshl_add_u32 v20, v21, 2, v20
  v_lshl_add_u32 v5, v20, 4, s4
  s_add_u32 s4, s100, 40960
  v_lshl_add_u32 v25, v0, 4, s4
  global_load_dword v24, v5, s[22:23] sc1
  global_load_dwordx4 a[108:111], v3, s[22:23] offset:-1024 sc1
  s_mul_i32 s4, s61, 81920
  s_lshl_b32 s30, s20, 11
  s_add_u32 s5, s4, s30
  s_add_u32 s5, s5, 12582912
  v_lshl_add_u32 v2, v1, 4, s5
  s_mov_b32 m0, s30
  v_bfe_u32 v20, v1, 2, 2
  v_lshl_add_u32 v21, v7, 3, v20
  v_lshlrev_b32 v21, 7, v21
  v_bfe_u32 v22, v1, 1, 1
  v_lshl_add_u32 v21, v22, 6, v21
  global_load_dwordx4 a[112:115], v3, s[22:23] offset:0 sc1
  v_and_b32 v22, 1, v1
  v_lshl_add_u32 v21, v22, 3, v21
  v_lshrrev_b32 v20, 1, v20
  v_and_b32 v22, 1, v7
  v_lshl_add_u32 v20, v22, 1, v20
  v_xor_b32 v22, 0, v20
  v_lshl_add_u32 v8, v22, 4, v21
  v_xor_b32 v22, 1, v20
  v_lshl_add_u32 v9, v22, 4, v21
  v_xor_b32 v22, 2, v20
  v_lshl_add_u32 v10, v22, 4, v21
  global_load_dwordx4 a[116:119], v3, s[22:23] offset:1024 sc1
  v_xor_b32 v22, 3, v20
  v_lshl_add_u32 v11, v22, 4, v21
  s_mul_i32 s6, s60, 5120
  s_add_u32 s5, s4, s6
  s_and_b32 s6, s20, 1
  s_lshl_b32 s6, s6, 6
  s_add_u32 s5, s5, s6
  s_add_u32 s5, s5, 12584960
  v_lshrrev_b32 v20, 3, v1
  v_lshl_add_u32 v20, v20, 7, s5
  v_and_b32 v21, 3, v1
  global_load_dwordx4 a[120:123], v3, s[22:23] offset:2048 sc1
  v_lshl_add_u32 v20, v21, 2, v20
  v_bfe_u32 v21, v1, 2, 1
  v_bfe_u32 v22, v1, 4, 1
  v_xor_b32 v21, v21, v22
  s_lshl_b32 s6, s60, 1
  s_xor_b32 s6, s6, s20
  s_and_b32 s6, s6, 2
  v_xor_b32 v21, s6, v21
  v_lshl_add_u32 v12, v21, 4, v20
  v_xor_b32 v21, 2, v21
  v_lshl_add_u32 v13, v21, 4, v20
  s_waitcnt vmcnt(4)
  v_cmp_ne_u32 vcc, s65, v24
  s_cbranch_vccnz f_spinb
f_okb:
  global_load_lds_dwordx4 v2, s[22:23] sc1
  global_load_lds_dwordx4 v2, s[22:23] offset:1024 sc1
  s_add_u32 m0, s30, 8192
  v_add_u32 v2, 8192, v2
  global_load_lds_dwordx4 v2, s[22:23] sc1
  global_load_lds_dwordx4 v2, s[22:23] offset:1024 sc1
  s_add_u32 m0, s30, 16384
  v_add_u32 v2, 8192, v2
  global_load_dword v248, v12, s[22:23] offset:-2048 sc1
  global_load_dword v249, v13, s[22:23] offset:-1024 sc1
  global_load_dword v250, v12, s[22:23] offset:0 sc1
  global_load_dword v251, v13, s[22:23] offset:1024 sc1
  global_load_dword v252, v12, s[22:23] offset:2048 sc1
  v_add_u32 v12, 1310720, v12
  v_add_u32 v13, 1310720, v13
  s_cmp_lg_u32 s49, 0
  s_cbranch_scc1 f_nodst
  global_store_dwordx4 v107, v[92:95], s[22:23] sc1
  v_add_u32 v107, 655360, v107
  global_store_dwordx4 v107, v[96:99], s[22:23] sc1
  s_branch f_dst
f_nodst:
  v_xor_b32 v209, s65, v209
  v_xor_b32 v211, s65, v211
  v_xor_b32 v213, s65, v213
  v_xor_b32 v215, s65, v215
  v_or3_b32 v209, v209, v211, v213
  v_or_b32 v209, v209, v215
  v_cmp_ne_u32 vcc, 0, v209
  s_cbranch_vccnz u_spins
u_oks:
  v_add_f32 v208, v208, v210
  v_add_f32 v212, v212, v214
  v_add_f32 v208, v208, v212
  v_cvt_pk_bf16_f32 v208, v208, v208
  ds_write_b16 v112, v208
  s_waitcnt lgkmcnt(0)
  s_barrier
  ds_read_b128 v[128:131], v113 offset:0
  ds_read_b128 v[132:135], v113 offset:64
  ds_read_b128 v[136:139], v113 offset:128
  ds_read_b128 v[140:143], v113 offset:192
  ds_read_b128 v[144:147], v113 offset:256
  s_waitcnt lgkmcnt(4)
  v_mfma_f32_16x16x32_bf16 v[192:195], v[128:131], v[66:69], 0
  v_mfma_f32_16x16x32_bf16 v[200:203], v[128:131], v[70:73], 0
  s_waitcnt lgkmcnt(3)
  v_mfma_f32_16x16x32_bf16 v[192:195], v[132:135], v[74:77], v[192:195]
  v_mfma_f32_16x16x32_bf16 v[200:203], v[132:135], v[78:81], v[200:203]
  s_waitcnt lgkmcnt(2)
  v_mfma_f32_16x16x32_bf16 v[192:195], v[136:139], v[82:85], v[192:195]
  v_mfma_f32_16x16x32_bf16 v[200:203], v[136:139], v[86:89], v[200:203]
  s_waitcnt lgkmcnt(1)
  v_mfma_f32_16x16x32_bf16 v[192:195], v[140:143], v[90:93], v[192:195]
  v_mfma_f32_16x16x32_bf16 v[200:203], v[140:143], v[94:97], v[200:203]
  s_waitcnt lgkmcnt(0)
  v_mfma_f32_16x16x32_bf16 v[192:195], v[144:147], v[98:101], v[192:195]
  v_mfma_f32_16x16x32_bf16 v[200:203], v[144:147], v[102:105], v[200:203]
  v_cvt_pk_bf16_f32 v204, v188, v188
  v_and_b32 v189, 0xffff0000, v204
  v_sub_f32 v188, v188, v189
  v_cvt_pk_bf16_f32 v205, v188, v188
  v_cvt_pk_bf16_f32 v208, v196, v196
  v_and_b32 v197, 0xffff0000, v208
  v_sub_f32 v196, v196, v197
  v_cvt_pk_bf16_f32 v209, v196, v196
  v_cvt_pk_bf16_f32 v206, v192, v192
  v_and_b32 v193, 0xffff0000, v206
  v_sub_f32 v192, v192, v193
  v_cvt_pk_bf16_f32 v207, v192, v192
  v_cvt_pk_bf16_f32 v210, v200, v200
  v_and_b32 v201, 0xffff0000, v210
  v_sub_f32 v200, v200, v201
  v_cvt_pk_bf16_f32 v211, v200, v200
  s_mov_b64 exec, 0xffff
  global_store_dwordx4 v114, v[204:207], s[22:23] sc1
  global_store_dwordx4 v115, v[208:211], s[22:23] sc1
  s_mov_b64 exec, -1
f_dst:
  global_load_lds_dwordx4 v2, s[22:23] sc1
  global_load_lds_dwordx4 v2, s[22:23] offset:1024 sc1
  s_add_u32 m0, s30, 24576
warm5:
  s_cbranch_execz warm9
  v_add_u32 v2, 8192, v2
  global_load_lds_dwordx4 v2, s[22:23] sc1
  global_load_lds_dwordx4 v2, s[22:23] offset:1024 sc1
  s_add_u32 m0, s30, 32768
  v_add_u32 v2, 8192, v2
  s_bfe_u32 s4, s63, 0x20002
  s_lshl_b32 s4, s4, 4
  s_lshr_b32 s5, s63, 4
  s_add_u32 s4, s4, s5
  s_lshl_b32 s4, s4, 2
  s_and_b32 s5, s63, 3
  s_add_u32 s4, s4, s5
  s_lshl_b32 s4, s4, 4
  s_add_u32 s4, s4, 4235264
  v_mul_u32_u24 v245, 73984, v1
  v_add_u32 v245, s4, v245
  v_mov_b32 v244, s65
  v_mov_b32 v19, s65
  s_lshl_b32 s5, s61, 14
  s_add_u32 s5, s5, 262144
  s_lshl_b32 s6, s60, 10
  s_add_u32 s6, s6, s5
  s_lshr_b32 s7, s20, 1
  s_lshl_b32 s7, s7, 8
  s_add_u32 s6, s6, s7
  s_and_b32 s7, s20, 1
  s_lshl_b32 s7, s7, 6
  s_add_u32 s6, s6, s7
  v_bfe_u32 v20, v1, 2, 1
  v_and_b32 v21, 3, v1
  v_lshlrev_b32 v20, 4, v20
  v_lshl_add_u32 v20, v21, 1, v20
  v_lshrrev_b32 v22, 5, v1
  v_add_u32 v20, v20, v22
  v_lshl_add_u32 v14, v20, 3, s6
  s_mov_b32 s36, 0xff
  s_mov_b32 s37, 0xff
  v_mov_b32 v5, v25
  s_waitcnt vmcnt(13)
  s_barrier
  ds_read_b64_tr_b16 v[128:129], v8 offset:0
  ds_read_b64_tr_b16 v[130:131], v8 offset:512
  ds_read_b64_tr_b16 v[132:133], v9 offset:0
  ds_read_b64_tr_b16 v[134:135], v9 offset:512
  ds_read_b64_tr_b16 v[136:137], v10 offset:0
  ds_read_b64_tr_b16 v[138:139], v10 offset:512
  ds_read_b64_tr_b16 v[140:141], v11 offset:0
  ds_read_b64_tr_b16 v[142:143], v11 offset:512
  ds_read_b64_tr_b16 v[144:145], v8 offset:4096
  ds_read_b64_tr_b16 v[146:147], v8 offset:4608
  ds_read_b64_tr_b16 v[148:149], v9 offset:4096
  ds_read_b64_tr_b16 v[150:151], v9 offset:4608
  ds_read_b64_tr_b16 v[152:153], v10 offset:4096
  ds_read_b64_tr_b16 v[154:155], v10 offset:4608
  ds_read_b64_tr_b16 v[156:157], v11 offset:4096
  ds_read_b64_tr_b16 v[158:159], v11 offset:4608
  s_waitcnt lgkmcnt(0)
  v_mfma_f32_16x16x32_bf16 v[32:35], a[0:3], v[128:131], 0
  s_waitcnt vmcnt(11)
  s_barrier
  v_mfma_f32_16x16x32_bf16 v[36:39], a[4:7], v[128:131], 0
  ds_read_b64_tr_b16 v[160:161], v8 offset:8192
  s_waitcnt vmcnt(10)
  v_lshlrev_b32 v254, 16, v248
  v_mfma_f32_16x16x32_bf16 v[40:43], a[8:11], v[128:131], 0
  ds_read_b64_tr_b16 v[162:163], v8 offset:8704
  global_load_lds_dwordx4 v2, s[22:23] sc1
  v_mfma_f32_16x16x32_bf16 v[52:55], a[8:11], v[132:135], 0
  ds_read_b64_tr_b16 v[164:165], v9 offset:8192
  v_and_b32 v255, 0xffff0000, v248
  v_mfma_f32_16x16x32_bf16 v[48:51], a[4:7], v[132:135], 0
  ds_read_b64_tr_b16 v[166:167], v9 offset:8704
  v_mov_b32 v20, v254
  v_mfma_f32_16x16x32_bf16 v[44:47], a[0:3], v[132:135], 0
  ds_read_b64_tr_b16 v[168:169], v10 offset:8192
  global_load_lds_dwordx4 v2, s[22:23] offset:1024 sc1
  s_add_u32 m0, s30, 40960
  v_add_u32 v2, 8192, v2
  v_mfma_f32_16x16x32_bf16 v[56:59], a[0:3], v[136:139], 0
  ds_read_b64_tr_b16 v[170:171], v10 offset:8704
  v_mul_f32 v21, v254, v254
  v_mfma_f32_16x16x32_bf16 v[60:63], a[4:7], v[136:139], 0
  ds_read_b64_tr_b16 v[172:173], v11 offset:8192
  v_mov_b32 v22, v255
  v_mfma_f32_16x16x32_bf16 v[64:67], a[8:11], v[136:139], 0
  ds_read_b64_tr_b16 v[174:175], v11 offset:8704
  global_load_lds_dwordx4 v2, s[22:23] sc1
  v_mfma_f32_16x16x32_bf16 v[76:79], a[8:11], v[140:143], 0
  ds_read_b64_tr_b16 v[176:177], v8 offset:12288
  v_mul_f32 v23, v255, v255
  v_mfma_f32_16x16x32_bf16 v[72:75], a[4:7], v[140:143], 0
  ds_read_b64_tr_b16 v[178:179], v8 offset:12800
  s_waitcnt vmcnt(12)
  v_lshlrev_b32 v254, 16, v249
  v_mfma_f32_16x16x32_bf16 v[68:71], a[0:3], v[140:143], 0
  ds_read_b64_tr_b16 v[180:181], v9 offset:12288
  global_load_lds_dwordx4 v2, s[22:23] offset:1024 sc1
  s_add_u32 m0, s30, 49152
  v_add_u32 v2, 8192, v2
  v_mfma_f32_16x16x32_bf16 v[32:35], a[12:15], v[144:147], v[32:35]
  ds_read_b64_tr_b16 v[182:183], v9 offset:12800
  v_and_b32 v255, 0xffff0000, v249
  v_mfma_f32_16x16x32_bf16 v[36:39], a[16:19], v[144:147], v[36:39]
  ds_read_b64_tr_b16 v[184:185], v10 offset:12288
  global_load_dwordx4 a[124:127], v3, s[22:23] offset:3072 sc1
  v_add_u32 v3, 8192, v3
  v_mfma_f32_16x16x32_bf16 v[40:43], a[20:23], v[144:147], v[40:43]
  ds_read_b64_tr_b16 v[186:187], v10 offset:12800
  v_add_f32 v20, v20, v254
  v_mfma_f32_16x16x32_bf16 v[52:55], a[20:23], v[148:151], v[52:55]
  ds_read_b64_tr_b16 v[188:189], v11 offset:12288
  v_fmac_f32 v21, v254, v254
  v_mfma_f32_16x16x32_bf16 v[48:51], a[16:19], v[148:151], v[48:51]
  ds_read_b64_tr_b16 v[190:191], v11 offset:12800
  global_load_dwordx4 a[128:131], v3, s[22:23] offset:-4096 sc1
  v_mfma_f32_16x16x32_bf16 v[44:47], a[12:15], v[148:151], v[44:47]
  v_add_f32 v22, v22, v255
  v_fmac_f32 v23, v255, v255
  v_mfma_f32_16x16x32_bf16 v[56:59], a[12:15], v[152:155], v[56:59]
  s_waitcnt vmcnt(14)
  v_lshlrev_b32 v254, 16, v250
  v_and_b32 v255, 0xffff0000, v250
  v_mfma_f32_16x16x32_bf16 v[60:63], a[16:19], v[152:155], v[60:63]
  global_load_dwordx4 a[132:135], v3, s[22:23] offset:-3072 sc1
  v_add_f32 v20, v20, v254
  v_mfma_f32_16x16x32_bf16 v[64:67], a[20:23], v[152:155], v[64:67]
  v_fmac_f32 v21, v254, v254
  v_add_f32 v22, v22, v255
  v_mfma_f32_16x16x32_bf16 v[76:79], a[20:23], v[156:159], v[76:79]
  v_fmac_f32 v23, v255, v255
  s_waitcnt vmcnt(14)
  v_lshlrev_b32 v254, 16, v251
  v_mfma_f32_16x16x32_bf16 v[72:75], a[16:19], v[156:159], v[72:75]
  global_load_dwordx4 a[136:139], v3, s[22:23] offset:-2048 sc1
  v_and_b32 v255, 0xffff0000, v251
  v_mfma_f32_16x16x32_bf16 v[68:71], a[12:15], v[156:159], v[68:71]
  v_add_f32 v20, v20, v254
  s_waitcnt lgkmcnt(0)
  v_mfma_f32_16x16x32_bf16 v[32:35], a[24:27], v[160:163], v[32:35]
  s_waitcnt vmcnt(12)
  s_waitcnt vmcnt(10)
  s_barrier
  s_cmp_lg_u32 s20, 0
  s_cbranch_scc1 f_nab1
  s_mov_b64 exec, 0xff
  global_store_dwordx4 v245, v[244:247], s[22:23] sc1
  s_mov_b64 exec, -1
f_nab1:
  v_mfma_f32_16x16x32_bf16 v[36:39], a[28:31], v[160:163], v[36:39]
  ds_read_b64_tr_b16 v[128:129], v8 offset:16384
  v_fmac_f32 v21, v254, v254
  v_mfma_f32_16x16x32_bf16 v[40:43], a[32:35], v[160:163], v[40:43]
  ds_read_b64_tr_b16 v[130:131], v8 offset:16896
  global_load_lds_dwordx4 v2, s[22:23] sc1
  v_mfma_f32_16x16x32_bf16 v[52:55], a[32:35], v[164:167], v[52:55]
  ds_read_b64_tr_b16 v[132:133], v9 offset:16384
  v_add_f32 v22, v22, v255
  v_mfma_f32_16x16x32_bf16 v[48:51], a[28:31], v[164:167], v[48:51]
  ds_read_b64_tr_b16 v[134:135], v9 offset:16896
  v_fmac_f32 v23, v255, v255
  v_mfma_f32_16x16x32_bf16 v[44:47], a[24:27], v[164:167], v[44:47]
  ds_read_b64_tr_b16 v[136:137], v10 offset:16384
  v_lshlrev_b32 v254, 16, v252
  v_mfma_f32_16x16x32_bf16 v[56:59], a[24:27], v[168:171], v[56:59]
  ds_read_b64_tr_b16 v[138:139], v10 offset:16896
  global_load_lds_dwordx4 v2, s[22:23] offset:1024 sc1
  s_add_u32 m0, s30, 57344
  v_add_u32 v2, 8192, v2
  v_mfma_f32_16x16x32_bf16 v[60:63], a[28:31], v[168:171], v[60:63]
  ds_read_b64_tr_b16 v[140:141], v11 offset:16384
  v_and_b32 v255, 0xffff0000, v252
  v_mfma_f32_16x16x32_bf16 v[64:67], a[32:35], v[168:171], v[64:67]
  ds_read_b64_tr_b16 v[142:143], v11 offset:16896
  v_add_f32 v20, v20, v254
  v_mfma_f32_16x16x32_bf16 v[76:79], a[32:35], v[172:175], v[76:79]
  ds_read_b64_tr_b16 v[144:145], v8 offset:20480
  v_fmac_f32 v21, v254, v254
  v_mfma_f32_16x16x32_bf16 v[72:75], a[28:31], v[172:175], v[72:75]
  ds_read_b64_tr_b16 v[146:147], v8 offset:20992
  global_load_dwordx4 a[140:143], v3, s[22:23] offset:-1024 sc1
  v_mfma_f32_16x16x32_bf16 v[68:71], a[24:27], v[172:175], v[68:71]
  ds_read_b64_tr_b16 v[148:149], v9 offset:20480
  v_add_f32 v22, v22, v255
  v_mfma_f32_16x16x32_bf16 v[32:35], a[36:39], v[176:179], v[32:35]
  ds_read_b64_tr_b16 v[150:151], v9 offset:20992
  v_fmac_f32 v23, v255, v255
  v_mfma_f32_16x16x32_bf16 v[36:39], a[40:43], v[176:179], v[36:39]
  ds_read_b64_tr_b16 v[152:153], v10 offset:20480
  v_permlane32_swap_b32 v20, v22
  v_mfma_f32_16x16x32_bf16 v[40:43], a[44:47], v[176:179], v[40:43]
  ds_read_b64_tr_b16 v[154:155], v10 offset:20992
  global_load_dwordx4 a[144:147], v3, s[22:23] offset:0 sc1
  v_mfma_f32_16x16x32_bf16 v[52:55], a[44:47], v[180:183], v[52:55]
  ds_read_b64_tr_b16 v[156:157], v11 offset:20480
  v_permlane32_swap_b32 v21, v23
  v_mfma_f32_16x16x32_bf16 v[48:51], a[40:43], v[180:183], v[48:51]
  ds_read_b64_tr_b16 v[158:159], v11 offset:20992
  v_add_f32 v20, v20, v22
  v_mfma_f32_16x16x32_bf16 v[44:47], a[36:39], v[180:183], v[44:47]
  v_add_f32 v21, v21, v23
  v_add_f32_dpp v20, v20, v20 row_ror:8 row_mask:0xf bank_mask:0xf
  v_mfma_f32_16x16x32_bf16 v[56:59], a[36:39], v[184:187], v[56:59]
  global_load_dwordx4 a[148:151], v3, s[22:23] offset:1024 sc1
  v_add_f32_dpp v21, v21, v21 row_ror:8 row_mask:0xf bank_mask:0xf
  v_mfma_f32_16x16x32_bf16 v[60:63], a[40:43], v[184:187], v[60:63]
  v_mov_b32 v22, v20
  v_mov_b32 v23, v21
  v_mfma_f32_16x16x32_bf16 v[64:67], a[44:47], v[184:187], v[64:67]
  v_permlane16_swap_b32 v20, v22
  v_mfma_f32_16x16x32_bf16 v[76:79], a[44:47], v[188:191], v[76:79]
  v_permlane16_swap_b32 v21, v23
  v_mfma_f32_16x16x32_bf16 v[72:75], a[40:43], v[188:191], v[72:75]
  global_load_dwordx4 a[152:155], v3, s[22:23] offset:2048 sc1
  v_add_f32 v20, v20, v22
  v_mfma_f32_16x16x32_bf16 v[68:71], a[36:39], v[188:191], v[68:71]
  v_add_f32 v21, v21, v23
  s_waitcnt lgkmcnt(0)
  v_mfma_f32_16x16x32_bf16 v[32:35], a[48:51], v[128:131], v[32:35]
  s_waitcnt vmcnt(14)
  s_barrier
  v_mfma_f32_16x16x32_bf16 v[36:39], a[52:55], v[128:131], v[36:39]
  ds_read_b64_tr_b16 v[160:161], v8 offset:24576
  s_mov_b64 exec, s[36:37]
  global_store_dwordx2 v14, v[20:21], s[22:23] offset:0 sc1
  s_mov_b64 exec, -1
  v_mfma_f32_16x16x32_bf16 v[40:43], a[56:59], v[128:131], v[40:43]
  ds_read_b64_tr_b16 v[162:163], v8 offset:25088
  global_load_lds_dwordx4 v2, s[22:23] sc1
  v_mfma_f32_16x16x32_bf16 v[52:55], a[56:59], v[132:135], v[52:55]
  ds_read_b64_tr_b16 v[164:165], v9 offset:24576
  v_lshrrev_b32 v22, 5, v1
  v_mfma_f32_16x16x32_bf16 v[48:51], a[52:55], v[132:135], v[48:51]
  ds_read_b64_tr_b16 v[166:167], v9 offset:25088
  s_lshl_b32 s6, s20, 7
  v_mfma_f32_16x16x32_bf16 v[44:47], a[48:51], v[132:135], v[44:47]
  ds_read_b64_tr_b16 v[168:169], v10 offset:24576
  s_add_u32 s5, s5, s6
  v_mfma_f32_16x16x32_bf16 v[56:59], a[48:51], v[136:139], v[56:59]
  ds_read_b64_tr_b16 v[170:171], v10 offset:25088
  global_load_lds_dwordx4 v2, s[22:23] offset:1024 sc1
  s_add_u32 m0, s30, 65536
  v_add_u32 v2, 8192, v2
  v_mfma_f32_16x16x32_bf16 v[60:63], a[52:55], v[136:139], v[60:63]
  ds_read_b64_tr_b16 v[172:173], v11 offset:24576
  v_lshrrev_b32 v20, 3, v1
  v_mfma_f32_16x16x32_bf16 v[64:67], a[56:59], v[136:139], v[64:67]
  ds_read_b64_tr_b16 v[174:175], v11 offset:25088
  v_lshlrev_b32 v20, 11, v20
  v_mfma_f32_16x16x32_bf16 v[76:79], a[56:59], v[140:143], v[76:79]
  ds_read_b64_tr_b16 v[176:177], v8 offset:28672
  v_and_b32 v21, 7, v1
  v_mfma_f32_16x16x32_bf16 v[72:75], a[52:55], v[140:143], v[72:75]
  ds_read_b64_tr_b16 v[178:179], v8 offset:29184
  global_load_dwordx4 a[156:159], v3, s[22:23] offset:3072 sc1
  v_add_u32 v3, 8192, v3
  v_mfma_f32_16x16x32_bf16 v[68:71], a[48:51], v[140:143], v[68:71]
  ds_read_b64_tr_b16 v[180:181], v9 offset:28672
  v_lshl_add_u32 v20, v21, 4, v20
  v_mfma_f32_16x16x32_bf16 v[32:35], a[60:63], v[144:147], v[32:35]
  ds_read_b64_tr_b16 v[182:183], v9 offset:29184
  v_add_u32 v15, s5, v20
  v_mfma_f32_16x16x32_bf16 v[36:39], a[64:67], v[144:147], v[36:39]
  ds_read_b64_tr_b16 v[184:185], v10 offset:28672
  v_lshl_add_u32 v20, v21, 1, v22
  v_mfma_f32_16x16x32_bf16 v[40:43], a[68:71], v[144:147], v[40:43]
  ds_read_b64_tr_b16 v[186:187], v10 offset:29184
  global_load_dwordx4 a[160:163], v3, s[22:23] offset:-4096 sc1
  v_mfma_f32_16x16x32_bf16 v[52:55], a[68:71], v[148:151], v[52:55]
  ds_read_b64_tr_b16 v[188:189], v11 offset:28672
  s_lshl_b32 s6, s20, 9
  v_mfma_f32_16x16x32_bf16 v[48:51], a[64:67], v[148:151], v[48:51]
  ds_read_b64_tr_b16 v[190:191], v11 offset:29184
  v_lshl_add_u32 v16, v20, 5, s6
  v_mfma_f32_16x16x32_bf16 v[44:47], a[60:63], v[148:151], v[44:47]
  v_lshlrev_b32 v17, 5, v6
  s_mul_i32 s5, s61, 393216
  v_mfma_f32_16x16x32_bf16 v[56:59], a[60:63], v[152:155], v[56:59]
  global_load_dwordx4 a[164:167], v3, s[22:23] offset:-3072 sc1
  s_mul_i32 s6, s62, 3072
  v_mfma_f32_16x16x32_bf16 v[60:63], a[64:67], v[152:155], v[60:63]
  s_add_u32 s5, s5, s6
  s_add_u32 s5, s5, 16777216
  v_mfma_f32_16x16x32_bf16 v[64:67], a[68:71], v[152:155], v[64:67]
  v_lshl_add_u32 v4, v1, 4, s5
  s_lshl_b32 s5, s61, 4
  v_mfma_f32_16x16x32_bf16 v[76:79], a[68:71], v[156:159], v[76:79]
  s_add_u32 s5, s5, s60
  s_lshl_b32 s5, s5, 8
  v_mfma_f32_16x16x32_bf16 v[72:75], a[64:67], v[156:159], v[72:75]
  global_load_dwordx4 a[168:171], v3, s[22:23] offset:-2048 sc1
  s_add_u32 s5, s5, 589824
  v_mfma_f32_16x16x32_bf16 v[68:71], a[60:63], v[156:159], v[68:71]
  v_lshl_add_u32 v18, v1, 2, s5
  s_waitcnt lgkmcnt(0)
  v_mfma_f32_16x16x32_bf16 v[32:35], a[72:75], v[160:163], v[32:35]
  s_waitcnt vmcnt(19)
  s_barrier
  v_mfma_f32_16x16x32_bf16 v[36:39], a[76:79], v[160:163], v[36:39]
  ds_read_b64_tr_b16 v[128:129], v8 offset:32768
  s_lshr_b32 s4, s60, 3
  v_mfma_f32_16x16x32_bf16 v[40:43], a[80:83], v[160:163], v[40:43]
  ds_read_b64_tr_b16 v[130:131], v8 offset:33280
  global_load_lds_dwordx4 v2, s[22:23] sc1
  v_mfma_f32_16x16x32_bf16 v[52:55], a[80:83], v[164:167], v[52:55]
  ds_read_b64_tr_b16 v[132:133], v9 offset:32768
  s_lshl_b32 s4, s4, 2
  v_mfma_f32_16x16x32_bf16 v[48:51], a[76:79], v[164:167], v[48:51]
  ds_read_b64_tr_b16 v[134:135], v9 offset:33280
  s_and_b32 s32, s60, 3
  v_mfma_f32_16x16x32_bf16 v[44:47], a[72:75], v[164:167], v[44:47]
  ds_read_b64_tr_b16 v[136:137], v10 offset:32768
  s_add_u32 s32, s32, s4
  v_mfma_f32_16x16x32_bf16 v[56:59], a[72:75], v[168:171], v[56:59]
  ds_read_b64_tr_b16 v[138:139], v10 offset:33280
  global_load_lds_dwordx4 v2, s[22:23] offset:1024 sc1
  s_add_u32 m0, s30, 73728
  v_add_u32 v2, 8192, v2
  v_mfma_f32_16x16x32_bf16 v[60:63], a[76:79], v[168:171], v[60:63]
  ds_read_b64_tr_b16 v[140:141], v11 offset:32768
  s_bfe_u32 s4, s60, 65538
  v_mfma_f32_16x16x32_bf16 v[64:67], a[80:83], v[168:171], v[64:67]
  ds_read_b64_tr_b16 v[142:143], v11 offset:33280
  s_lshl_b32 s33, s61, 1
  v_mfma_f32_16x16x32_bf16 v[76:79], a[80:83], v[172:175], v[76:79]
  ds_read_b64_tr_b16 v[144:145], v8 offset:36864
  s_add_u32 s33, s33, s4
  v_mfma_f32_16x16x32_bf16 v[72:75], a[76:79], v[172:175], v[72:75]
  ds_read_b64_tr_b16 v[146:147], v8 offset:37376
  global_load_dwordx4 a[172:175], v3, s[22:23] offset:-1024 sc1
  v_mfma_f32_16x16x32_bf16 v[68:71], a[72:75], v[172:175], v[68:71]
  ds_read_b64_tr_b16 v[148:149], v9 offset:36864
  s_min_u32 s5, s32, 1
  v_mfma_f32_16x16x32_bf16 v[32:35], a[84:87], v[176:179], v[32:35]
  ds_read_b64_tr_b16 v[150:151], v9 offset:37376
  s_xor_b32 s5, s5, 1
  v_mfma_f32_16x16x32_bf16 v[36:39], a[88:91], v[176:179], v[36:39]
  ds_read_b64_tr_b16 v[152:153], v10 offset:36864
  s_lshl_b32 s5, s5, 14
  v_mfma_f32_16x16x32_bf16 v[40:43], a[92:95], v[176:179], v[40:43]
  ds_read_b64_tr_b16 v[154:155], v10 offset:37376
  global_load_dwordx4 a[176:179], v3, s[22:23] offset:0 sc1
  v_mfma_f32_16x16x32_bf16 v[52:55], a[92:95], v[180:183], v[52:55]
  ds_read_b64_tr_b16 v[156:157], v11 offset:36864
  v_add_u32 v16, s5, v16
  v_mfma_f32_16x16x32_bf16 v[48:51], a[88:91], v[180:183], v[48:51]
  ds_read_b64_tr_b16 v[158:159], v11 offset:37376
  v_add_u32 v17, s5, v17
  v_mfma_f32_16x16x32_bf16 v[44:47], a[84:87], v[180:183], v[44:47]
  s_add_u32 s5, s5, 4294832128
  s_lshl_b32 s4, s4, 1
  v_mfma_f32_16x16x32_bf16 v[56:59], a[84:87], v[184:187], v[56:59]
  global_load_dwordx4 a[180:183], v3, s[22:23] offset:1024 sc1
  s_and_b32 s5, s20, 1
  v_mfma_f32_16x16x32_bf16 v[60:63], a[88:91], v[184:187], v[60:63]
  s_add_u32 s16, s4, s5
  v_bfe_u32 v20, v1, 3, 1
  v_mfma_f32_16x16x32_bf16 v[64:67], a[92:95], v[184:187], v[64:67]
  v_lshrrev_b32 v21, 5, v1
  v_lshl_add_u32 v20, v21, 1, v20
  v_mfma_f32_16x16x32_bf16 v[76:79], a[92:95], v[188:191], v[76:79]
  v_xor_b32 v20, s16, v20
  v_bfe_u32 v21, v1, 1, 1
  v_mfma_f32_16x16x32_bf16 v[72:75], a[88:91], v[188:191], v[72:75]
  global_load_dwordx4 a[184:187], v3, s[22:23] offset:2048 sc1
  v_lshl_add_u32 v20, v21, 2, v20
  v_mfma_f32_16x16x32_bf16 v[68:71], a[84:87], v[188:191], v[68:71]
  v_lshlrev_b32 v20, 4, v20
  s_waitcnt lgkmcnt(0)
  v_mfma_f32_16x16x32_bf16 v[32:35], a[96:99], v[128:131], v[32:35]
  s_waitcnt vmcnt(23)
  s_barrier
  v_mfma_f32_16x16x32_bf16 v[36:39], a[100:103], v[128:131], v[36:39]
  ds_read_b64_tr_b16 v[160:161], v8 offset:40960
  v_and_b32 v21, 1, v1
  v_mfma_f32_16x16x32_bf16 v[40:43], a[104:107], v[128:131], v[40:43]
  ds_read_b64_tr_b16 v[162:163], v8 offset:41472
  global_load_lds_dwordx4 v2, s[22:23] sc1
  v_mfma_f32_16x16x32_bf16 v[52:55], a[104:107], v[132:135], v[52:55]
  ds_read_b64_tr_b16 v[164:165], v9 offset:40960
  v_lshl_add_u32 v20, v21, 3, v20
  v_mfma_f32_16x16x32_bf16 v[48:51], a[100:103], v[132:135], v[48:51]
  ds_read_b64_tr_b16 v[166:167], v9 offset:41472
  v_lshrrev_b32 v21, 2, v1
  v_mfma_f32_16x16x32_bf16 v[44:47], a[96:99], v[132:135], v[44:47]
  ds_read_b64_tr_b16 v[168:169], v10 offset:40960
  v_lshl_add_u32 v20, v21, 7, v20
  v_mfma_f32_16x16x32_bf16 v[56:59], a[96:99], v[136:139], v[56:59]
  ds_read_b64_tr_b16 v[170:171], v10 offset:41472
  global_load_lds_dwordx4 v2, s[22:23] offset:1024 sc1
  s_add_u32 m0, s30, 81920
  v_add_u32 v2, 1236992, v2
  v_mfma_f32_16x16x32_bf16 v[60:63], a[100:103], v[136:139], v[60:63]
  ds_read_b64_tr_b16 v[172:173], v11 offset:40960
  s_lshr_b32 s4, s20, 1
  v_mfma_f32_16x16x32_bf16 v[64:67], a[104:107], v[136:139], v[64:67]
  ds_read_b64_tr_b16 v[174:175], v11 offset:41472
  s_mul_i32 s4, s4, 81920
  v_mfma_f32_16x16x32_bf16 v[76:79], a[104:107], v[140:143], v[76:79]
  ds_read_b64_tr_b16 v[176:177], v8 offset:45056
  s_mul_i32 s5, s32, 10240
  v_mfma_f32_16x16x32_bf16 v[72:75], a[100:103], v[140:143], v[72:75]
  ds_read_b64_tr_b16 v[178:179], v8 offset:45568
  global_load_dwordx4 a[188:191], v3, s[22:23] offset:3072 sc1
  v_add_u32 v3, 8192, v3
  v_mfma_f32_16x16x32_bf16 v[68:71], a[96:99], v[140:143], v[68:71]
  ds_read_b64_tr_b16 v[180:181], v9 offset:45056
  s_add_u32 s4, s4, s5
  v_mfma_f32_16x16x32_bf16 v[32:35], a[108:111], v[144:147], v[32:35]
  ds_read_b64_tr_b16 v[182:183], v9 offset:45568
  v_add_u32 v31, s4, v20
  v_mfma_f32_16x16x32_bf16 v[36:39], a[112:115], v[144:147], v[36:39]
  ds_read_b64_tr_b16 v[184:185], v10 offset:45056
  s_lshl_b32 s34, s32, 2
  v_mfma_f32_16x16x32_bf16 v[40:43], a[116:119], v[144:147], v[40:43]
  ds_read_b64_tr_b16 v[186:187], v10 offset:45568
  global_load_dwordx4 a[192:195], v3, s[22:23] offset:-4096 sc1
  v_mfma_f32_16x16x32_bf16 v[52:55], a[116:119], v[148:151], v[52:55]
  ds_read_b64_tr_b16 v[188:189], v11 offset:45056
  s_add_u32 s34, s34, s20
  v_mfma_f32_16x16x32_bf16 v[48:51], a[112:115], v[148:151], v[48:51]
  ds_read_b64_tr_b16 v[190:191], v11 offset:45568
  s_mul_i32 s34, s34, 61440
  v_mfma_f32_16x16x32_bf16 v[44:47], a[108:111], v[148:151], v[44:47]
  s_add_u32 s34, s34, 6295552
  s_lshr_b32 s35, s33, 1
  v_mfma_f32_16x16x32_bf16 v[56:59], a[108:111], v[152:155], v[56:59]
  global_load_dwordx4 a[196:199], v3, s[22:23] offset:-3072 sc1
  s_lshl_b32 s4, s35, 4
  v_mfma_f32_16x16x32_bf16 v[60:63], a[112:115], v[152:155], v[60:63]
  s_lshl_b32 s5, s20, 2
  s_add_u32 s4, s4, s5
  v_mfma_f32_16x16x32_bf16 v[64:67], a[116:119], v[152:155], v[64:67]
  s_lshl_b32 s4, s4, 8
  s_add_u32 s4, s4, 589824
  v_mfma_f32_16x16x32_bf16 v[76:79], a[116:119], v[156:159], v[76:79]
  v_and_b32 v20, 3, v1
  v_lshl_add_u32 v30, v20, 8, s4
  v_mfma_f32_16x16x32_bf16 v[72:75], a[112:115], v[156:159], v[72:75]
  global_load_dwordx4 a[200:203], v3, s[22:23] offset:-2048 sc1
  v_lshlrev_b32 v20, 10, v7
  v_mfma_f32_16x16x32_bf16 v[68:71], a[108:111], v[156:159], v[68:71]
  v_lshl_add_u32 v20, v6, 4, v20
  s_waitcnt lgkmcnt(0)
  v_mfma_f32_16x16x32_bf16 v[32:35], a[120:123], v[160:163], v[32:35]
  s_waitcnt vmcnt(23)
  s_barrier
  v_mfma_f32_16x16x32_bf16 v[36:39], a[124:127], v[160:163], v[36:39]
  ds_read_b64_tr_b16 v[128:129], v8 offset:49152
  s_mul_i32 s4, s35, 393216
  v_mfma_f32_16x16x32_bf16 v[40:43], a[128:131], v[160:163], v[40:43]
  ds_read_b64_tr_b16 v[130:131], v8 offset:49664
  s_mul_i32 s5, s20, 49152
  v_mfma_f32_16x16x32_bf16 v[52:55], a[128:131], v[164:167], v[52:55]
  ds_read_b64_tr_b16 v[132:133], v9 offset:49152
  global_load_dword v24, v5, s[22:23] sc1
  v_mfma_f32_16x16x32_bf16 v[48:51], a[124:127], v[164:167], v[48:51]
  ds_read_b64_tr_b16 v[134:135], v9 offset:49664
  s_add_u32 s4, s4, s5
  v_mfma_f32_16x16x32_bf16 v[44:47], a[120:123], v[164:167], v[44:47]
  ds_read_b64_tr_b16 v[136:137], v10 offset:49152
  s_and_b32 s5, s33, 1
  v_mfma_f32_16x16x32_bf16 v[56:59], a[120:123], v[168:171], v[56:59]
  ds_read_b64_tr_b16 v[138:139], v10 offset:49664
  s_lshl_b32 s5, s5, 9
  v_mfma_f32_16x16x32_bf16 v[60:63], a[124:127], v[168:171], v[60:63]
  ds_read_b64_tr_b16 v[140:141], v11 offset:49152
  global_load_dwordx4 a[204:207], v3, s[22:23] offset:-1024 sc1
  v_mfma_f32_16x16x32_bf16 v[64:67], a[128:131], v[168:171], v[64:67]
  ds_read_b64_tr_b16 v[142:143], v11 offset:49664
  s_add_u32 s4, s4, s5
  v_mfma_f32_16x16x32_bf16 v[76:79], a[128:131], v[172:175], v[76:79]
  ds_read_b64_tr_b16 v[144:145], v8 offset:53248
  s_add_u32 s4, s4, 16781312
  v_mfma_f32_16x16x32_bf16 v[72:75], a[124:127], v[172:175], v[72:75]
  ds_read_b64_tr_b16 v[146:147], v8 offset:53760
  s_and_b32 s5, s20, 1
  v_mfma_f32_16x16x32_bf16 v[68:71], a[120:123], v[172:175], v[68:71]
  ds_read_b64_tr_b16 v[148:149], v9 offset:53248
  s_lshl_b32 s5, s5, 8
  v_mfma_f32_16x16x32_bf16 v[32:35], a[132:135], v[176:179], v[32:35]
  ds_read_b64_tr_b16 v[150:151], v9 offset:53760
  global_load_dwordx4 a[208:211], v3, s[22:23] offset:0 sc1
  v_mfma_f32_16x16x32_bf16 v[36:39], a[136:139], v[176:179], v[36:39]
  ds_read_b64_tr_b16 v[152:153], v10 offset:53248
  s_xor_b32 s6, s5, 256
  s_waitcnt vmcnt(25)
  v_mfma_f32_16x16x32_bf16 v[40:43], a[140:143], v[176:179], v[40:43]
  ds_read_b64_tr_b16 v[154:155], v10 offset:53760
  s_add_u32 s6, s6, s4
  v_mfma_f32_16x16x32_bf16 v[52:55], a[140:143], v[180:183], v[52:55]
  ds_read_b64_tr_b16 v[156:157], v11 offset:53248
  s_add_u32 s5, s5, s4
  v_mfma_f32_16x16x32_bf16 v[48:51], a[136:139], v[180:183], v[48:51]
  ds_read_b64_tr_b16 v[158:159], v11 offset:53760
  v_add_u32 v26, s6, v20
  v_mfma_f32_16x16x32_bf16 v[44:47], a[132:135], v[180:183], v[44:47]
  global_load_dwordx4 a[212:215], v3, s[22:23] offset:1024 sc1
  v_add_u32 v27, s5, v20
  v_mfma_f32_16x16x32_bf16 v[56:59], a[132:135], v[184:187], v[56:59]
  v_add_u32 v28, 196608, v26
  v_add_u32 v29, 196608, v27
  v_mfma_f32_16x16x32_bf16 v[60:63], a[136:139], v[184:187], v[60:63]
  v_mfma_f32_16x16x32_bf16 v[64:67], a[140:143], v[184:187], v[64:67]
  v_mfma_f32_16x16x32_bf16 v[76:79], a[140:143], v[188:191], v[76:79]
  global_load_dwordx4 a[216:219], v3, s[22:23] offset:2048 sc1
  v_mfma_f32_16x16x32_bf16 v[72:75], a[136:139], v[188:191], v[72:75]
  v_mfma_f32_16x16x32_bf16 v[68:71], a[132:135], v[188:191], v[68:71]
  s_waitcnt lgkmcnt(0)
  s_waitcnt vmcnt(26)
  v_mfma_f32_16x16x32_bf16 v[32:35], a[144:147], v[128:131], v[32:35]
  s_waitcnt vmcnt(21)
  s_barrier
  v_mfma_f32_16x16x32_bf16 v[36:39], a[148:151], v[128:131], v[36:39]
  ds_read_b64_tr_b16 v[160:161], v8 offset:57344
  v_mfma_f32_16x16x32_bf16 v[40:43], a[152:155], v[128:131], v[40:43]
  ds_read_b64_tr_b16 v[162:163], v8 offset:57856
  global_load_dwordx4 a[220:223], v3, s[22:23] offset:3072 sc1
  v_add_u32 v3, 8192, v3
  v_mfma_f32_16x16x32_bf16 v[52:55], a[152:155], v[132:135], v[52:55]
  ds_read_b64_tr_b16 v[164:165], v9 offset:57344
  v_mfma_f32_16x16x32_bf16 v[48:51], a[148:151], v[132:135], v[48:51]
  ds_read_b64_tr_b16 v[166:167], v9 offset:57856
  v_mfma_f32_16x16x32_bf16 v[44:47], a[144:147], v[132:135], v[44:47]
  ds_read_b64_tr_b16 v[168:169], v10 offset:57344
  v_mfma_f32_16x16x32_bf16 v[56:59], a[144:147], v[136:139], v[56:59]
  ds_read_b64_tr_b16 v[170:171], v10 offset:57856
  global_load_dwordx4 a[224:227], v3, s[22:23] offset:-4096 sc1
  v_mfma_f32_16x16x32_bf16 v[60:63], a[148:151], v[136:139], v[60:63]
  ds_read_b64_tr_b16 v[172:173], v11 offset:57344
  v_mfma_f32_16x16x32_bf16 v[64:67], a[152:155], v[136:139], v[64:67]
  ds_read_b64_tr_b16 v[174:175], v11 offset:57856
  v_mfma_f32_16x16x32_bf16 v[76:79], a[152:155], v[140:143], v[76:79]
  ds_read_b64_tr_b16 v[176:177], v8 offset:61440
  v_mfma_f32_16x16x32_bf16 v[72:75], a[148:151], v[140:143], v[72:75]
  ds_read_b64_tr_b16 v[178:179], v8 offset:61952
  global_load_dwordx4 a[228:231], v3, s[22:23] offset:-3072 sc1
  v_mfma_f32_16x16x32_bf16 v[68:71], a[144:147], v[140:143], v[68:71]
  ds_read_b64_tr_b16 v[180:181], v9 offset:61440
  s_waitcnt vmcnt(23)
  v_mfma_f32_16x16x32_bf16 v[32:35], a[156:159], v[144:147], v[32:35]
  ds_read_b64_tr_b16 v[182:183], v9 offset:61952
  s_waitcnt vmcnt(22)
  v_mfma_f32_16x16x32_bf16 v[36:39], a[160:163], v[144:147], v[36:39]
  ds_read_b64_tr_b16 v[184:185], v10 offset:61440
  s_waitcnt vmcnt(21)
  v_mfma_f32_16x16x32_bf16 v[40:43], a[164:167], v[144:147], v[40:43]
  ds_read_b64_tr_b16 v[186:187], v10 offset:61952
  global_load_dwordx4 a[232:235], v3, s[22:23] offset:-2048 sc1
  v_mfma_f32_16x16x32_bf16 v[52:55], a[164:167], v[148:151], v[52:55]
  ds_read_b64_tr_b16 v[188:189], v11 offset:61440
  v_mfma_f32_16x16x32_bf16 v[48:51], a[160:163], v[148:151], v[48:51]
  ds_read_b64_tr_b16 v[190:191], v11 offset:61952
  v_mfma_f32_16x16x32_bf16 v[44:47], a[156:159], v[148:151], v[44:47]
  v_mfma_f32_16x16x32_bf16 v[56:59], a[156:159], v[152:155], v[56:59]
  global_load_dwordx4 v[224:227], v15, s[22:23] offset:0 sc1
  v_mfma_f32_16x16x32_bf16 v[60:63], a[160:163], v[152:155], v[60:63]
  v_mfma_f32_16x16x32_bf16 v[64:67], a[164:167], v[152:155], v[64:67]
  v_mfma_f32_16x16x32_bf16 v[76:79], a[164:167], v[156:159], v[76:79]
  v_mfma_f32_16x16x32_bf16 v[72:75], a[160:163], v[156:159], v[72:75]
  global_load_dwordx4 v[228:231], v15, s[22:23] offset:1024 sc1
  v_mfma_f32_16x16x32_bf16 v[68:71], a[156:159], v[156:159], v[68:71]
  v_add_u32 v8, 65536, v8
  v_add_u32 v9, 65536, v9
  v_add_u32 v10, 65536, v10
  v_add_u32 v11, 65536, v11
  s_waitcnt vmcnt(10)
  v_cmp_ne_u32 vcc, s65, v24
  s_cbranch_vccnz f_spinb1
f_okb1:
  s_waitcnt lgkmcnt(0)
  v_mfma_f32_16x16x32_bf16 v[32:35], a[168:171], v[160:163], v[32:35]
  s_barrier
  s_cmp_lg_u32 s2, 0
  s_cbranch_scc1 u_noepo
  v_mov_b32 v244, 589760
  s_mov_b64 exec, 1
  global_store_dword v244, v19, s[22:23] sc1
  s_mov_b64 exec, -1
u_noepo:
  v_mfma_f32_16x16x32_bf16 v[36:39], a[172:175], v[160:163], v[36:39]
  ds_read_b64_tr_b16 v[128:129], v8 offset:0
  v_mfma_f32_16x16x32_bf16 v[40:43], a[176:179], v[160:163], v[40:43]
  ds_read_b64_tr_b16 v[130:131], v8 offset:512
  global_load_lds_dwordx4 v2, s[22:23] sc1
  v_mfma_f32_16x16x32_bf16 v[52:55], a[176:179], v[164:167], v[52:55]
  ds_read_b64_tr_b16 v[132:133], v9 offset:0
  v_mfma_f32_16x16x32_bf16 v[48:51], a[172:175], v[164:167], v[48:51]
  ds_read_b64_tr_b16 v[134:135], v9 offset:512
  global_load_lds_dwordx4 v2, s[22:23] offset:1024 sc1
  s_add_u32 m0, s30, 90112
  v_add_u32 v2, 8192, v2
  v_mfma_f32_16x16x32_bf16 v[44:47], a[168:171], v[164:167], v[44:47]
  ds_read_b64_tr_b16 v[136:137], v10 offset:0
  v_mfma_f32_16x16x32_bf16 v[56:59], a[168:171], v[168:171], v[56:59]
  ds_read_b64_tr_b16 v[138:139], v10 offset:512
warm6:
  s_cbranch_execz warm_back
  global_load_lds_dwordx4 v2, s[22:23] sc1
  v_mfma_f32_16x16x32_bf16 v[60:63], a[172:175], v[168:171], v[60:63]
  ds_read_b64_tr_b16 v[140:141], v11 offset:0
  v_mfma_f32_16x16x32_bf16 v[64:67], a[176:179], v[168:171], v[64:67]
  ds_read_b64_tr_b16 v[142:143], v11 offset:512
  v_mfma_f32_16x16x32_bf16 v[76:79], a[176:179], v[172:175], v[76:79]
  ds_read_b64_tr_b16 v[144:145], v8 offset:4096
  global_load_lds_dwordx4 v2, s[22:23] offset:1024 sc1
  s_add_u32 m0, s30, 98304
  v_add_u32 v2, 8192, v2
  v_mfma_f32_16x16x32_bf16 v[72:75], a[172:175], v[172:175], v[72:75]
  ds_read_b64_tr_b16 v[146:147], v8 offset:4608
  v_mfma_f32_16x16x32_bf16 v[68:71], a[168:171], v[172:175], v[68:71]
  ds_read_b64_tr_b16 v[148:149], v9 offset:4096
  global_load_dwordx4 a[236:239], v3, s[22:23] offset:-1024 sc1
  v_mfma_f32_16x16x32_bf16 v[32:35], a[180:183], v[176:179], v[32:35]
  ds_read_b64_tr_b16 v[150:151], v9 offset:4608
  v_mfma_f32_16x16x32_bf16 v[36:39], a[184:187], v[176:179], v[36:39]
  ds_read_b64_tr_b16 v[152:153], v10 offset:4096
  global_load_dword v248, v12, s[22:23] offset:-2048 sc1
  v_mfma_f32_16x16x32_bf16 v[40:43], a[188:191], v[176:179], v[40:43]
  ds_read_b64_tr_b16 v[154:155], v10 offset:4608
  v_mfma_f32_16x16x32_bf16 v[52:55], a[188:191], v[180:183], v[52:55]
  ds_read_b64_tr_b16 v[156:157], v11 offset:4096
  global_load_dword v249, v13, s[22:23] offset:-1024 sc1
  v_mfma_f32_16x16x32_bf16 v[48:51], a[184:187], v[180:183], v[48:51]
  ds_read_b64_tr_b16 v[158:159], v11 offset:4608
  v_mfma_f32_16x16x32_bf16 v[44:47], a[180:183], v[180:183], v[44:47]
  v_mfma_f32_16x16x32_bf16 v[56:59], a[180:183], v[184:187], v[56:59]
  global_load_dword v250, v12, s[22:23] offset:0 sc1
  v_mfma_f32_16x16x32_bf16 v[60:63], a[184:187], v[184:187], v[60:63]
  v_mfma_f32_16x16x32_bf16 v[64:67], a[188:191], v[184:187], v[64:67]
  global_load_dword v251, v13, s[22:23] offset:1024 sc1
  v_mfma_f32_16x16x32_bf16 v[76:79], a[188:191], v[188:191], v[76:79]
  v_mfma_f32_16x16x32_bf16 v[72:75], a[184:187], v[188:191], v[72:75]
  global_load_dword v252, v12, s[22:23] offset:2048 sc1
  v_mfma_f32_16x16x32_bf16 v[68:71], a[180:183], v[188:191], v[68:71]
  s_waitcnt vmcnt(10)
  v_min3_f32 v232, v225, v227, v229
  v_min_f32 v232, v232, v231
  v_cmp_gt_f32 vcc, 0, v232
  s_cbranch_vccnz f_sping0
f_okg0:
  s_waitcnt lgkmcnt(0)
  v_mfma_f32_16x16x32_bf16 v[32:35], a[192:195], v[128:131], v[32:35]
  s_barrier
  v_mfma_f32_16x16x32_bf16 v[36:39], a[196:199], v[128:131], v[36:39]
  ds_read_b64_tr_b16 v[160:161], v8 offset:8192
  v_add_f32 v224, v224, v228
  v_mfma_f32_16x16x32_bf16 v[40:43], a[200:203], v[128:131], v[40:43]
  ds_read_b64_tr_b16 v[162:163], v8 offset:8704
  v_add_f32 v225, v225, v229
  v_mfma_f32_16x16x32_bf16 v[52:55], a[200:203], v[132:135], v[52:55]
  ds_read_b64_tr_b16 v[164:165], v9 offset:8192
  global_load_lds_dwordx4 v2, s[22:23] sc1
  v_mfma_f32_16x16x32_bf16 v[48:51], a[196:199], v[132:135], v[48:51]
  ds_read_b64_tr_b16 v[166:167], v9 offset:8704
  v_add_f32 v226, v226, v230
  v_mfma_f32_16x16x32_bf16 v[44:47], a[192:195], v[132:135], v[44:47]
  ds_read_b64_tr_b16 v[168:169], v10 offset:8192
  v_add_f32 v227, v227, v231
  v_mfma_f32_16x16x32_bf16 v[56:59], a[192:195], v[136:139], v[56:59]
  ds_read_b64_tr_b16 v[170:171], v10 offset:8704
  v_permlane32_swap_b32 v224, v226
  v_mfma_f32_16x16x32_bf16 v[60:63], a[196:199], v[136:139], v[60:63]
  ds_read_b64_tr_b16 v[172:173], v11 offset:8192
  global_load_lds_dwordx4 v2, s[22:23] offset:1024 sc1
  s_add_u32 m0, s30, 106496
  v_add_u32 v2, 8192, v2
  v_mfma_f32_16x16x32_bf16 v[64:67], a[200:203], v[136:139], v[64:67]
  ds_read_b64_tr_b16 v[174:175], v11 offset:8704
  v_permlane32_swap_b32 v225, v227
  v_mfma_f32_16x16x32_bf16 v[76:79], a[200:203], v[140:143], v[76:79]
  ds_read_b64_tr_b16 v[176:177], v8 offset:12288
  v_add_f32 v224, v224, v226
  v_mfma_f32_16x16x32_bf16 v[72:75], a[196:199], v[140:143], v[72:75]
  ds_read_b64_tr_b16 v[178:179], v8 offset:12800
  v_add_f32 v225, v225, v227
  v_mfma_f32_16x16x32_bf16 v[68:71], a[192:195], v[140:143], v[68:71]
  ds_read_b64_tr_b16 v[180:181], v9 offset:12288
  v_add_f32_dpp v224, v224, v224 row_ror:8 row_mask:0xf bank_mask:0xf
  v_mfma_f32_16x16x32_bf16 v[32:35], a[204:207], v[144:147], v[32:35]
  ds_read_b64_tr_b16 v[182:183], v9 offset:12800
  global_load_dwordx4 a[240:243], v3, s[22:23] offset:0 sc1
  v_mfma_f32_16x16x32_bf16 v[36:39], a[208:211], v[144:147], v[36:39]
  ds_read_b64_tr_b16 v[184:185], v10 offset:12288
  v_add_f32_dpp v225, v225, v225 row_ror:8 row_mask:0xf bank_mask:0xf
  v_mfma_f32_16x16x32_bf16 v[40:43], a[212:215], v[144:147], v[40:43]
  ds_read_b64_tr_b16 v[186:187], v10 offset:12800
  v_mov_b32 v226, v224
  v_mfma_f32_16x16x32_bf16 v[52:55], a[212:215], v[148:151], v[52:55]
  ds_read_b64_tr_b16 v[188:189], v11 offset:12288
  v_mov_b32 v227, v225
  v_mfma_f32_16x16x32_bf16 v[48:51], a[208:211], v[148:151], v[48:51]
  ds_read_b64_tr_b16 v[190:191], v11 offset:12800
  v_permlane16_swap_b32 v224, v226
  v_mfma_f32_16x16x32_bf16 v[44:47], a[204:207], v[148:151], v[44:47]
  global_load_dwordx4 a[244:247], v3, s[22:23] offset:1024 sc1
  v_mfma_f32_16x16x32_bf16 v[56:59], a[204:207], v[152:155], v[56:59]
  v_permlane16_swap_b32 v225, v227
  v_mfma_f32_16x16x32_bf16 v[60:63], a[208:211], v[152:155], v[60:63]
  v_add_f32 v224, v224, v226
  v_add_f32 v225, v225, v227
  v_mfma_f32_16x16x32_bf16 v[64:67], a[212:215], v[152:155], v[64:67]
  v_mul_f32 v224, 0xbacccccd, v224
  v_mul_f32 v225, 0x3acccccd, v225
  v_mfma_f32_16x16x32_bf16 v[76:79], a[212:215], v[156:159], v[76:79]
  global_load_dwordx4 a[248:251], v3, s[22:23] offset:2048 sc1
  v_fma_f32 v225, -v224, v224, v225
  v_mfma_f32_16x16x32_bf16 v[72:75], a[208:211], v[156:159], v[72:75]
  v_cvt_pk_bf16_f32 v226, v224, v224
  v_max_f32 v225, 0, v225
  v_mfma_f32_16x16x32_bf16 v[68:71], a[204:207], v[156:159], v[68:71]
  v_and_b32 v226, 0xffff0000, v226
  s_waitcnt lgkmcnt(0)
  v_mfma_f32_16x16x32_bf16 v[32:35], a[216:219], v[160:163], v[32:35]
  s_waitcnt vmcnt(13)
  s_barrier
  v_mfma_f32_16x16x32_bf16 v[36:39], a[220:223], v[160:163], v[36:39]
  ds_read_b64_tr_b16 v[128:129], v8 offset:16384
  v_add_f32 v238, 0x3727c5ac, v225
  v_mfma_f32_16x16x32_bf16 v[40:43], a[224:227], v[160:163], v[40:43]
  ds_read_b64_tr_b16 v[130:131], v8 offset:16896
  v_sub_f32 v227, v224, v226
  v_mfma_f32_16x16x32_bf16 v[52:55], a[224:227], v[164:167], v[52:55]
  ds_read_b64_tr_b16 v[132:133], v9 offset:16384
  v_rsq_f32 v228, v238
  v_mfma_f32_16x16x32_bf16 v[48:51], a[220:223], v[164:167], v[48:51]
  ds_read_b64_tr_b16 v[134:135], v9 offset:16896
  v_sqrt_f32 v229, v238
  v_mfma_f32_16x16x32_bf16 v[44:47], a[216:219], v[164:167], v[44:47]
  ds_read_b64_tr_b16 v[136:137], v10 offset:16384
  v_cvt_pk_bf16_f32 v232, v226, v227
  v_mfma_f32_16x16x32_bf16 v[56:59], a[216:219], v[168:171], v[56:59]
  ds_read_b64_tr_b16 v[138:139], v10 offset:16896
  global_load_lds_dwordx4 v2, s[22:23] sc1
  v_mfma_f32_16x16x32_bf16 v[60:63], a[220:223], v[168:171], v[60:63]
  ds_read_b64_tr_b16 v[140:141], v11 offset:16384
  v_mul_f32 v237, 0xc0135761, v228
  v_mfma_f32_16x16x32_bf16 v[64:67], a[224:227], v[168:171], v[64:67]
  ds_read_b64_tr_b16 v[142:143], v11 offset:16896
  v_cvt_pk_bf16_f32 v230, v229, v229
  v_mfma_f32_16x16x32_bf16 v[76:79], a[224:227], v[172:175], v[76:79]
  ds_read_b64_tr_b16 v[144:145], v8 offset:20480
  v_mul_f32 v228, v228, v228
  v_mfma_f32_16x16x32_bf16 v[72:75], a[220:223], v[172:175], v[72:75]
  ds_read_b64_tr_b16 v[146:147], v8 offset:20992
  v_and_b32 v230, 0xffff0000, v230
  v_mfma_f32_16x16x32_bf16 v[68:71], a[216:219], v[172:175], v[68:71]
  ds_read_b64_tr_b16 v[148:149], v9 offset:20480
  v_mul_f32 v228, 0x3d372713, v228
  v_mfma_f32_16x16x32_bf16 v[32:35], a[228:231], v[176:179], v[32:35]
  ds_read_b64_tr_b16 v[150:151], v9 offset:20992
  v_sub_f32 v231, v229, v230
  v_mfma_f32_16x16x32_bf16 v[36:39], a[232:235], v[176:179], v[36:39]
  ds_read_b64_tr_b16 v[152:153], v10 offset:20480
  v_mul_f32 v236, v228, v237
  s_waitcnt vmcnt(11)
  v_mfma_f32_16x16x32_bf16 v[40:43], a[236:239], v[176:179], v[40:43]
  ds_read_b64_tr_b16 v[154:155], v10 offset:20992
  v_cvt_pk_bf16_f32 v234, v230, v231
  v_mfma_f32_16x16x32_bf16 v[52:55], a[236:239], v[180:183], v[52:55]
  ds_read_b64_tr_b16 v[156:157], v11 offset:20480
  v_mov_b32 v233, v232
  v_mfma_f32_16x16x32_bf16 v[48:51], a[232:235], v[180:183], v[48:51]
  ds_read_b64_tr_b16 v[158:159], v11 offset:20992
  v_mov_b32 v235, v234
  v_mfma_f32_16x16x32_bf16 v[44:47], a[228:231], v[180:183], v[44:47]
  v_mov_b32 v239, v238
  ds_write_b128 v16, v[232:235] offset:0
  v_mfma_f32_16x16x32_bf16 v[56:59], a[228:231], v[184:187], v[56:59]
  global_load_lds_dwordx4 v2, s[22:23] offset:1024 sc1
  s_add_u32 m0, s30, 114688
  v_add_u32 v2, 8192, v2
  v_mfma_f32_16x16x32_bf16 v[60:63], a[232:235], v[184:187], v[60:63]
  ds_write_b128 v16, v[236:239] offset:16
  s_waitcnt vmcnt(11)
  v_lshlrev_b32 v254, 16, v248
  v_mfma_f32_16x16x32_bf16 v[64:67], a[236:239], v[184:187], v[64:67]
  v_and_b32 v255, 0xffff0000, v248
  v_mov_b32 v20, v254
  v_mfma_f32_16x16x32_bf16 v[76:79], a[236:239], v[188:191], v[76:79]
  v_mul_f32 v21, v254, v254
  v_mov_b32 v22, v255
  v_mfma_f32_16x16x32_bf16 v[72:75], a[232:235], v[188:191], v[72:75]
  v_mul_f32 v23, v255, v255
  s_waitcnt vmcnt(10)
  v_lshlrev_b32 v254, 16, v249
  v_mfma_f32_16x16x32_bf16 v[68:71], a[228:231], v[188:191], v[68:71]
  v_and_b32 v255, 0xffff0000, v249
  s_waitcnt lgkmcnt(0)
  v_mfma_f32_16x16x32_bf16 v[80:83], a[0:3], v[128:131], 0
  s_barrier
  v_mfma_f32_16x16x32_bf16 v[84:87], a[4:7], v[128:131], 0
  ds_read_b64_tr_b16 v[160:161], v8 offset:24576
  v_add_f32 v20, v20, v254
  v_mfma_f32_16x16x32_bf16 v[88:91], a[8:11], v[128:131], 0
  ds_read_b64_tr_b16 v[162:163], v8 offset:25088
  v_fmac_f32 v21, v254, v254
  v_mfma_f32_16x16x32_bf16 v[100:103], a[8:11], v[132:135], 0
  ds_read_b64_tr_b16 v[164:165], v9 offset:24576
  v_add_f32 v22, v22, v255
  v_mfma_f32_16x16x32_bf16 v[96:99], a[4:7], v[132:135], 0
  ds_read_b64_tr_b16 v[166:167], v9 offset:25088
  v_fmac_f32 v23, v255, v255
  v_mfma_f32_16x16x32_bf16 v[92:95], a[0:3], v[132:135], 0
  ds_read_b64_tr_b16 v[168:169], v10 offset:24576
  s_waitcnt vmcnt(9)
  v_lshlrev_b32 v254, 16, v250
  v_mfma_f32_16x16x32_bf16 v[104:107], a[0:3], v[136:139], 0
  ds_read_b64_tr_b16 v[170:171], v10 offset:25088
  global_load_lds_dwordx4 v2, s[22:23] sc1
  v_mfma_f32_16x16x32_bf16 v[108:111], a[4:7], v[136:139], 0
  ds_read_b64_tr_b16 v[172:173], v11 offset:24576
  v_and_b32 v255, 0xffff0000, v250
  v_mfma_f32_16x16x32_bf16 v[112:115], a[8:11], v[136:139], 0
  ds_read_b64_tr_b16 v[174:175], v11 offset:25088
  v_add_f32 v20, v20, v254
  v_mfma_f32_16x16x32_bf16 v[124:127], a[8:11], v[140:143], 0
  ds_read_b64_tr_b16 v[176:177], v8 offset:28672
  v_fmac_f32 v21, v254, v254
  v_mfma_f32_16x16x32_bf16 v[120:123], a[4:7], v[140:143], 0
  ds_read_b64_tr_b16 v[178:179], v8 offset:29184
  v_add_f32 v22, v22, v255
  v_mfma_f32_16x16x32_bf16 v[116:119], a[0:3], v[140:143], 0
  ds_read_b64_tr_b16 v[180:181], v9 offset:28672
  v_fmac_f32 v23, v255, v255
  v_mfma_f32_16x16x32_bf16 v[80:83], a[12:15], v[144:147], v[80:83]
  ds_read_b64_tr_b16 v[182:183], v9 offset:29184
  s_waitcnt vmcnt(9)
  v_lshlrev_b32 v254, 16, v251
  v_mfma_f32_16x16x32_bf16 v[84:87], a[16:19], v[144:147], v[84:87]
  ds_read_b64_tr_b16 v[184:185], v10 offset:28672
  v_and_b32 v255, 0xffff0000, v251
  v_mfma_f32_16x16x32_bf16 v[88:91], a[20:23], v[144:147], v[88:91]
  ds_read_b64_tr_b16 v[186:187], v10 offset:29184
  v_add_f32 v20, v20, v254
  v_mfma_f32_16x16x32_bf16 v[100:103], a[20:23], v[148:151], v[100:103]
  ds_read_b64_tr_b16 v[188:189], v11 offset:28672
  v_fmac_f32 v21, v254, v254
  v_mfma_f32_16x16x32_bf16 v[96:99], a[16:19], v[148:151], v[96:99]
  ds_read_b64_tr_b16 v[190:191], v11 offset:29184
  v_add_f32 v22, v22, v255
  v_mfma_f32_16x16x32_bf16 v[92:95], a[12:15], v[148:151], v[92:95]
  v_fmac_f32 v23, v255, v255
  s_waitcnt vmcnt(8)
  v_lshlrev_b32 v254, 16, v252
  v_mfma_f32_16x16x32_bf16 v[104:107], a[12:15], v[152:155], v[104:107]
  global_load_lds_dwordx4 v2, s[22:23] offset:1024 sc1
  s_add_u32 m0, s30, 122880
  v_add_u32 v2, 8192, v2
  v_mfma_f32_16x16x32_bf16 v[108:111], a[16:19], v[152:155], v[108:111]
  v_and_b32 v255, 0xffff0000, v252
  v_add_f32 v20, v20, v254
  v_mfma_f32_16x16x32_bf16 v[112:115], a[20:23], v[152:155], v[112:115]
  v_fmac_f32 v21, v254, v254
  v_add_f32 v22, v22, v255
  v_mfma_f32_16x16x32_bf16 v[124:127], a[20:23], v[156:159], v[124:127]
  v_fmac_f32 v23, v255, v255
  v_mfma_f32_16x16x32_bf16 v[120:123], a[16:19], v[156:159], v[120:123]
  v_permlane32_swap_b32 v20, v22
  v_mfma_f32_16x16x32_bf16 v[116:119], a[12:15], v[156:159], v[116:119]
  s_waitcnt lgkmcnt(0)
  v_mfma_f32_16x16x32_bf16 v[80:83], a[24:27], v[160:163], v[80:83]
  s_waitcnt vmcnt(7)
  s_barrier
  v_mfma_f32_16x16x32_bf16 v[84:87], a[28:31], v[160:163], v[84:87]
  ds_read_b128 v[192:195], v17 offset:0
  v_permlane32_swap_b32 v21, v23
  v_mfma_f32_16x16x32_bf16 v[88:91], a[32:35], v[160:163], v[88:91]
  ds_read_b128 v[200:203], v17 offset:512
  global_load_lds_dwordx4 v2, s[22:23] sc1
  v_mfma_f32_16x16x32_bf16 v[100:103], a[32:35], v[164:167], v[100:103]
  ds_read_b128 v[208:211], v17 offset:1024
  v_add_f32 v20, v20, v22
  v_mfma_f32_16x16x32_bf16 v[96:99], a[28:31], v[164:167], v[96:99]
  ds_read_b128 v[216:219], v17 offset:1536
  v_add_f32 v21, v21, v23
  v_mfma_f32_16x16x32_bf16 v[92:95], a[24:27], v[164:167], v[92:95]
  ds_read_b128 v[196:199], v17 offset:16
  global_load_lds_dwordx4 v2, s[22:23] offset:1024 sc1
  s_add_u32 m0, s30, 131072
  v_add_u32 v2, 8192, v2
  v_lshl_add_u32 v3, v1, 4, s34
  v_mfma_f32_16x16x32_bf16 v[104:107], a[24:27], v[168:171], v[104:107]
  ds_read_b128 v[204:207], v17 offset:528
  v_add_f32_dpp v20, v20, v20 row_ror:8 row_mask:0xf bank_mask:0xf
  v_mfma_f32_16x16x32_bf16 v[108:111], a[28:31], v[168:171], v[108:111]
  ds_read_b128 v[212:215], v17 offset:1040
  v_add_f32_dpp v21, v21, v21 row_ror:8 row_mask:0xf bank_mask:0xf
  v_mfma_f32_16x16x32_bf16 v[112:115], a[32:35], v[168:171], v[112:115]
  ds_read_b128 v[220:223], v17 offset:1552
  global_load_dwordx4 a[0:3], v3, s[22:23] offset:-4096 sc1
  v_mfma_f32_16x16x32_bf16 v[124:127], a[32:35], v[172:175], v[124:127]
  ds_read_b64_tr_b16 v[128:129], v8 offset:32768
  v_mov_b32 v22, v20
  v_mfma_f32_16x16x32_bf16 v[120:123], a[28:31], v[172:175], v[120:123]
  ds_read_b64_tr_b16 v[130:131], v8 offset:33280
  v_mov_b32 v23, v21
  v_mfma_f32_16x16x32_bf16 v[116:119], a[24:27], v[172:175], v[116:119]
  ds_read_b64_tr_b16 v[132:133], v9 offset:32768
  global_load_dwordx4 a[4:7], v3, s[22:23] offset:-3072 sc1
  v_mfma_f32_16x16x32_bf16 v[80:83], a[36:39], v[176:179], v[80:83]
  ds_read_b64_tr_b16 v[134:135], v9 offset:33280
  v_permlane16_swap_b32 v20, v22
  v_mfma_f32_16x16x32_bf16 v[84:87], a[40:43], v[176:179], v[84:87]
  ds_read_b64_tr_b16 v[136:137], v10 offset:32768
  global_load_dwordx4 a[8:11], v3, s[22:23] offset:-2048 sc1
  v_mfma_f32_16x16x32_bf16 v[88:91], a[44:47], v[176:179], v[88:91]
  ds_read_b64_tr_b16 v[138:139], v10 offset:33280
  v_permlane16_swap_b32 v21, v23
  v_mfma_f32_16x16x32_bf16 v[100:103], a[44:47], v[180:183], v[100:103]
  ds_read_b64_tr_b16 v[140:141], v11 offset:32768
  v_add_f32 v20, v20, v22
  v_mfma_f32_16x16x32_bf16 v[96:99], a[40:43], v[180:183], v[96:99]
  ds_read_b64_tr_b16 v[142:143], v11 offset:33280
  global_load_dwordx4 a[12:15], v3, s[22:23] offset:-1024 sc1
  v_mfma_f32_16x16x32_bf16 v[92:95], a[36:39], v[180:183], v[92:95]
  ds_read_b64_tr_b16 v[144:145], v8 offset:36864
  v_add_f32 v21, v21, v23
  v_mfma_f32_16x16x32_bf16 v[104:107], a[36:39], v[184:187], v[104:107]
  ds_read_b64_tr_b16 v[146:147], v8 offset:37376
  s_mov_b64 exec, s[36:37]
  global_store_dwordx2 v14, v[20:21], s[22:23] offset:512 sc1
  s_mov_b64 exec, -1
  v_mfma_f32_16x16x32_bf16 v[108:111], a[40:43], v[184:187], v[108:111]
  ds_read_b64_tr_b16 v[148:149], v9 offset:36864
  global_load_dwordx4 a[16:19], v3, s[22:23] offset:0 sc1
  v_mfma_f32_16x16x32_bf16 v[112:115], a[44:47], v[184:187], v[112:115]
  ds_read_b64_tr_b16 v[150:151], v9 offset:37376
  v_mfma_f32_16x16x32_bf16 v[124:127], a[44:47], v[188:191], v[124:127]
  ds_read_b64_tr_b16 v[152:153], v10 offset:36864
  v_mfma_f32_16x16x32_bf16 v[120:123], a[40:43], v[188:191], v[120:123]
  ds_read_b64_tr_b16 v[154:155], v10 offset:37376
  global_load_dwordx4 a[20:23], v3, s[22:23] offset:1024 sc1
  v_mfma_f32_16x16x32_bf16 v[116:119], a[36:39], v[188:191], v[116:119]
  ds_read_b64_tr_b16 v[156:157], v11 offset:36864
  ds_read_b64_tr_b16 v[158:159], v11 offset:37376
  s_waitcnt vmcnt(15) lgkmcnt(9)
  v_mfma_f32_16x16x32_bf16 v[32:35], a[240:243], v[192:195], v[32:35]
  global_load_lds_dwordx4 v2, s[22:23] sc1
  v_mfma_f32_16x16x32_bf16 v[44:47], a[240:243], v[200:203], v[44:47]
  v_mfma_f32_16x16x32_bf16 v[56:59], a[240:243], v[208:211], v[56:59]
  v_mfma_f32_16x16x32_bf16 v[68:71], a[240:243], v[216:219], v[68:71]
  global_load_lds_dwordx4 v2, s[22:23] offset:1024 sc1
  s_waitcnt vmcnt(16)
  v_mfma_f32_16x16x32_bf16 v[36:39], a[244:247], v[192:195], v[36:39]
  v_mfma_f32_16x16x32_bf16 v[48:51], a[244:247], v[200:203], v[48:51]
  v_mfma_f32_16x16x32_bf16 v[60:63], a[244:247], v[208:211], v[60:63]
  s_add_u32 m0, s30, 139264
  v_mfma_f32_16x16x32_bf16 v[72:75], a[244:247], v[216:219], v[72:75]
  s_waitcnt vmcnt(15)
  v_mfma_f32_16x16x32_bf16 v[40:43], a[248:251], v[192:195], v[40:43]
  v_mfma_f32_16x16x32_bf16 v[52:55], a[248:251], v[200:203], v[52:55]
  v_add_u32 v2, 8192, v2
  v_mfma_f32_16x16x32_bf16 v[64:67], a[248:251], v[208:211], v[64:67]
  v_mfma_f32_16x16x32_bf16 v[76:79], a[248:251], v[216:219], v[76:79]
  v_pk_mul_f32 v[236:237], v[32:33], v[32:33]
  global_load_lds_dwordx4 v2, s[22:23] sc1
  v_pk_mul_f32 v[238:239], v[44:45], v[44:45]
  v_pk_mul_f32 v[240:241], v[56:57], v[56:57]
  v_pk_mul_f32 v[242:243], v[68:69], v[68:69]
  v_pk_fma_f32 v[236:237], v[236:237], v[196:197], v[196:197] op_sel:[0,0,1] op_sel_hi:[1,0,1]
  v_pk_fma_f32 v[238:239], v[238:239], v[204:205], v[204:205] op_sel:[0,0,1] op_sel_hi:[1,0,1]
  global_load_lds_dwordx4 v2, s[22:23] offset:1024 sc1
  v_pk_fma_f32 v[240:241], v[240:241], v[212:213], v[212:213] op_sel:[0,0,1] op_sel_hi:[1,0,1]
  v_pk_fma_f32 v[242:243], v[242:243], v[220:221], v[220:221] op_sel:[0,0,1] op_sel_hi:[1,0,1]
  v_pk_mul_f32 v[236:237], v[236:237], v[32:33]
  v_pk_mul_f32 v[238:239], v[238:239], v[44:45]
  v_pk_mul_f32 v[240:241], v[240:241], v[56:57]
  v_pk_mul_f32 v[242:243], v[242:243], v[68:69]
  s_add_u32 m0, s30, 147456
  v_exp_f32 v236, v236
  v_exp_f32 v237, v237
  v_pk_mul_f32 v[32:33], v[32:33], v[34:35]
  v_exp_f32 v238, v238
  v_exp_f32 v239, v239
  v_add_u32 v2, 8192, v2
  v_pk_mul_f32 v[44:45], v[44:45], v[46:47]
  v_exp_f32 v240, v240
  v_exp_f32 v241, v241
  v_pk_mul_f32 v[56:57], v[56:57], v[58:59]
  v_exp_f32 v242, v242
  v_exp_f32 v243, v243
  global_load_lds_dwordx4 v2, s[22:23] sc1
  v_pk_mul_f32 v[68:69], v[68:69], v[70:71]
  v_pk_fma_f32 v[236:237], v[236:237], v[198:199], v[198:199]
  v_pk_fma_f32 v[238:239], v[238:239], v[206:207], v[206:207]
  v_pk_fma_f32 v[240:241], v[240:241], v[214:215], v[214:215]
  v_pk_fma_f32 v[242:243], v[242:243], v[222:223], v[222:223]
  global_load_lds_dwordx4 v2, s[22:23] offset:1024 sc1
  v_rcp_f32 v236, v236
  v_rcp_f32 v237, v237
  v_rcp_f32 v238, v238
  v_rcp_f32 v239, v239
  v_rcp_f32 v240, v240
  v_rcp_f32 v241, v241
  s_add_u32 m0, s30, 155648
  v_rcp_f32 v242, v242
  v_rcp_f32 v243, v243
  v_pk_mul_f32 v[32:33], v[32:33], v[236:237]
  v_pk_mul_f32 v[44:45], v[44:45], v[238:239]
  v_pk_mul_f32 v[56:57], v[56:57], v[240:241]
  v_add_u32 v2, 8192, v2
  v_pk_mul_f32 v[68:69], v[68:69], v[242:243]
  v_cvt_pk_bf16_f32 v224, v32, v33
  v_cvt_pk_bf16_f32 v226, v56, v57
  v_cvt_pk_bf16_f32 v225, v44, v45
  v_cvt_pk_bf16_f32 v227, v68, v69
  v_permlane32_swap_b32 v224, v226
  s_nop 0
  v_permlane32_swap_b32 v225, v227
  s_nop 1
  v_permlane16_swap_b32 v224, v225
  v_permlane16_swap_b32 v226, v227
  global_store_dwordx4 v4, v[224:227], s[22:23] offset:0 sc1
  v_pk_mul_f32 v[236:237], v[36:37], v[36:37]
  global_load_lds_dwordx4 v2, s[22:23] sc1
  v_pk_mul_f32 v[238:239], v[48:49], v[48:49]
  v_pk_mul_f32 v[240:241], v[60:61], v[60:61]
  v_pk_mul_f32 v[242:243], v[72:73], v[72:73]
  v_pk_fma_f32 v[236:237], v[236:237], v[196:197], v[196:197] op_sel:[0,0,1] op_sel_hi:[1,0,1]
  v_pk_fma_f32 v[238:239], v[238:239], v[204:205], v[204:205] op_sel:[0,0,1] op_sel_hi:[1,0,1]
  v_pk_fma_f32 v[240:241], v[240:241], v[212:213], v[212:213] op_sel:[0,0,1] op_sel_hi:[1,0,1]
  v_pk_fma_f32 v[242:243], v[242:243], v[220:221], v[220:221] op_sel:[0,0,1] op_sel_hi:[1,0,1]
  v_pk_mul_f32 v[236:237], v[236:237], v[36:37]
  global_load_lds_dwordx4 v2, s[22:23] offset:1024 sc1
  v_pk_mul_f32 v[238:239], v[238:239], v[48:49]
  v_pk_mul_f32 v[240:241], v[240:241], v[60:61]
  v_pk_mul_f32 v[242:243], v[242:243], v[72:73]
  v_exp_f32 v236, v236
  v_exp_f32 v237, v237
  v_pk_mul_f32 v[36:37], v[36:37], v[38:39]
  v_exp_f32 v238, v238
  v_exp_f32 v239, v239
  v_pk_mul_f32 v[48:49], v[48:49], v[50:51]
  global_load_dwordx4 a[24:27], v3, s[22:23] offset:2048 sc1
  v_exp_f32 v240, v240
  v_exp_f32 v241, v241
  v_pk_mul_f32 v[60:61], v[60:61], v[62:63]
  v_exp_f32 v242, v242
  v_exp_f32 v243, v243
  v_pk_mul_f32 v[72:73], v[72:73], v[74:75]
  v_pk_fma_f32 v[236:237], v[236:237], v[198:199], v[198:199]
  v_pk_fma_f32 v[238:239], v[238:239], v[206:207], v[206:207]
  v_pk_fma_f32 v[240:241], v[240:241], v[214:215], v[214:215]
  global_load_dwordx4 a[28:31], v3, s[22:23] offset:3072 sc1
  v_pk_fma_f32 v[242:243], v[242:243], v[222:223], v[222:223]
  v_rcp_f32 v236, v236
  v_rcp_f32 v237, v237
  v_rcp_f32 v238, v238
  v_rcp_f32 v239, v239
  v_rcp_f32 v240, v240
  v_rcp_f32 v241, v241
  v_rcp_f32 v242, v242
  v_rcp_f32 v243, v243
  v_add_u32 v3, 8192, v3
  v_pk_mul_f32 v[36:37], v[36:37], v[236:237]
  v_pk_mul_f32 v[48:49], v[48:49], v[238:239]
  v_pk_mul_f32 v[60:61], v[60:61], v[240:241]
  v_pk_mul_f32 v[72:73], v[72:73], v[242:243]
  v_cvt_pk_bf16_f32 v228, v36, v37
  v_cvt_pk_bf16_f32 v230, v60, v61
  v_cvt_pk_bf16_f32 v229, v48, v49
  v_cvt_pk_bf16_f32 v231, v72, v73
  v_permlane32_swap_b32 v228, v230
  s_nop 0
  v_permlane32_swap_b32 v229, v231
  s_nop 1
  v_permlane16_swap_b32 v228, v229
  v_permlane16_swap_b32 v230, v231
  global_store_dwordx4 v4, v[228:231], s[22:23] offset:1024 sc1
  v_pk_mul_f32 v[236:237], v[40:41], v[40:41]
  global_load_dwordx4 a[32:35], v3, s[22:23] offset:-4096 sc1
  v_pk_mul_f32 v[238:239], v[52:53], v[52:53]
  v_pk_mul_f32 v[240:241], v[64:65], v[64:65]
  v_pk_mul_f32 v[242:243], v[76:77], v[76:77]
  v_pk_fma_f32 v[236:237], v[236:237], v[196:197], v[196:197] op_sel:[0,0,1] op_sel_hi:[1,0,1]
  v_pk_fma_f32 v[238:239], v[238:239], v[204:205], v[204:205] op_sel:[0,0,1] op_sel_hi:[1,0,1]
  v_pk_fma_f32 v[240:241], v[240:241], v[212:213], v[212:213] op_sel:[0,0,1] op_sel_hi:[1,0,1]
  v_pk_fma_f32 v[242:243], v[242:243], v[220:221], v[220:221] op_sel:[0,0,1] op_sel_hi:[1,0,1]
  v_pk_mul_f32 v[236:237], v[236:237], v[40:41]
  v_pk_mul_f32 v[238:239], v[238:239], v[52:53]
  v_pk_mul_f32 v[240:241], v[240:241], v[64:65]
  v_pk_mul_f32 v[242:243], v[242:243], v[76:77]
  global_load_dwordx4 a[36:39], v3, s[22:23] offset:-3072 sc1
  v_exp_f32 v236, v236
  v_exp_f32 v237, v237
  v_pk_mul_f32 v[40:41], v[40:41], v[42:43]
  v_exp_f32 v238, v238
  v_exp_f32 v239, v239
  v_pk_mul_f32 v[52:53], v[52:53], v[54:55]
  v_exp_f32 v240, v240
  v_exp_f32 v241, v241
  v_pk_mul_f32 v[64:65], v[64:65], v[66:67]
  v_exp_f32 v242, v242
  v_exp_f32 v243, v243
  global_load_dwordx4 a[40:43], v3, s[22:23] offset:-2048 sc1
  v_pk_mul_f32 v[76:77], v[76:77], v[78:79]
  v_pk_fma_f32 v[236:237], v[236:237], v[198:199], v[198:199]
  v_pk_fma_f32 v[238:239], v[238:239], v[206:207], v[206:207]
  v_pk_fma_f32 v[240:241], v[240:241], v[214:215], v[214:215]
  v_pk_fma_f32 v[242:243], v[242:243], v[222:223], v[222:223]
  v_rcp_f32 v236, v236
  v_rcp_f32 v237, v237
  v_rcp_f32 v238, v238
  v_rcp_f32 v239, v239
  v_rcp_f32 v240, v240
  v_rcp_f32 v241, v241
  global_load_dwordx4 a[44:47], v3, s[22:23] offset:-1024 sc1
  v_rcp_f32 v242, v242
  v_rcp_f32 v243, v243
  v_pk_mul_f32 v[40:41], v[40:41], v[236:237]
  v_pk_mul_f32 v[52:53], v[52:53], v[238:239]
  v_pk_mul_f32 v[64:65], v[64:65], v[240:241]
  v_pk_mul_f32 v[76:77], v[76:77], v[242:243]
  v_cvt_pk_bf16_f32 v232, v40, v41
  v_cvt_pk_bf16_f32 v234, v64, v65
  v_cvt_pk_bf16_f32 v233, v52, v53
  v_cvt_pk_bf16_f32 v235, v76, v77
  v_permlane32_swap_b32 v232, v234
  s_nop 0
  v_permlane32_swap_b32 v233, v235
  s_nop 1
  v_permlane16_swap_b32 v232, v233
  v_permlane16_swap_b32 v234, v235
  global_store_dwordx4 v4, v[232:235], s[22:23] offset:2048 sc1
  v_add_u32 v4, 196608, v4
  s_waitcnt lgkmcnt(0)
  v_mfma_f32_16x16x32_bf16 v[80:83], a[48:51], v[128:131], v[80:83]
  s_waitcnt vmcnt(28)
  s_barrier
  v_mfma_f32_16x16x32_bf16 v[84:87], a[52:55], v[128:131], v[84:87]
  ds_read_b64_tr_b16 v[160:161], v8 offset:40960
  v_mfma_f32_16x16x32_bf16 v[88:91], a[56:59], v[128:131], v[88:91]
  ds_read_b64_tr_b16 v[162:163], v8 offset:41472
  v_mfma_f32_16x16x32_bf16 v[100:103], a[56:59], v[132:135], v[100:103]
  ds_read_b64_tr_b16 v[164:165], v9 offset:40960
  v_mfma_f32_16x16x32_bf16 v[96:99], a[52:55], v[132:135], v[96:99]
  ds_read_b64_tr_b16 v[166:167], v9 offset:41472
  v_mfma_f32_16x16x32_bf16 v[92:95], a[48:51], v[132:135], v[92:95]
  ds_read_b64_tr_b16 v[168:169], v10 offset:40960
  v_mfma_f32_16x16x32_bf16 v[104:107], a[48:51], v[136:139], v[104:107]
  ds_read_b64_tr_b16 v[170:171], v10 offset:41472
  v_mfma_f32_16x16x32_bf16 v[108:111], a[52:55], v[136:139], v[108:111]
  ds_read_b64_tr_b16 v[172:173], v11 offset:40960
  v_mfma_f32_16x16x32_bf16 v[112:115], a[56:59], v[136:139], v[112:115]
  ds_read_b64_tr_b16 v[174:175], v11 offset:41472
  v_mfma_f32_16x16x32_bf16 v[124:127], a[56:59], v[140:143], v[124:127]
  ds_read_b64_tr_b16 v[176:177], v8 offset:45056
  v_mfma_f32_16x16x32_bf16 v[120:123], a[52:55], v[140:143], v[120:123]
  ds_read_b64_tr_b16 v[178:179], v8 offset:45568
  v_mfma_f32_16x16x32_bf16 v[116:119], a[48:51], v[140:143], v[116:119]
  ds_read_b64_tr_b16 v[180:181], v9 offset:45056
  v_mfma_f32_16x16x32_bf16 v[80:83], a[60:63], v[144:147], v[80:83]
  ds_read_b64_tr_b16 v[182:183], v9 offset:45568
  v_mfma_f32_16x16x32_bf16 v[84:87], a[64:67], v[144:147], v[84:87]
  ds_read_b64_tr_b16 v[184:185], v10 offset:45056
  v_mfma_f32_16x16x32_bf16 v[88:91], a[68:71], v[144:147], v[88:91]
  ds_read_b64_tr_b16 v[186:187], v10 offset:45568
  v_mfma_f32_16x16x32_bf16 v[100:103], a[68:71], v[148:151], v[100:103]
  ds_read_b64_tr_b16 v[188:189], v11 offset:45056
  v_mfma_f32_16x16x32_bf16 v[96:99], a[64:67], v[148:151], v[96:99]
  ds_read_b64_tr_b16 v[190:191], v11 offset:45568
  v_mfma_f32_16x16x32_bf16 v[92:95], a[60:63], v[148:151], v[92:95]
  v_mfma_f32_16x16x32_bf16 v[104:107], a[60:63], v[152:155], v[104:107]
  v_mfma_f32_16x16x32_bf16 v[108:111], a[64:67], v[152:155], v[108:111]
  v_mfma_f32_16x16x32_bf16 v[112:115], a[68:71], v[152:155], v[112:115]
  v_mfma_f32_16x16x32_bf16 v[124:127], a[68:71], v[156:159], v[124:127]
  v_mfma_f32_16x16x32_bf16 v[120:123], a[64:67], v[156:159], v[120:123]
  v_mfma_f32_16x16x32_bf16 v[116:119], a[60:63], v[156:159], v[116:119]
  s_waitcnt lgkmcnt(0)
  v_mfma_f32_16x16x32_bf16 v[80:83], a[72:75], v[160:163], v[80:83]
  s_waitcnt vmcnt(26)
  s_barrier
  v_mfma_f32_16x16x32_bf16 v[84:87], a[76:79], v[160:163], v[84:87]
  ds_read_b64_tr_b16 v[128:129], v8 offset:49152
  v_mfma_f32_16x16x32_bf16 v[88:91], a[80:83], v[160:163], v[88:91]
  ds_read_b64_tr_b16 v[130:131], v8 offset:49664
  global_load_dwordx4 a[48:51], v3, s[22:23] offset:0 sc1
  v_mfma_f32_16x16x32_bf16 v[100:103], a[80:83], v[164:167], v[100:103]
  ds_read_b64_tr_b16 v[132:133], v9 offset:49152
  v_mfma_f32_16x16x32_bf16 v[96:99], a[76:79], v[164:167], v[96:99]
  ds_read_b64_tr_b16 v[134:135], v9 offset:49664
  v_mfma_f32_16x16x32_bf16 v[92:95], a[72:75], v[164:167], v[92:95]
  ds_read_b64_tr_b16 v[136:137], v10 offset:49152
  v_mfma_f32_16x16x32_bf16 v[104:107], a[72:75], v[168:171], v[104:107]
  ds_read_b64_tr_b16 v[138:139], v10 offset:49664
  global_load_dwordx4 a[52:55], v3, s[22:23] offset:1024 sc1
  v_mfma_f32_16x16x32_bf16 v[108:111], a[76:79], v[168:171], v[108:111]
warm7:
  s_cbranch_execz warm_back
  ds_read_b64_tr_b16 v[140:141], v11 offset:49152
  v_mfma_f32_16x16x32_bf16 v[112:115], a[80:83], v[168:171], v[112:115]
  ds_read_b64_tr_b16 v[142:143], v11 offset:49664
  v_mfma_f32_16x16x32_bf16 v[124:127], a[80:83], v[172:175], v[124:127]
  ds_read_b64_tr_b16 v[144:145], v8 offset:53248
  v_mfma_f32_16x16x32_bf16 v[120:123], a[76:79], v[172:175], v[120:123]
  ds_read_b64_tr_b16 v[146:147], v8 offset:53760
  global_load_dwordx4 a[56:59], v3, s[22:23] offset:2048 sc1
  v_mfma_f32_16x16x32_bf16 v[116:119], a[72:75], v[172:175], v[116:119]
  ds_read_b64_tr_b16 v[148:149], v9 offset:53248
  v_mfma_f32_16x16x32_bf16 v[80:83], a[84:87], v[176:179], v[80:83]
  ds_read_b64_tr_b16 v[150:151], v9 offset:53760
  v_mfma_f32_16x16x32_bf16 v[84:87], a[88:91], v[176:179], v[84:87]
  ds_read_b64_tr_b16 v[152:153], v10 offset:53248
  v_mfma_f32_16x16x32_bf16 v[88:91], a[92:95], v[176:179], v[88:91]
  ds_read_b64_tr_b16 v[154:155], v10 offset:53760
  global_load_dwordx4 a[60:63], v3, s[22:23] offset:3072 sc1
  v_add_u32 v3, 8192, v3
  v_mfma_f32_16x16x32_bf16 v[100:103], a[92:95], v[180:183], v[100:103]
  ds_read_b64_tr_b16 v[156:157], v11 offset:53248
  v_mfma_f32_16x16x32_bf16 v[96:99], a[88:91], v[180:183], v[96:99]
  ds_read_b64_tr_b16 v[158:159], v11 offset:53760
  v_mfma_f32_16x16x32_bf16 v[92:95], a[84:87], v[180:183], v[92:95]
  v_mfma_f32_16x16x32_bf16 v[104:107], a[84:87], v[184:187], v[104:107]
  global_load_dwordx4 a[64:67], v3, s[22:23] offset:-4096 sc1
  v_mfma_f32_16x16x32_bf16 v[108:111], a[88:91], v[184:187], v[108:111]
  v_mfma_f32_16x16x32_bf16 v[112:115], a[92:95], v[184:187], v[112:115]
  v_mfma_f32_16x16x32_bf16 v[124:127], a[92:95], v[188:191], v[124:127]
  v_mfma_f32_16x16x32_bf16 v[120:123], a[88:91], v[188:191], v[120:123]
  global_load_dwordx4 a[68:71], v3, s[22:23] offset:-3072 sc1
  v_mfma_f32_16x16x32_bf16 v[116:119], a[84:87], v[188:191], v[116:119]
  s_waitcnt lgkmcnt(0)
  v_mfma_f32_16x16x32_bf16 v[80:83], a[96:99], v[128:131], v[80:83]
  s_waitcnt vmcnt(30)
  s_waitcnt vmcnt(6)
  s_barrier
  s_cmp_lg_u32 s20, 0
  s_cbranch_scc1 f_nac0
  s_mov_b64 exec, 0xffffffff
  global_store_dword v18, v19, s[22:23] offset:0 sc1
  s_mov_b64 exec, -1
f_nac0:
  v_mfma_f32_16x16x32_bf16 v[84:87], a[100:103], v[128:131], v[84:87]
  ds_read_b64_tr_b16 v[160:161], v8 offset:57344
  v_mfma_f32_16x16x32_bf16 v[88:91], a[104:107], v[128:131], v[88:91]
  ds_read_b64_tr_b16 v[162:163], v8 offset:57856
  global_load_dwordx4 v[224:227], v15, s[22:23] offset:512 sc1
  v_mfma_f32_16x16x32_bf16 v[100:103], a[104:107], v[132:135], v[100:103]
  ds_read_b64_tr_b16 v[164:165], v9 offset:57344
  v_mfma_f32_16x16x32_bf16 v[96:99], a[100:103], v[132:135], v[96:99]
  ds_read_b64_tr_b16 v[166:167], v9 offset:57856
  v_mfma_f32_16x16x32_bf16 v[92:95], a[96:99], v[132:135], v[92:95]
  ds_read_b64_tr_b16 v[168:169], v10 offset:57344
  global_load_dwordx4 v[228:231], v15, s[22:23] offset:1536 sc1
  v_mfma_f32_16x16x32_bf16 v[104:107], a[96:99], v[136:139], v[104:107]
  ds_read_b64_tr_b16 v[170:171], v10 offset:57856
  v_mfma_f32_16x16x32_bf16 v[108:111], a[100:103], v[136:139], v[108:111]
  ds_read_b64_tr_b16 v[172:173], v11 offset:57344
  v_mfma_f32_16x16x32_bf16 v[112:115], a[104:107], v[136:139], v[112:115]
  ds_read_b64_tr_b16 v[174:175], v11 offset:57856
  global_load_dwordx4 a[72:75], v3, s[22:23] offset:-2048 sc1
  v_mfma_f32_16x16x32_bf16 v[124:127], a[104:107], v[140:143], v[124:127]
  ds_read_b64_tr_b16 v[176:177], v8 offset:61440
  v_mfma_f32_16x16x32_bf16 v[120:123], a[100:103], v[140:143], v[120:123]
  ds_read_b64_tr_b16 v[178:179], v8 offset:61952
  v_mfma_f32_16x16x32_bf16 v[116:119], a[96:99], v[140:143], v[116:119]
  ds_read_b64_tr_b16 v[180:181], v9 offset:61440
  global_load_dwordx4 a[76:79], v3, s[22:23] offset:-1024 sc1
  v_mfma_f32_16x16x32_bf16 v[80:83], a[108:111], v[144:147], v[80:83]
  ds_read_b64_tr_b16 v[182:183], v9 offset:61952
  v_mfma_f32_16x16x32_bf16 v[84:87], a[112:115], v[144:147], v[84:87]
  ds_read_b64_tr_b16 v[184:185], v10 offset:61440
  global_load_dwordx4 a[80:83], v3, s[22:23] offset:0 sc1
  v_mfma_f32_16x16x32_bf16 v[88:91], a[116:119], v[144:147], v[88:91]
  ds_read_b64_tr_b16 v[186:187], v10 offset:61952
  v_mfma_f32_16x16x32_bf16 v[100:103], a[116:119], v[148:151], v[100:103]
  ds_read_b64_tr_b16 v[188:189], v11 offset:61440
  v_mfma_f32_16x16x32_bf16 v[96:99], a[112:115], v[148:151], v[96:99]
  ds_read_b64_tr_b16 v[190:191], v11 offset:61952
  global_load_dwordx4 a[84:87], v3, s[22:23] offset:1024 sc1
  v_mfma_f32_16x16x32_bf16 v[92:95], a[108:111], v[148:151], v[92:95]
  v_mfma_f32_16x16x32_bf16 v[104:107], a[108:111], v[152:155], v[104:107]
  v_mfma_f32_16x16x32_bf16 v[108:111], a[112:115], v[152:155], v[108:111]
  global_load_dwordx4 a[88:91], v3, s[22:23] offset:2048 sc1
  v_mfma_f32_16x16x32_bf16 v[112:115], a[116:119], v[152:155], v[112:115]
  v_mfma_f32_16x16x32_bf16 v[124:127], a[116:119], v[156:159], v[124:127]
  v_mfma_f32_16x16x32_bf16 v[120:123], a[112:115], v[156:159], v[120:123]
  global_load_dwordx4 a[92:95], v3, s[22:23] offset:3072 sc1
  v_add_u32 v3, 8192, v3
  v_mfma_f32_16x16x32_bf16 v[116:119], a[108:111], v[156:159], v[116:119]
  v_add_u32 v8, 65536, v8
  v_add_u32 v9, 65536, v9
  v_add_u32 v10, 65536, v10
  v_add_u32 v11, 65536, v11
  s_waitcnt lgkmcnt(0)
  v_mfma_f32_16x16x32_bf16 v[80:83], a[120:123], v[160:163], v[80:83]
  s_barrier
  v_mfma_f32_16x16x32_bf16 v[84:87], a[124:127], v[160:163], v[84:87]
  ds_read_b64_tr_b16 v[128:129], v8 offset:0
  v_mfma_f32_16x16x32_bf16 v[88:91], a[128:131], v[160:163], v[88:91]
  ds_read_b64_tr_b16 v[130:131], v8 offset:512
  global_load_dwordx4 a[96:99], v3, s[22:23] offset:-4096 sc1
  v_mfma_f32_16x16x32_bf16 v[100:103], a[128:131], v[164:167], v[100:103]
  ds_read_b64_tr_b16 v[132:133], v9 offset:0
  v_mfma_f32_16x16x32_bf16 v[96:99], a[124:127], v[164:167], v[96:99]
  ds_read_b64_tr_b16 v[134:135], v9 offset:512
  v_mfma_f32_16x16x32_bf16 v[92:95], a[120:123], v[164:167], v[92:95]
  ds_read_b64_tr_b16 v[136:137], v10 offset:0
  v_mfma_f32_16x16x32_bf16 v[104:107], a[120:123], v[168:171], v[104:107]
  ds_read_b64_tr_b16 v[138:139], v10 offset:512
  global_load_dwordx4 a[100:103], v3, s[22:23] offset:-3072 sc1
  v_mfma_f32_16x16x32_bf16 v[108:111], a[124:127], v[168:171], v[108:111]
  ds_read_b64_tr_b16 v[140:141], v11 offset:0
  v_mfma_f32_16x16x32_bf16 v[112:115], a[128:131], v[168:171], v[112:115]
  ds_read_b64_tr_b16 v[142:143], v11 offset:512
  v_mfma_f32_16x16x32_bf16 v[124:127], a[128:131], v[172:175], v[124:127]
  ds_read_b64_tr_b16 v[144:145], v8 offset:4096
  v_mfma_f32_16x16x32_bf16 v[120:123], a[124:127], v[172:175], v[120:123]
  ds_read_b64_tr_b16 v[146:147], v8 offset:4608
  global_load_dwordx4 a[104:107], v3, s[22:23] offset:-2048 sc1
  v_mfma_f32_16x16x32_bf16 v[116:119], a[120:123], v[172:175], v[116:119]
  ds_read_b64_tr_b16 v[148:149], v9 offset:4096
  v_mfma_f32_16x16x32_bf16 v[80:83], a[132:135], v[176:179], v[80:83]
  ds_read_b64_tr_b16 v[150:151], v9 offset:4608
  v_mfma_f32_16x16x32_bf16 v[84:87], a[136:139], v[176:179], v[84:87]
  ds_read_b64_tr_b16 v[152:153], v10 offset:4096
  v_mfma_f32_16x16x32_bf16 v[88:91], a[140:143], v[176:179], v[88:91]
  ds_read_b64_tr_b16 v[154:155], v10 offset:4608
  global_load_dwordx4 a[108:111], v3, s[22:23] offset:-1024 sc1
  v_mfma_f32_16x16x32_bf16 v[100:103], a[140:143], v[180:183], v[100:103]
  ds_read_b64_tr_b16 v[156:157], v11 offset:4096
  v_mfma_f32_16x16x32_bf16 v[96:99], a[136:139], v[180:183], v[96:99]
  ds_read_b64_tr_b16 v[158:159], v11 offset:4608
  v_mfma_f32_16x16x32_bf16 v[92:95], a[132:135], v[180:183], v[92:95]
  v_mfma_f32_16x16x32_bf16 v[104:107], a[132:135], v[184:187], v[104:107]
  global_load_dwordx4 a[112:115], v3, s[22:23] offset:0 sc1
  v_mfma_f32_16x16x32_bf16 v[108:111], a[136:139], v[184:187], v[108:111]
  v_mfma_f32_16x16x32_bf16 v[112:115], a[140:143], v[184:187], v[112:115]
  v_mfma_f32_16x16x32_bf16 v[124:127], a[140:143], v[188:191], v[124:127]
  v_mfma_f32_16x16x32_bf16 v[120:123], a[136:139], v[188:191], v[120:123]
  global_load_dwordx4 a[116:119], v3, s[22:23] offset:1024 sc1
  v_mfma_f32_16x16x32_bf16 v[116:119], a[132:135], v[188:191], v[116:119]
  s_waitcnt vmcnt(12)
  v_min3_f32 v232, v225, v227, v229
  v_min_f32 v232, v232, v231
  v_cmp_gt_f32 vcc, 0, v232
  s_cbranch_vccnz f_sping1
f_okg1:
  s_waitcnt lgkmcnt(0)
  v_mfma_f32_16x16x32_bf16 v[80:83], a[144:147], v[128:131], v[80:83]
  ds_read_b64_tr_b16 v[160:161], v8 offset:8192
  v_add_f32 v224, v224, v228
  v_mfma_f32_16x16x32_bf16 v[84:87], a[148:151], v[128:131], v[84:87]
  ds_read_b64_tr_b16 v[162:163], v8 offset:8704
  v_add_f32 v225, v225, v229
  v_mfma_f32_16x16x32_bf16 v[88:91], a[152:155], v[128:131], v[88:91]
  ds_read_b64_tr_b16 v[164:165], v9 offset:8192
  global_load_dwordx4 a[120:123], v3, s[22:23] offset:2048 sc1
  v_mfma_f32_16x16x32_bf16 v[100:103], a[152:155], v[132:135], v[100:103]
  ds_read_b64_tr_b16 v[166:167], v9 offset:8704
  v_add_f32 v226, v226, v230
  v_mfma_f32_16x16x32_bf16 v[96:99], a[148:151], v[132:135], v[96:99]
  ds_read_b64_tr_b16 v[168:169], v10 offset:8192
  v_add_f32 v227, v227, v231
  v_mfma_f32_16x16x32_bf16 v[92:95], a[144:147], v[132:135], v[92:95]
  ds_read_b64_tr_b16 v[170:171], v10 offset:8704
  v_permlane32_swap_b32 v224, v226
  v_mfma_f32_16x16x32_bf16 v[104:107], a[144:147], v[136:139], v[104:107]
  ds_read_b64_tr_b16 v[172:173], v11 offset:8192
  global_load_dwordx4 a[124:127], v3, s[22:23] offset:3072 sc1
  v_add_u32 v3, 8192, v3
  v_mfma_f32_16x16x32_bf16 v[108:111], a[148:151], v[136:139], v[108:111]
  ds_read_b64_tr_b16 v[174:175], v11 offset:8704
  v_permlane32_swap_b32 v225, v227
  v_mfma_f32_16x16x32_bf16 v[112:115], a[152:155], v[136:139], v[112:115]
  ds_read_b64_tr_b16 v[176:177], v8 offset:12288
  v_add_f32 v224, v224, v226
  v_mfma_f32_16x16x32_bf16 v[124:127], a[152:155], v[140:143], v[124:127]
  ds_read_b64_tr_b16 v[178:179], v8 offset:12800
  v_add_f32 v225, v225, v227
  v_mfma_f32_16x16x32_bf16 v[120:123], a[148:151], v[140:143], v[120:123]
  ds_read_b64_tr_b16 v[180:181], v9 offset:12288
  global_load_dwordx4 a[128:131], v3, s[22:23] offset:-4096 sc1
  v_mfma_f32_16x16x32_bf16 v[116:119], a[144:147], v[140:143], v[116:119]
  ds_read_b64_tr_b16 v[182:183], v9 offset:12800
  v_add_f32_dpp v224, v224, v224 row_ror:8 row_mask:0xf bank_mask:0xf
  v_mfma_f32_16x16x32_bf16 v[80:83], a[156:159], v[144:147], v[80:83]
  ds_read_b64_tr_b16 v[184:185], v10 offset:12288
  v_add_f32_dpp v225, v225, v225 row_ror:8 row_mask:0xf bank_mask:0xf
  v_mfma_f32_16x16x32_bf16 v[84:87], a[160:163], v[144:147], v[84:87]
  ds_read_b64_tr_b16 v[186:187], v10 offset:12800
  v_mov_b32 v226, v224
  v_mfma_f32_16x16x32_bf16 v[88:91], a[164:167], v[144:147], v[88:91]
  ds_read_b64_tr_b16 v[188:189], v11 offset:12288
  global_load_dwordx4 a[132:135], v3, s[22:23] offset:-3072 sc1
  v_mfma_f32_16x16x32_bf16 v[100:103], a[164:167], v[148:151], v[100:103]
  ds_read_b64_tr_b16 v[190:191], v11 offset:12800
  v_mov_b32 v227, v225
  v_mfma_f32_16x16x32_bf16 v[96:99], a[160:163], v[148:151], v[96:99]
  v_permlane16_swap_b32 v224, v226
  v_mfma_f32_16x16x32_bf16 v[92:95], a[156:159], v[148:151], v[92:95]
  v_permlane16_swap_b32 v225, v227
  v_mfma_f32_16x16x32_bf16 v[104:107], a[156:159], v[152:155], v[104:107]
  global_load_dwordx4 a[136:139], v3, s[22:23] offset:-2048 sc1
  v_add_f32 v224, v224, v226
  v_mfma_f32_16x16x32_bf16 v[108:111], a[160:163], v[152:155], v[108:111]
  v_add_f32 v225, v225, v227
  v_mul_f32 v224, 0xbacccccd, v224
  v_mfma_f32_16x16x32_bf16 v[112:115], a[164:167], v[152:155], v[112:115]
  v_mul_f32 v225, 0x3acccccd, v225
  v_fma_f32 v225, -v224, v224, v225
  v_mfma_f32_16x16x32_bf16 v[124:127], a[164:167], v[156:159], v[124:127]
  v_cvt_pk_bf16_f32 v226, v224, v224
  v_max_f32 v225, 0, v225
  v_mfma_f32_16x16x32_bf16 v[120:123], a[160:163], v[156:159], v[120:123]
  global_load_dwordx4 a[140:143], v3, s[22:23] offset:-1024 sc1
  v_and_b32 v226, 0xffff0000, v226
  v_mfma_f32_16x16x32_bf16 v[116:119], a[156:159], v[156:159], v[116:119]
  v_add_f32 v238, 0x3727c5ac, v225
  s_waitcnt lgkmcnt(0)
  v_mfma_f32_16x16x32_bf16 v[80:83], a[168:171], v[160:163], v[80:83]
  ds_read_b64_tr_b16 v[128:129], v8 offset:16384
  v_sub_f32 v227, v224, v226
  v_mfma_f32_16x16x32_bf16 v[84:87], a[172:175], v[160:163], v[84:87]
  ds_read_b64_tr_b16 v[130:131], v8 offset:16896
  v_rsq_f32 v228, v238
  v_mfma_f32_16x16x32_bf16 v[88:91], a[176:179], v[160:163], v[88:91]
  ds_read_b64_tr_b16 v[132:133], v9 offset:16384
  global_load_dwordx4 a[144:147], v3, s[22:23] offset:0 sc1
  v_mfma_f32_16x16x32_bf16 v[100:103], a[176:179], v[164:167], v[100:103]
  ds_read_b64_tr_b16 v[134:135], v9 offset:16896
  v_sqrt_f32 v229, v238
  v_mfma_f32_16x16x32_bf16 v[96:99], a[172:175], v[164:167], v[96:99]
  ds_read_b64_tr_b16 v[136:137], v10 offset:16384
  v_cvt_pk_bf16_f32 v232, v226, v227
  v_mfma_f32_16x16x32_bf16 v[92:95], a[168:171], v[164:167], v[92:95]
  ds_read_b64_tr_b16 v[138:139], v10 offset:16896
  v_mul_f32 v237, 0xc0135761, v228
  v_mfma_f32_16x16x32_bf16 v[104:107], a[168:171], v[168:171], v[104:107]
  ds_read_b64_tr_b16 v[140:141], v11 offset:16384
  global_load_dwordx4 a[148:151], v3, s[22:23] offset:1024 sc1
  v_mfma_f32_16x16x32_bf16 v[108:111], a[172:175], v[168:171], v[108:111]
  ds_read_b64_tr_b16 v[142:143], v11 offset:16896
  v_cvt_pk_bf16_f32 v230, v229, v229
  v_mfma_f32_16x16x32_bf16 v[112:115], a[176:179], v[168:171], v[112:115]
  ds_read_b64_tr_b16 v[144:145], v8 offset:20480
  v_mul_f32 v228, v228, v228
  v_mfma_f32_16x16x32_bf16 v[124:127], a[176:179], v[172:175], v[124:127]
  ds_read_b64_tr_b16 v[146:147], v8 offset:20992
  v_and_b32 v230, 0xffff0000, v230
  v_mfma_f32_16x16x32_bf16 v[120:123], a[172:175], v[172:175], v[120:123]
  ds_read_b64_tr_b16 v[148:149], v9 offset:20480
  global_load_dwordx4 a[152:155], v3, s[22:23] offset:2048 sc1
  v_mfma_f32_16x16x32_bf16 v[116:119], a[168:171], v[172:175], v[116:119]
  ds_read_b64_tr_b16 v[150:151], v9 offset:20992
  v_mul_f32 v228, 0x3d372713, v228
  v_mfma_f32_16x16x32_bf16 v[80:83], a[180:183], v[176:179], v[80:83]
  ds_read_b64_tr_b16 v[152:153], v10 offset:20480
  v_sub_f32 v231, v229, v230
  v_mfma_f32_16x16x32_bf16 v[84:87], a[184:187], v[176:179], v[84:87]
  ds_read_b64_tr_b16 v[154:155], v10 offset:20992
  v_mul_f32 v236, v228, v237
  v_mfma_f32_16x16x32_bf16 v[88:91], a[188:191], v[176:179], v[88:91]
  ds_read_b64_tr_b16 v[156:157], v11 offset:20480
  global_load_dwordx4 a[156:159], v3, s[22:23] offset:3072 sc1
  v_add_u32 v3, 8192, v3
  v_mfma_f32_16x16x32_bf16 v[100:103], a[188:191], v[180:183], v[100:103]
  ds_read_b64_tr_b16 v[158:159], v11 offset:20992
  v_cvt_pk_bf16_f32 v234, v230, v231
  v_mfma_f32_16x16x32_bf16 v[96:99], a[184:187], v[180:183], v[96:99]
  v_mov_b32 v233, v232
  v_mov_b32 v235, v234
  v_mfma_f32_16x16x32_bf16 v[92:95], a[180:183], v[180:183], v[92:95]
  v_mov_b32_e64 v239, v238
  ds_write_b128 v16, v[232:235] offset:2048
  v_mfma_f32_16x16x32_bf16 v[104:107], a[180:183], v[184:187], v[104:107]
  global_load_dwordx4 a[160:163], v3, s[22:23] offset:-4096 sc1
  ds_write_b128 v16, v[236:239] offset:2064
  v_mfma_f32_16x16x32_bf16 v[108:111], a[184:187], v[184:187], v[108:111]
  v_mfma_f32_16x16x32_bf16 v[112:115], a[188:191], v[184:187], v[112:115]
  v_mfma_f32_16x16x32_bf16 v[124:127], a[188:191], v[188:191], v[124:127]
  v_mfma_f32_16x16x32_bf16 v[120:123], a[184:187], v[188:191], v[120:123]
  global_load_dwordx4 a[164:167], v3, s[22:23] offset:-3072 sc1
  v_mfma_f32_16x16x32_bf16 v[116:119], a[180:183], v[188:191], v[116:119]
  s_waitcnt lgkmcnt(0)
  v_mfma_f32_16x16x32_bf16 v[80:83], a[192:195], v[128:131], v[80:83]
  ds_read_b64_tr_b16 v[160:161], v8 offset:24576
  v_mfma_f32_16x16x32_bf16 v[84:87], a[196:199], v[128:131], v[84:87]
  ds_read_b64_tr_b16 v[162:163], v8 offset:25088
  s_mov_b64 exec, 15
  global_load_dword v24, v30, s[22:23] offset:0 sc1
  s_mov_b64 exec, -1
  v_mfma_f32_16x16x32_bf16 v[88:91], a[200:203], v[128:131], v[88:91]
  ds_read_b64_tr_b16 v[164:165], v9 offset:24576
  v_mfma_f32_16x16x32_bf16 v[100:103], a[200:203], v[132:135], v[100:103]
  ds_read_b64_tr_b16 v[166:167], v9 offset:25088
  v_mfma_f32_16x16x32_bf16 v[96:99], a[196:199], v[132:135], v[96:99]
  ds_read_b64_tr_b16 v[168:169], v10 offset:24576
  v_mfma_f32_16x16x32_bf16 v[92:95], a[192:195], v[132:135], v[92:95]
  ds_read_b64_tr_b16 v[170:171], v10 offset:25088
  global_load_dwordx4 a[168:171], v3, s[22:23] offset:-2048 sc1
  v_mfma_f32_16x16x32_bf16 v[104:107], a[192:195], v[136:139], v[104:107]
  ds_read_b64_tr_b16 v[172:173], v11 offset:24576
  v_mfma_f32_16x16x32_bf16 v[108:111], a[196:199], v[136:139], v[108:111]
  ds_read_b64_tr_b16 v[174:175], v11 offset:25088
  v_mfma_f32_16x16x32_bf16 v[112:115], a[200:203], v[136:139], v[112:115]
  ds_read_b64_tr_b16 v[176:177], v8 offset:28672
  global_load_dwordx4 a[172:175], v3, s[22:23] offset:-1024 sc1
  v_mfma_f32_16x16x32_bf16 v[124:127], a[200:203], v[140:143], v[124:127]
  ds_read_b64_tr_b16 v[178:179], v8 offset:29184
  v_mfma_f32_16x16x32_bf16 v[120:123], a[196:199], v[140:143], v[120:123]
  ds_read_b64_tr_b16 v[180:181], v9 offset:28672
  v_mfma_f32_16x16x32_bf16 v[116:119], a[192:195], v[140:143], v[116:119]
  ds_read_b64_tr_b16 v[182:183], v9 offset:29184
  v_mfma_f32_16x16x32_bf16 v[80:83], a[204:207], v[144:147], v[80:83]
  ds_read_b64_tr_b16 v[184:185], v10 offset:28672
  global_load_dwordx4 a[176:179], v3, s[22:23] offset:0 sc1
  v_mfma_f32_16x16x32_bf16 v[84:87], a[208:211], v[144:147], v[84:87]
  ds_read_b64_tr_b16 v[186:187], v10 offset:29184
  v_mfma_f32_16x16x32_bf16 v[88:91], a[212:215], v[144:147], v[88:91]
  ds_read_b64_tr_b16 v[188:189], v11 offset:28672
  v_mfma_f32_16x16x32_bf16 v[100:103], a[212:215], v[148:151], v[100:103]
  ds_read_b64_tr_b16 v[190:191], v11 offset:29184
  global_load_dwordx4 a[180:183], v3, s[22:23] offset:1024 sc1
  v_mfma_f32_16x16x32_bf16 v[96:99], a[208:211], v[148:151], v[96:99]
  v_mfma_f32_16x16x32_bf16 v[92:95], a[204:207], v[148:151], v[92:95]
  v_mfma_f32_16x16x32_bf16 v[104:107], a[204:207], v[152:155], v[104:107]
  global_load_dwordx4 a[184:187], v3, s[22:23] offset:2048 sc1
  v_mfma_f32_16x16x32_bf16 v[108:111], a[208:211], v[152:155], v[108:111]
  v_mfma_f32_16x16x32_bf16 v[112:115], a[212:215], v[152:155], v[112:115]
  v_mfma_f32_16x16x32_bf16 v[124:127], a[212:215], v[156:159], v[124:127]
  v_mfma_f32_16x16x32_bf16 v[120:123], a[208:211], v[156:159], v[120:123]
  global_load_dwordx4 a[188:191], v3, s[22:23] offset:3072 sc1
  v_add_u32 v3, 8192, v3
  v_mfma_f32_16x16x32_bf16 v[116:119], a[204:207], v[156:159], v[116:119]
  s_waitcnt lgkmcnt(0)
  v_mfma_f32_16x16x32_bf16 v[80:83], a[216:219], v[160:163], v[80:83]
  s_barrier
  v_mfma_f32_16x16x32_bf16 v[84:87], a[220:223], v[160:163], v[84:87]
  ds_read_b128 v[192:195], v17 offset:2048
  v_mfma_f32_16x16x32_bf16 v[88:91], a[224:227], v[160:163], v[88:91]
  ds_read_b128 v[200:203], v17 offset:2560
  global_load_dwordx4 a[192:195], v3, s[22:23] offset:-4096 sc1
  v_mfma_f32_16x16x32_bf16 v[100:103], a[224:227], v[164:167], v[100:103]
  ds_read_b128 v[208:211], v17 offset:3072
  v_mfma_f32_16x16x32_bf16 v[96:99], a[220:223], v[164:167], v[96:99]
  ds_read_b128 v[216:219], v17 offset:3584
  v_mfma_f32_16x16x32_bf16 v[92:95], a[216:219], v[164:167], v[92:95]
  ds_read_b128 v[196:199], v17 offset:2064
  v_mfma_f32_16x16x32_bf16 v[104:107], a[216:219], v[168:171], v[104:107]
  ds_read_b128 v[204:207], v17 offset:2576
  global_load_dwordx4 a[196:199], v3, s[22:23] offset:-3072 sc1
  v_mfma_f32_16x16x32_bf16 v[108:111], a[220:223], v[168:171], v[108:111]
  ds_read_b128 v[212:215], v17 offset:3088
  v_mfma_f32_16x16x32_bf16 v[112:115], a[224:227], v[168:171], v[112:115]
  ds_read_b128 v[220:223], v17 offset:3600
  v_mfma_f32_16x16x32_bf16 v[124:127], a[224:227], v[172:175], v[124:127]
  ds_read_b64_tr_b16 v[244:245], v31 offset:0
  v_mfma_f32_16x16x32_bf16 v[120:123], a[220:223], v[172:175], v[120:123]
  ds_read_b64_tr_b16 v[246:247], v31 offset:2048
  global_load_dwordx4 a[200:203], v3, s[22:23] offset:-2048 sc1
  v_mfma_f32_16x16x32_bf16 v[116:119], a[216:219], v[172:175], v[116:119]
  ds_read_b64_tr_b16 v[248:249], v31 offset:4096
  v_mfma_f32_16x16x32_bf16 v[80:83], a[228:231], v[176:179], v[80:83]
  ds_read_b64_tr_b16 v[250:251], v31 offset:6144
  v_mfma_f32_16x16x32_bf16 v[84:87], a[232:235], v[176:179], v[84:87]
  ds_read_b64_tr_b16 v[252:253], v31 offset:8192
  v_mfma_f32_16x16x32_bf16 v[88:91], a[236:239], v[176:179], v[88:91]
  global_load_dwordx4 a[204:207], v3, s[22:23] offset:-1024 sc1
  v_mfma_f32_16x16x32_bf16 v[100:103], a[236:239], v[180:183], v[100:103]
  v_mfma_f32_16x16x32_bf16 v[96:99], a[232:235], v[180:183], v[96:99]
  v_mfma_f32_16x16x32_bf16 v[92:95], a[228:231], v[180:183], v[92:95]
  v_mfma_f32_16x16x32_bf16 v[104:107], a[228:231], v[184:187], v[104:107]
  global_load_dwordx4 a[208:211], v3, s[22:23] offset:0 sc1
  v_mfma_f32_16x16x32_bf16 v[108:111], a[232:235], v[184:187], v[108:111]
  v_mfma_f32_16x16x32_bf16 v[112:115], a[236:239], v[184:187], v[112:115]
  v_mfma_f32_16x16x32_bf16 v[124:127], a[236:239], v[188:191], v[124:127]
  v_mfma_f32_16x16x32_bf16 v[120:123], a[232:235], v[188:191], v[120:123]
  global_load_dwordx4 a[212:215], v3, s[22:23] offset:1024 sc1
  v_mfma_f32_16x16x32_bf16 v[116:119], a[228:231], v[188:191], v[116:119]
  s_waitcnt lgkmcnt(0)
  v_mfma_f32_16x16x32_bf16 v[80:83], a[240:243], v[192:195], v[80:83]
  global_load_dwordx4 a[216:219], v3, s[22:23] offset:2048 sc1
  v_mfma_f32_16x16x32_bf16 v[92:95], a[240:243], v[200:203], v[92:95]
  v_mfma_f32_16x16x32_bf16 v[104:107], a[240:243], v[208:211], v[104:107]
  v_mfma_f32_16x16x32_bf16 v[116:119], a[240:243], v[216:219], v[116:119]
  v_mfma_f32_16x16x32_bf16 v[84:87], a[244:247], v[192:195], v[84:87]
  global_load_dwordx4 a[220:223], v3, s[22:23] offset:3072 sc1
  v_mfma_f32_16x16x32_bf16 v[96:99], a[244:247], v[200:203], v[96:99]
  v_mfma_f32_16x16x32_bf16 v[108:111], a[244:247], v[208:211], v[108:111]
  v_mfma_f32_16x16x32_bf16 v[120:123], a[244:247], v[216:219], v[120:123]
  v_mfma_f32_16x16x32_bf16 v[88:91], a[248:251], v[192:195], v[88:91]
  v_add_u32 v3, 8192, v3
  v_mfma_f32_16x16x32_bf16 v[100:103], a[248:251], v[200:203], v[100:103]
  v_mfma_f32_16x16x32_bf16 v[112:115], a[248:251], v[208:211], v[112:115]
  v_mfma_f32_16x16x32_bf16 v[124:127], a[248:251], v[216:219], v[124:127]
  s_waitcnt vmcnt(14)
  v_cmp_ne_u32 vcc, s65, v24
  s_cbranch_vccnz f_spinc0
f_okc0:
  v_pk_mul_f32 v[236:237], v[80:81], v[80:81]
  global_load_dwordx4 a[224:227], v3, s[22:23] offset:-4096 sc1
  v_pk_mul_f32 v[238:239], v[92:93], v[92:93]
  v_pk_mul_f32 v[240:241], v[104:105], v[104:105]
  v_pk_mul_f32 v[242:243], v[116:117], v[116:117]
  v_pk_fma_f32 v[236:237], v[236:237], v[196:197], v[196:197] op_sel:[0,0,1] op_sel_hi:[1,0,1]
  v_pk_fma_f32 v[238:239], v[238:239], v[204:205], v[204:205] op_sel:[0,0,1] op_sel_hi:[1,0,1]
  v_pk_fma_f32 v[240:241], v[240:241], v[212:213], v[212:213] op_sel:[0,0,1] op_sel_hi:[1,0,1]
  v_pk_fma_f32 v[242:243], v[242:243], v[220:221], v[220:221] op_sel:[0,0,1] op_sel_hi:[1,0,1]
  v_pk_mul_f32 v[236:237], v[236:237], v[80:81]
  v_pk_mul_f32 v[238:239], v[238:239], v[92:93]
  v_pk_mul_f32 v[240:241], v[240:241], v[104:105]
  v_pk_mul_f32 v[242:243], v[242:243], v[116:117]
  global_load_dwordx4 a[228:231], v3, s[22:23] offset:-3072 sc1
  v_exp_f32 v236, v236
  v_exp_f32 v237, v237
  v_pk_mul_f32 v[80:81], v[80:81], v[82:83]
  v_exp_f32 v238, v238
  v_exp_f32 v239, v239
  v_pk_mul_f32 v[92:93], v[92:93], v[94:95]
  v_exp_f32 v240, v240
  v_exp_f32 v241, v241
  v_pk_mul_f32 v[104:105], v[104:105], v[106:107]
  v_exp_f32 v242, v242
  v_exp_f32 v243, v243
  global_load_dwordx4 a[232:235], v3, s[22:23] offset:-2048 sc1
  v_pk_mul_f32 v[116:117], v[116:117], v[118:119]
  v_pk_fma_f32 v[236:237], v[236:237], v[198:199], v[198:199]
  v_pk_fma_f32 v[238:239], v[238:239], v[206:207], v[206:207]
  v_pk_fma_f32 v[240:241], v[240:241], v[214:215], v[214:215]
  v_pk_fma_f32 v[242:243], v[242:243], v[222:223], v[222:223]
  v_rcp_f32 v236, v236
  v_rcp_f32 v237, v237
  v_rcp_f32 v238, v238
  v_rcp_f32 v239, v239
  v_rcp_f32 v240, v240
  v_rcp_f32 v241, v241
  global_load_dwordx4 a[236:239], v3, s[22:23] offset:-1024 sc1
  v_rcp_f32 v242, v242
  v_rcp_f32 v243, v243
  v_pk_mul_f32 v[80:81], v[80:81], v[236:237]
  v_pk_mul_f32 v[92:93], v[92:93], v[238:239]
  v_pk_mul_f32 v[104:105], v[104:105], v[240:241]
  v_pk_mul_f32 v[116:117], v[116:117], v[242:243]
  v_cvt_pk_bf16_f32 v224, v80, v81
  v_cvt_pk_bf16_f32 v226, v104, v105
  v_cvt_pk_bf16_f32 v225, v92, v93
  v_cvt_pk_bf16_f32 v227, v116, v117
  v_permlane32_swap_b32 v224, v226
  s_nop 0
  v_permlane32_swap_b32 v225, v227
  s_nop 1
  v_permlane16_swap_b32 v224, v225
  v_permlane16_swap_b32 v226, v227
  global_store_dwordx4 v4, v[224:227], s[22:23] offset:0 sc1
  v_pk_mul_f32 v[236:237], v[84:85], v[84:85]
  global_load_dwordx4 v[32:35], v26, s[22:23] offset:-4096 sc1
  v_pk_mul_f32 v[238:239], v[96:97], v[96:97]
  v_pk_mul_f32 v[240:241], v[108:109], v[108:109]
  v_pk_mul_f32 v[242:243], v[120:121], v[120:121]
  v_pk_fma_f32 v[236:237], v[236:237], v[196:197], v[196:197] op_sel:[0,0,1] op_sel_hi:[1,0,1]
  v_pk_fma_f32 v[238:239], v[238:239], v[204:205], v[204:205] op_sel:[0,0,1] op_sel_hi:[1,0,1]
  v_pk_fma_f32 v[240:241], v[240:241], v[212:213], v[212:213] op_sel:[0,0,1] op_sel_hi:[1,0,1]
  v_pk_fma_f32 v[242:243], v[242:243], v[220:221], v[220:221] op_sel:[0,0,1] op_sel_hi:[1,0,1]
  global_load_dwordx4 v[36:39], v26, s[22:23] offset:0 sc1
  v_pk_mul_f32 v[236:237], v[236:237], v[84:85]
  v_pk_mul_f32 v[238:239], v[238:239], v[96:97]
  v_pk_mul_f32 v[240:241], v[240:241], v[108:109]
  v_pk_mul_f32 v[242:243], v[242:243], v[120:121]
  v_exp_f32 v236, v236
  v_exp_f32 v237, v237
  v_pk_mul_f32 v[84:85], v[84:85], v[86:87]
  v_add_u32 v26, 8192, v26
  v_exp_f32 v238, v238
  v_exp_f32 v239, v239
  v_pk_mul_f32 v[96:97], v[96:97], v[98:99]
  v_exp_f32 v240, v240
  v_exp_f32 v241, v241
  v_pk_mul_f32 v[108:109], v[108:109], v[110:111]
  v_exp_f32 v242, v242
  v_exp_f32 v243, v243
  global_load_dwordx4 v[40:43], v26, s[22:23] offset:-4096 sc1
  v_pk_mul_f32 v[120:121], v[120:121], v[122:123]
  v_pk_fma_f32 v[236:237], v[236:237], v[198:199], v[198:199]
  v_pk_fma_f32 v[238:239], v[238:239], v[206:207], v[206:207]
  v_pk_fma_f32 v[240:241], v[240:241], v[214:215], v[214:215]
  v_pk_fma_f32 v[242:243], v[242:243], v[222:223], v[222:223]
  v_rcp_f32 v236, v236
  v_rcp_f32 v237, v237
  global_load_dwordx4 v[44:47], v26, s[22:23] offset:0 sc1
  v_rcp_f32 v238, v238
  v_rcp_f32 v239, v239
  v_rcp_f32 v240, v240
  v_rcp_f32 v241, v241
  v_rcp_f32 v242, v242
  v_rcp_f32 v243, v243
  v_pk_mul_f32 v[84:85], v[84:85], v[236:237]
  v_add_u32 v26, 8192, v26
  v_pk_mul_f32 v[96:97], v[96:97], v[238:239]
  v_pk_mul_f32 v[108:109], v[108:109], v[240:241]
  v_pk_mul_f32 v[120:121], v[120:121], v[242:243]
  v_cvt_pk_bf16_f32 v228, v84, v85
  v_cvt_pk_bf16_f32 v230, v108, v109
  v_cvt_pk_bf16_f32 v229, v96, v97
  v_cvt_pk_bf16_f32 v231, v120, v121
  v_permlane32_swap_b32 v228, v230
  s_nop 0
  v_permlane32_swap_b32 v229, v231
  s_nop 1
  v_permlane16_swap_b32 v228, v229
  v_permlane16_swap_b32 v230, v231
  global_store_dwordx4 v4, v[228:231], s[22:23] offset:1024 sc1
  v_pk_mul_f32 v[236:237], v[88:89], v[88:89]
  global_load_dwordx4 v[48:51], v26, s[22:23] offset:-4096 sc1
  v_pk_mul_f32 v[238:239], v[100:101], v[100:101]
  v_pk_mul_f32 v[240:241], v[112:113], v[112:113]
  v_pk_mul_f32 v[242:243], v[124:125], v[124:125]
  v_pk_fma_f32 v[236:237], v[236:237], v[196:197], v[196:197] op_sel:[0,0,1] op_sel_hi:[1,0,1]
  v_pk_fma_f32 v[238:239], v[238:239], v[204:205], v[204:205] op_sel:[0,0,1] op_sel_hi:[1,0,1]
  v_pk_fma_f32 v[240:241], v[240:241], v[212:213], v[212:213] op_sel:[0,0,1] op_sel_hi:[1,0,1]
  v_pk_fma_f32 v[242:243], v[242:243], v[220:221], v[220:221] op_sel:[0,0,1] op_sel_hi:[1,0,1]
  global_load_dwordx4 v[52:55], v26, s[22:23] offset:0 sc1
  v_pk_mul_f32 v[236:237], v[236:237], v[88:89]
  v_pk_mul_f32 v[238:239], v[238:239], v[100:101]
  v_pk_mul_f32 v[240:241], v[240:241], v[112:113]
  v_pk_mul_f32 v[242:243], v[242:243], v[124:125]
  v_exp_f32 v236, v236
  v_exp_f32 v237, v237
  v_pk_mul_f32 v[88:89], v[88:89], v[90:91]
  v_add_u32 v26, 8192, v26
  v_exp_f32 v238, v238
  v_exp_f32 v239, v239
  v_pk_mul_f32 v[100:101], v[100:101], v[102:103]
  v_exp_f32 v240, v240
  v_exp_f32 v241, v241
  v_pk_mul_f32 v[112:113], v[112:113], v[114:115]
  v_exp_f32 v242, v242
  v_exp_f32 v243, v243
  global_load_dwordx4 v[56:59], v26, s[22:23] offset:-4096 sc1
  v_pk_mul_f32 v[124:125], v[124:125], v[126:127]
  v_pk_fma_f32 v[236:237], v[236:237], v[198:199], v[198:199]
  v_pk_fma_f32 v[238:239], v[238:239], v[206:207], v[206:207]
  v_pk_fma_f32 v[240:241], v[240:241], v[214:215], v[214:215]
  v_pk_fma_f32 v[242:243], v[242:243], v[222:223], v[222:223]
  v_rcp_f32 v236, v236
  v_rcp_f32 v237, v237
  global_load_dwordx4 v[60:63], v26, s[22:23] offset:0 sc1
  v_rcp_f32 v238, v238
  v_rcp_f32 v239, v239
  v_rcp_f32 v240, v240
  v_rcp_f32 v241, v241
  v_rcp_f32 v242, v242
  v_rcp_f32 v243, v243
  v_pk_mul_f32 v[88:89], v[88:89], v[236:237]
  v_add_u32 v26, 8192, v26
  v_pk_mul_f32 v[100:101], v[100:101], v[238:239]
  v_pk_mul_f32 v[112:113], v[112:113], v[240:241]
  v_pk_mul_f32 v[124:125], v[124:125], v[242:243]
  v_cvt_pk_bf16_f32 v232, v88, v89
  v_cvt_pk_bf16_f32 v234, v112, v113
  v_cvt_pk_bf16_f32 v233, v100, v101
  v_cvt_pk_bf16_f32 v235, v124, v125
  v_permlane32_swap_b32 v232, v234
  s_nop 0
  v_permlane32_swap_b32 v233, v235
  s_nop 1
  v_permlane16_swap_b32 v232, v233
  v_permlane16_swap_b32 v234, v235
  global_store_dwordx4 v4, v[232:235], s[22:23] offset:2048 sc1
  global_load_dwordx4 v[64:67], v26, s[22:23] offset:-4096 sc1
  s_waitcnt vmcnt(10)
  v_mfma_f32_16x16x32_bf16 v[80:83], a[0:3], v[32:35], 0
warm8:
  s_cbranch_execz warm_back
  global_load_dwordx4 v[68:71], v26, s[22:23] offset:0 sc1
  v_add_u32 v26, 8192, v26
  v_mfma_f32_16x16x32_bf16 v[84:87], a[4:7], v[32:35], 0
  s_lshr_b32 s8, s20, 1
  s_and_b32 s9, s20, 1
  v_mfma_f32_16x16x32_bf16 v[88:91], a[8:11], v[32:35], 0
  s_mul_i32 s10, s35, 1
  s_mul_i32 s11, s8, 16
  v_mfma_f32_16x16x32_bf16 v[92:95], a[12:15], v[32:35], 0
  s_add_u32 s14, s10, s11
  s_mul_i32 s10, s32, 320
  v_mfma_f32_16x16x32_bf16 v[96:99], a[16:19], v[32:35], 0
  s_add_u32 s10, s10, 12800
  s_waitcnt vmcnt(10)
  v_mfma_f32_16x16x32_bf16 v[80:83], a[20:23], v[36:39], v[80:83]
  global_load_dwordx4 v[72:75], v26, s[22:23] offset:-4096 sc1
  v_lshl_add_u32 v5, v1, 4, s10
  v_mfma_f32_16x16x32_bf16 v[84:87], a[24:27], v[36:39], v[84:87]
  s_lshl_b32 s10, s20, 10
  s_add_u32 s10, s10, 81920
  v_mfma_f32_16x16x32_bf16 v[88:91], a[28:31], v[36:39], v[88:91]
  v_lshl_add_u32 v2, v1, 4, s10
  v_lshl_add_u32 v17, v7, 4, s10
  v_mfma_f32_16x16x32_bf16 v[92:95], a[32:35], v[36:39], v[92:95]
  s_xor_b32 s10, s9, 1
  s_xor_b32 s11, s10, s20
  v_mfma_f32_16x16x32_bf16 v[96:99], a[36:39], v[36:39], v[96:99]
  s_mul_i32 s10, s10, 15360
  s_waitcnt vmcnt(10)
  v_mfma_f32_16x16x32_bf16 v[80:83], a[40:43], v[40:43], v[80:83]
  global_load_dwordx4 v[76:79], v26, s[22:23] offset:0 sc1
  s_mul_i32 s11, s11, 5120
  v_mfma_f32_16x16x32_bf16 v[84:87], a[44:47], v[40:43], v[84:87]
  s_add_u32 s10, s10, s11
  v_lshl_add_u32 v8, v1, 4, s10
  v_mfma_f32_16x16x32_bf16 v[88:91], a[48:51], v[40:43], v[88:91]
  s_xor_b32 s10, s9, 0
  s_xor_b32 s11, s10, s20
  v_mfma_f32_16x16x32_bf16 v[92:95], a[52:55], v[40:43], v[92:95]
  s_mul_i32 s10, s10, 15360
  s_mul_i32 s11, s11, 5120
  v_mfma_f32_16x16x32_bf16 v[96:99], a[56:59], v[40:43], v[96:99]
  s_add_u32 s10, s10, s11
  s_waitcnt vmcnt(10)
  v_mfma_f32_16x16x32_bf16 v[80:83], a[60:63], v[44:47], v[80:83]
  global_load_dwordx4 v[128:131], v27, s[22:23] offset:-4096 sc1
  v_lshl_add_u32 v9, v1, 4, s10
  v_mfma_f32_16x16x32_bf16 v[84:87], a[64:67], v[44:47], v[84:87]
  s_xor_b32 s10, s9, 3
  s_xor_b32 s11, s10, s20
  v_mfma_f32_16x16x32_bf16 v[88:91], a[68:71], v[44:47], v[88:91]
  s_mul_i32 s10, s10, 15360
  s_mul_i32 s11, s11, 5120
  v_mfma_f32_16x16x32_bf16 v[92:95], a[72:75], v[44:47], v[92:95]
  s_add_u32 s10, s10, s11
  v_lshl_add_u32 v10, v1, 4, s10
  v_mfma_f32_16x16x32_bf16 v[96:99], a[76:79], v[44:47], v[96:99]
  s_xor_b32 s10, s9, 2
  s_waitcnt vmcnt(9)
  v_mfma_f32_16x16x32_bf16 v[80:83], a[80:83], v[48:51], v[80:83]
  global_load_dwordx4 v[132:135], v27, s[22:23] offset:0 sc1
  v_add_u32 v27, 8192, v27
  v_mfma_f32_16x16x32_bf16 v[84:87], a[84:87], v[48:51], v[84:87]
  s_xor_b32 s11, s10, s20
  s_mul_i32 s10, s10, 15360
  v_mfma_f32_16x16x32_bf16 v[88:91], a[88:91], v[48:51], v[88:91]
  s_mul_i32 s11, s11, 5120
  s_add_u32 s10, s10, s11
  v_mfma_f32_16x16x32_bf16 v[92:95], a[92:95], v[48:51], v[92:95]
  v_lshl_add_u32 v11, v1, 4, s10
  s_mul_i32 s10, s20, 15360
  v_mfma_f32_16x16x32_bf16 v[96:99], a[96:99], v[48:51], v[96:99]
  v_lshl_add_u32 v12, v1, 4, s10
  s_waitcnt vmcnt(9)
  v_mfma_f32_16x16x32_bf16 v[80:83], a[100:103], v[52:55], v[80:83]
  global_load_dwordx4 v[136:139], v27, s[22:23] offset:-4096 sc1
  s_mul_i32 s10, s20, 2816
  v_mfma_f32_16x16x32_bf16 v[84:87], a[104:107], v[52:55], v[84:87]
  s_add_u32 s10, s10, 66560
  v_mul_u32_u24 v4, 176, v6
  v_mfma_f32_16x16x32_bf16 v[88:91], a[108:111], v[52:55], v[88:91]
  v_lshl_add_u32 v4, v7, 3, v4
  v_add_u32 v13, s10, v4
  v_mfma_f32_16x16x32_bf16 v[92:95], a[112:115], v[52:55], v[92:95]
  s_lshl_b32 s11, s14, 2
  s_add_u32 s11, s11, s16
  v_mfma_f32_16x16x32_bf16 v[96:99], a[116:119], v[52:55], v[96:99]
  s_mul_i32 s11, s11, 20480
  s_waitcnt vmcnt(9)
  v_mfma_f32_16x16x32_bf16 v[80:83], a[120:123], v[56:59], v[80:83]
  global_load_dwordx4 v[140:143], v27, s[22:23] offset:0 sc1
  v_add_u32 v27, 8192, v27
  v_mfma_f32_16x16x32_bf16 v[84:87], a[124:127], v[56:59], v[84:87]
  s_mul_i32 s12, s32, 160
  s_add_u32 s11, s11, s12
  v_mfma_f32_16x16x32_bf16 v[88:91], a[128:131], v[56:59], v[88:91]
  v_add_u32 v4, 0, v1
  v_min_u32 v4, 159, v4
  v_mfma_f32_16x16x32_bf16 v[92:95], a[132:135], v[56:59], v[92:95]
  v_mul_u32_u24 v31, 6554, v4
  v_lshrrev_b32 v31, 16, v31
  v_mfma_f32_16x16x32_bf16 v[96:99], a[136:139], v[56:59], v[96:99]
  v_add_u32 v20, v4, v31
  s_waitcnt vmcnt(9)
  v_mfma_f32_16x16x32_bf16 v[80:83], a[140:143], v[60:63], v[80:83]
  global_load_dwordx4 v[144:147], v27, s[22:23] offset:-4096 sc1
  s_waitcnt vmcnt(9)
  s_waitcnt lgkmcnt(0)
  s_barrier
  s_cmp_lg_u32 s20, 0
  s_cbranch_scc1 f_nac1
  s_mov_b64 exec, 0xffffffff
  global_store_dword v18, v19, s[22:23] offset:128 sc1
  s_mov_b64 exec, -1
f_nac1:
  v_mfma_f32_16x16x32_bf16 v[84:87], a[144:147], v[60:63], v[84:87]
  v_lshl_add_u32 v20, v20, 4, s10
  v_mul_u32_u24 v31, 1120, v31
  v_mfma_f32_16x16x32_bf16 v[88:91], a[148:151], v[60:63], v[88:91]
  v_lshl_add_u32 v31, v4, 4, v31
  v_add_u32 v14, s11, v31
  v_mfma_f32_16x16x32_bf16 v[92:95], a[152:155], v[60:63], v[92:95]
  v_add_u32 v4, 64, v1
  v_min_u32 v4, 159, v4
  v_mfma_f32_16x16x32_bf16 v[96:99], a[156:159], v[60:63], v[96:99]
  v_mul_u32_u24 v31, 6554, v4
  s_waitcnt vmcnt(8)
  v_mfma_f32_16x16x32_bf16 v[80:83], a[160:163], v[64:67], v[80:83]
  global_load_dwordx4 v[148:151], v27, s[22:23] offset:0 sc1
  v_add_u32 v27, 8192, v27
  v_mfma_f32_16x16x32_bf16 v[84:87], a[164:167], v[64:67], v[84:87]
  v_lshrrev_b32 v31, 16, v31
  v_add_u32 v21, v4, v31
  v_mfma_f32_16x16x32_bf16 v[88:91], a[168:171], v[64:67], v[88:91]
  v_lshl_add_u32 v21, v21, 4, s10
  v_mul_u32_u24 v31, 1120, v31
  v_mfma_f32_16x16x32_bf16 v[92:95], a[172:175], v[64:67], v[92:95]
  v_lshl_add_u32 v31, v4, 4, v31
  v_add_u32 v15, s11, v31
  v_mfma_f32_16x16x32_bf16 v[96:99], a[176:179], v[64:67], v[96:99]
  v_add_u32 v4, 128, v1
  s_waitcnt vmcnt(8)
  v_mfma_f32_16x16x32_bf16 v[80:83], a[180:183], v[68:71], v[80:83]
  global_load_dwordx4 v[152:155], v27, s[22:23] offset:-4096 sc1
  v_min_u32 v4, 159, v4
  v_mfma_f32_16x16x32_bf16 v[84:87], a[184:187], v[68:71], v[84:87]
  v_mul_u32_u24 v31, 6554, v4
  v_lshrrev_b32 v31, 16, v31
  v_mfma_f32_16x16x32_bf16 v[88:91], a[188:191], v[68:71], v[88:91]
  v_add_u32 v22, v4, v31
  v_lshl_add_u32 v22, v22, 4, s10
  v_mfma_f32_16x16x32_bf16 v[92:95], a[192:195], v[68:71], v[92:95]
  v_mul_u32_u24 v31, 1120, v31
  v_lshl_add_u32 v31, v4, 4, v31
  v_mfma_f32_16x16x32_bf16 v[96:99], a[196:199], v[68:71], v[96:99]
  v_add_u32 v16, s11, v31
  s_waitcnt vmcnt(8)
  v_mfma_f32_16x16x32_bf16 v[80:83], a[200:203], v[72:75], v[80:83]
  global_load_dwordx4 v[156:159], v27, s[22:23] offset:0 sc1
  v_add_u32 v27, 8192, v27
  s_mov_b64 exec, 0xfffff
  global_load_dwordx4 v[220:223], v5, s[22:23] sc1
  v_add_u32 v5, 15360, v5
  global_load_dwordx4 v[224:227], v5, s[22:23] sc1
  v_add_u32 v5, 15360, v5
  s_mov_b64 exec, -1
  v_mfma_f32_16x16x32_bf16 v[84:87], a[204:207], v[72:75], v[84:87]
  v_mfma_f32_16x16x32_bf16 v[88:91], a[208:211], v[72:75], v[88:91]
  v_mfma_f32_16x16x32_bf16 v[92:95], a[212:215], v[72:75], v[92:95]
  v_mfma_f32_16x16x32_bf16 v[96:99], a[216:219], v[72:75], v[96:99]
  s_waitcnt vmcnt(10)
  v_mfma_f32_16x16x32_bf16 v[80:83], a[220:223], v[76:79], v[80:83]
  global_load_dwordx4 v[160:163], v27, s[22:23] offset:-4096 sc1
  s_mov_b64 exec, 0xfffff
  global_load_dwordx4 v[228:231], v5, s[22:23] sc1
  v_add_u32 v5, 15360, v5
  global_load_dwordx4 v[232:235], v5, s[22:23] sc1
  v_add_u32 v5, 15360, v5
  s_mov_b64 exec, -1
  v_mfma_f32_16x16x32_bf16 v[84:87], a[224:227], v[76:79], v[84:87]
  v_mfma_f32_16x16x32_bf16 v[88:91], a[228:231], v[76:79], v[88:91]
  v_mfma_f32_16x16x32_bf16 v[92:95], a[232:235], v[76:79], v[92:95]
  v_mfma_f32_16x16x32_bf16 v[96:99], a[236:239], v[76:79], v[96:99]
  s_waitcnt vmcnt(12)
  v_mfma_f32_16x16x32_bf16 v[100:103], a[0:3], v[128:131], 0
  global_load_dwordx4 v[164:167], v27, s[22:23] offset:0 sc1
  v_add_u32 v27, 8192, v27
  v_mfma_f32_16x16x32_bf16 v[104:107], a[4:7], v[128:131], 0
  v_mfma_f32_16x16x32_bf16 v[108:111], a[8:11], v[128:131], 0
  v_mfma_f32_16x16x32_bf16 v[112:115], a[12:15], v[128:131], 0
  ds_write_b128 v8, v[80:83] offset:0
  v_mfma_f32_16x16x32_bf16 v[116:119], a[16:19], v[128:131], 0
  s_waitcnt vmcnt(12)
  v_mfma_f32_16x16x32_bf16 v[100:103], a[20:23], v[132:135], v[100:103]
  global_load_dwordx4 v[168:171], v27, s[22:23] offset:-4096 sc1
  v_mfma_f32_16x16x32_bf16 v[104:107], a[24:27], v[132:135], v[104:107]
  ds_write_b128 v8, v[84:87] offset:1024
  v_mfma_f32_16x16x32_bf16 v[108:111], a[28:31], v[132:135], v[108:111]
  v_mfma_f32_16x16x32_bf16 v[112:115], a[32:35], v[132:135], v[112:115]
  v_mfma_f32_16x16x32_bf16 v[116:119], a[36:39], v[132:135], v[116:119]
  ds_write_b128 v8, v[88:91] offset:2048
  s_waitcnt vmcnt(12)
  v_mfma_f32_16x16x32_bf16 v[100:103], a[40:43], v[136:139], v[100:103]
  global_load_dwordx4 v[172:175], v27, s[22:23] offset:0 sc1
  v_mfma_f32_16x16x32_bf16 v[104:107], a[44:47], v[136:139], v[104:107]
  v_mfma_f32_16x16x32_bf16 v[108:111], a[48:51], v[136:139], v[108:111]
  ds_write_b128 v8, v[92:95] offset:3072
  v_mfma_f32_16x16x32_bf16 v[112:115], a[52:55], v[136:139], v[112:115]
  v_mfma_f32_16x16x32_bf16 v[116:119], a[56:59], v[136:139], v[116:119]
  s_waitcnt vmcnt(12)
  v_mfma_f32_16x16x32_bf16 v[100:103], a[60:63], v[140:143], v[100:103]
  s_mov_b64 exec, 15
  global_load_dword v24, v30, s[22:23] offset:128 sc1
  s_mov_b64 exec, -1
  v_mfma_f32_16x16x32_bf16 v[104:107], a[64:67], v[140:143], v[104:107]
  ds_write_b128 v8, v[96:99] offset:4096
  v_mfma_f32_16x16x32_bf16 v[108:111], a[68:71], v[140:143], v[108:111]
  v_mfma_f32_16x16x32_bf16 v[112:115], a[72:75], v[140:143], v[112:115]
  v_mfma_f32_16x16x32_bf16 v[116:119], a[76:79], v[140:143], v[116:119]
  s_waitcnt vmcnt(12)
  v_mfma_f32_16x16x32_bf16 v[100:103], a[80:83], v[144:147], v[100:103]
  v_mfma_f32_16x16x32_bf16 v[104:107], a[84:87], v[144:147], v[104:107]
  v_mfma_f32_16x16x32_bf16 v[108:111], a[88:91], v[144:147], v[108:111]
  v_mfma_f32_16x16x32_bf16 v[112:115], a[92:95], v[144:147], v[112:115]
  v_mfma_f32_16x16x32_bf16 v[116:119], a[96:99], v[144:147], v[116:119]
  s_waitcnt vmcnt(11)
  v_mfma_f32_16x16x32_bf16 v[100:103], a[100:103], v[148:151], v[100:103]
  v_mfma_f32_16x16x32_bf16 v[104:107], a[104:107], v[148:151], v[104:107]
  v_mfma_f32_16x16x32_bf16 v[108:111], a[108:111], v[148:151], v[108:111]
  v_mfma_f32_16x16x32_bf16 v[112:115], a[112:115], v[148:151], v[112:115]
  v_mfma_f32_16x16x32_bf16 v[116:119], a[116:119], v[148:151], v[116:119]
  s_waitcnt vmcnt(10)
  v_mfma_f32_16x16x32_bf16 v[100:103], a[120:123], v[152:155], v[100:103]
  v_mfma_f32_16x16x32_bf16 v[104:107], a[124:127], v[152:155], v[104:107]
  v_mfma_f32_16x16x32_bf16 v[108:111], a[128:131], v[152:155], v[108:111]
  v_mfma_f32_16x16x32_bf16 v[112:115], a[132:135], v[152:155], v[112:115]
  v_mfma_f32_16x16x32_bf16 v[116:119], a[136:139], v[152:155], v[116:119]
  s_waitcnt vmcnt(9)
  v_mfma_f32_16x16x32_bf16 v[100:103], a[140:143], v[156:159], v[100:103]
  v_mfma_f32_16x16x32_bf16 v[104:107], a[144:147], v[156:159], v[104:107]
  v_mfma_f32_16x16x32_bf16 v[108:111], a[148:151], v[156:159], v[108:111]
  v_mfma_f32_16x16x32_bf16 v[112:115], a[152:155], v[156:159], v[112:115]
  v_mfma_f32_16x16x32_bf16 v[116:119], a[156:159], v[156:159], v[116:119]
  s_waitcnt vmcnt(6)
  v_mfma_f32_16x16x32_bf16 v[100:103], a[160:163], v[160:163], v[100:103]
  s_waitcnt vmcnt(0)
  v_cmp_ne_u32 vcc, s65, v24
  s_cbranch_vccnz f_spinc1
f_okc1:
  v_mfma_f32_16x16x32_bf16 v[104:107], a[164:167], v[160:163], v[104:107]
  global_load_dwordx4 v[32:35], v28, s[22:23] offset:-4096 sc1
  v_mfma_f32_16x16x32_bf16 v[108:111], a[168:171], v[160:163], v[108:111]
  v_mfma_f32_16x16x32_bf16 v[112:115], a[172:175], v[160:163], v[112:115]
  v_mfma_f32_16x16x32_bf16 v[116:119], a[176:179], v[160:163], v[116:119]
  v_mfma_f32_16x16x32_bf16 v[100:103], a[180:183], v[164:167], v[100:103]
  global_load_dwordx4 v[36:39], v28, s[22:23] offset:0 sc1
  v_add_u32 v28, 8192, v28
  v_mfma_f32_16x16x32_bf16 v[104:107], a[184:187], v[164:167], v[104:107]
  v_add_f32 v220, v220, v228
  v_add_f32 v221, v221, v229
  v_mfma_f32_16x16x32_bf16 v[108:111], a[188:191], v[164:167], v[108:111]
  v_add_f32 v222, v222, v230
  v_add_f32 v223, v223, v231
  v_mfma_f32_16x16x32_bf16 v[112:115], a[192:195], v[164:167], v[112:115]
  global_load_dwordx4 v[40:43], v28, s[22:23] offset:-4096 sc1
  v_add_f32 v224, v224, v232
  v_mfma_f32_16x16x32_bf16 v[116:119], a[196:199], v[164:167], v[116:119]
  v_add_f32 v225, v225, v233
  v_mfma_f32_16x16x32_bf16 v[100:103], a[200:203], v[168:171], v[100:103]
  global_load_dwordx4 v[44:47], v28, s[22:23] offset:0 sc1
  v_add_u32 v28, 8192, v28
  global_load_dwordx4 v[48:51], v28, s[22:23] offset:-4096 sc1
  global_load_dwordx4 v[52:55], v28, s[22:23] offset:0 sc1
  v_add_u32 v28, 8192, v28
  v_mfma_f32_16x16x32_bf16 v[104:107], a[204:207], v[168:171], v[104:107]
  v_add_f32 v226, v226, v234
  v_add_f32 v227, v227, v235
  v_mfma_f32_16x16x32_bf16 v[108:111], a[208:211], v[168:171], v[108:111]
  v_add_f32 v220, v220, v224
  v_add_f32 v221, v221, v225
  v_mfma_f32_16x16x32_bf16 v[112:115], a[212:215], v[168:171], v[112:115]
  global_load_dwordx4 v[56:59], v28, s[22:23] offset:-4096 sc1
  v_add_f32 v222, v222, v226
  v_mfma_f32_16x16x32_bf16 v[116:119], a[216:219], v[168:171], v[116:119]
  v_add_f32 v223, v223, v227
  v_mfma_f32_16x16x32_bf16 v[100:103], a[220:223], v[172:175], v[100:103]
  v_cvt_pk_bf16_f32 v31, v220, v221
  v_lshlrev_b32 v220, 16, v31
  v_mfma_f32_16x16x32_bf16 v[104:107], a[224:227], v[172:175], v[104:107]
  global_load_dwordx4 v[60:63], v28, s[22:23] offset:0 sc1
  v_add_u32 v28, 8192, v28
  v_mfma_f32_16x16x32_bf16 v[108:111], a[228:231], v[172:175], v[108:111]
  v_and_b32 v221, 0xffff0000, v31
  v_cvt_pk_bf16_f32 v31, v222, v223
  v_mfma_f32_16x16x32_bf16 v[112:115], a[232:235], v[172:175], v[112:115]
  v_lshlrev_b32 v222, 16, v31
  v_and_b32 v223, 0xffff0000, v31
  v_mfma_f32_16x16x32_bf16 v[116:119], a[236:239], v[172:175], v[116:119]
  global_load_dwordx4 v[64:67], v28, s[22:23] offset:-4096 sc1
  s_cmp_ge_u32 s20, 2
  s_cbranch_scc1 f_pathb
  s_waitcnt vmcnt(8)
  v_mfma_f32_16x16x32_bf16 v[120:123], a[0:3], v[32:35], 0
  global_load_dwordx4 v[68:71], v28, s[22:23] offset:0 sc1
  v_add_u32 v28, 8192, v28
  v_mfma_f32_16x16x32_bf16 v[124:127], a[4:7], v[32:35], 0
  ds_write_b128 v2, v[220:223]
  v_mfma_f32_16x16x32_bf16 v[128:131], a[8:11], v[32:35], 0
  v_mfma_f32_16x16x32_bf16 v[132:135], a[12:15], v[32:35], 0
  v_mfma_f32_16x16x32_bf16 v[136:139], a[16:19], v[32:35], 0
  ds_read_b128 v[220:223], v17 offset:0
  s_waitcnt vmcnt(8)
  v_mfma_f32_16x16x32_bf16 v[120:123], a[20:23], v[36:39], v[120:123]
  global_load_dwordx4 v[72:75], v28, s[22:23] offset:-4096 sc1
  ds_read_b128 v[224:227], v17 offset:64
  v_mfma_f32_16x16x32_bf16 v[124:127], a[24:27], v[36:39], v[124:127]
  ds_read_b128 v[228:231], v17 offset:128
  v_mfma_f32_16x16x32_bf16 v[128:131], a[28:31], v[36:39], v[128:131]
  ds_read_b128 v[232:235], v17 offset:192
  v_mfma_f32_16x16x32_bf16 v[132:135], a[32:35], v[36:39], v[132:135]
  ds_read_b128 v[236:239], v17 offset:256
  v_mfma_f32_16x16x32_bf16 v[136:139], a[36:39], v[36:39], v[136:139]
  s_waitcnt vmcnt(8)
  v_mfma_f32_16x16x32_bf16 v[120:123], a[40:43], v[40:43], v[120:123]
  global_load_dwordx4 v[76:79], v28, s[22:23] offset:0 sc1
  v_mfma_f32_16x16x32_bf16 v[124:127], a[44:47], v[40:43], v[124:127]
  v_mfma_f32_16x16x32_bf16 v[128:131], a[48:51], v[40:43], v[128:131]
  v_mfma_f32_16x16x32_bf16 v[132:135], a[52:55], v[40:43], v[132:135]
  v_mfma_f32_16x16x32_bf16 v[136:139], a[56:59], v[40:43], v[136:139]
  s_waitcnt vmcnt(8)
  v_mfma_f32_16x16x32_bf16 v[120:123], a[60:63], v[44:47], v[120:123]
  global_load_dwordx4 v[32:35], v29, s[22:23] offset:-4096 sc1
  v_mfma_f32_16x16x32_bf16 v[124:127], a[64:67], v[44:47], v[124:127]
  v_mfma_f32_16x16x32_bf16 v[128:131], a[68:71], v[44:47], v[128:131]
  v_mfma_f32_16x16x32_bf16 v[132:135], a[72:75], v[44:47], v[132:135]
  v_mfma_f32_16x16x32_bf16 v[136:139], a[76:79], v[44:47], v[136:139]
  s_waitcnt vmcnt(8)
  v_mfma_f32_16x16x32_bf16 v[120:123], a[80:83], v[48:51], v[120:123]
  global_load_dwordx4 v[36:39], v29, s[22:23] offset:0 sc1
  v_add_u32 v29, 8192, v29
  v_mfma_f32_16x16x32_bf16 v[124:127], a[84:87], v[48:51], v[124:127]
  v_mfma_f32_16x16x32_bf16 v[128:131], a[88:91], v[48:51], v[128:131]
  v_mfma_f32_16x16x32_bf16 v[132:135], a[92:95], v[48:51], v[132:135]
  v_mfma_f32_16x16x32_bf16 v[136:139], a[96:99], v[48:51], v[136:139]
  s_waitcnt lgkmcnt(0)
  s_barrier
  s_waitcnt vmcnt(8)
  v_mfma_f32_16x16x32_bf16 v[120:123], a[100:103], v[52:55], v[120:123]
  global_load_dwordx4 v[40:43], v29, s[22:23] offset:-4096 sc1
  ds_read_b128 v[160:163], v12 offset:5120
  v_mfma_f32_16x16x32_bf16 v[124:127], a[104:107], v[52:55], v[124:127]
  ds_read_b128 v[180:183], v12 offset:10240
  v_mfma_f32_16x16x32_bf16 v[128:131], a[108:111], v[52:55], v[128:131]
  ds_read_b128 v[164:167], v12 offset:6144
  v_mfma_f32_16x16x32_bf16 v[132:135], a[112:115], v[52:55], v[132:135]
  ds_read_b128 v[184:187], v12 offset:11264
  v_mfma_f32_16x16x32_bf16 v[136:139], a[116:119], v[52:55], v[136:139]
  ds_read_b128 v[168:171], v12 offset:7168
  s_waitcnt vmcnt(8)
  v_mfma_f32_16x16x32_bf16 v[120:123], a[120:123], v[56:59], v[120:123]
  global_load_dwordx4 v[44:47], v29, s[22:23] offset:0 sc1
  v_add_u32 v29, 8192, v29
  v_mfma_f32_16x16x32_bf16 v[124:127], a[124:127], v[56:59], v[124:127]
  ds_read_b128 v[188:191], v12 offset:12288
  v_mfma_f32_16x16x32_bf16 v[128:131], a[128:131], v[56:59], v[128:131]
  ds_read_b128 v[172:175], v12 offset:8192
  v_mfma_f32_16x16x32_bf16 v[132:135], a[132:135], v[56:59], v[132:135]
  ds_read_b128 v[192:195], v12 offset:13312
  v_mfma_f32_16x16x32_bf16 v[136:139], a[136:139], v[56:59], v[136:139]
  ds_read_b128 v[176:179], v12 offset:9216
  s_waitcnt vmcnt(8)
  v_mfma_f32_16x16x32_bf16 v[120:123], a[140:143], v[60:63], v[120:123]
  ds_read_b128 v[196:199], v12 offset:14336
  global_load_dwordx4 v[48:51], v29, s[22:23] offset:-4096 sc1
  v_mfma_f32_16x16x32_bf16 v[124:127], a[144:147], v[60:63], v[124:127]
  ds_read_b128 v[200:203], v12 offset:15360
  v_mfma_f32_16x16x32_bf16 v[128:131], a[148:151], v[60:63], v[128:131]
  ds_read_b128 v[204:207], v12 offset:16384
  v_mfma_f32_16x16x32_bf16 v[132:135], a[152:155], v[60:63], v[132:135]
  ds_read_b128 v[208:211], v12 offset:17408
  v_mfma_f32_16x16x32_bf16 v[136:139], a[156:159], v[60:63], v[136:139]
  ds_read_b128 v[212:215], v12 offset:18432
  s_waitcnt vmcnt(8)
  v_mfma_f32_16x16x32_bf16 v[120:123], a[160:163], v[64:67], v[120:123]
  ds_read_b128 v[216:219], v12 offset:19456
  v_mfma_f32_16x16x32_bf16 v[124:127], a[164:167], v[64:67], v[124:127]
  global_load_dwordx4 v[52:55], v29, s[22:23] offset:0 sc1
  v_add_u32 v29, 8192, v29
  v_mfma_f32_16x16x32_bf16 v[128:131], a[168:171], v[64:67], v[128:131]
  v_mfma_f32_16x16x32_bf16 v[132:135], a[172:175], v[64:67], v[132:135]
  v_mfma_f32_16x16x32_bf16 v[136:139], a[176:179], v[64:67], v[136:139]
  s_waitcnt lgkmcnt(5)
  v_add_f32 v160, v160, v180
  s_waitcnt vmcnt(8)
  v_mfma_f32_16x16x32_bf16 v[120:123], a[180:183], v[68:71], v[120:123]
  global_load_dwordx4 v[56:59], v29, s[22:23] offset:-4096 sc1
  v_add_f32 v161, v161, v181
  v_mfma_f32_16x16x32_bf16 v[124:127], a[184:187], v[68:71], v[124:127]
  v_add_f32 v162, v162, v182
  v_add_f32 v163, v163, v183
  v_mfma_f32_16x16x32_bf16 v[128:131], a[188:191], v[68:71], v[128:131]
  v_add_f32 v164, v164, v184
  v_add_f32 v165, v165, v185
  v_mfma_f32_16x16x32_bf16 v[132:135], a[192:195], v[68:71], v[132:135]
  v_add_f32 v166, v166, v186
  v_add_f32 v167, v167, v187
  v_mfma_f32_16x16x32_bf16 v[136:139], a[196:199], v[68:71], v[136:139]
  v_add_f32 v168, v168, v188
  s_waitcnt vmcnt(8)
  v_mfma_f32_16x16x32_bf16 v[120:123], a[200:203], v[72:75], v[120:123]
  global_load_dwordx4 v[60:63], v29, s[22:23] offset:0 sc1
  v_add_u32 v29, 8192, v29
  v_mfma_f32_16x16x32_bf16 v[124:127], a[204:207], v[72:75], v[124:127]
  v_add_f32 v169, v169, v189
  v_add_f32 v170, v170, v190
  v_mfma_f32_16x16x32_bf16 v[128:131], a[208:211], v[72:75], v[128:131]
  v_add_f32 v171, v171, v191
  v_add_f32 v172, v172, v192
  v_mfma_f32_16x16x32_bf16 v[132:135], a[212:215], v[72:75], v[132:135]
  v_add_f32 v173, v173, v193
  v_add_f32 v174, v174, v194
  v_mfma_f32_16x16x32_bf16 v[136:139], a[216:219], v[72:75], v[136:139]
  v_add_f32 v175, v175, v195
  s_waitcnt vmcnt(8)
  v_mfma_f32_16x16x32_bf16 v[120:123], a[220:223], v[76:79], v[120:123]
  global_load_dwordx4 v[64:67], v29, s[22:23] offset:-4096 sc1
  v_add_f32 v176, v176, v196
  v_mfma_f32_16x16x32_bf16 v[124:127], a[224:227], v[76:79], v[124:127]
  v_add_f32 v177, v177, v197
  v_add_f32 v178, v178, v198
  v_mfma_f32_16x16x32_bf16 v[128:131], a[228:231], v[76:79], v[128:131]
  v_add_f32 v179, v179, v199
  s_waitcnt lgkmcnt(0)
  v_add_f32 v100, v100, v200
  v_mfma_f32_16x16x32_bf16 v[132:135], a[232:235], v[76:79], v[132:135]
  v_add_f32 v101, v101, v201
  v_add_f32 v102, v102, v202
  v_mfma_f32_16x16x32_bf16 v[136:139], a[236:239], v[76:79], v[136:139]
  v_add_f32 v103, v103, v203
  s_waitcnt vmcnt(8)
  v_mfma_f32_16x16x32_bf16 v[140:143], a[0:3], v[32:35], 0
  global_load_dwordx4 v[68:71], v29, s[22:23] offset:0 sc1
  v_add_u32 v29, 8192, v29
  v_mfma_f32_16x16x32_bf16 v[144:147], a[4:7], v[32:35], 0
  v_add_f32 v104, v104, v204
  v_add_f32 v105, v105, v205
  v_mfma_f32_16x16x32_bf16 v[148:151], a[8:11], v[32:35], 0
  v_add_f32 v106, v106, v206
  v_add_f32 v107, v107, v207
  v_mfma_f32_16x16x32_bf16 v[152:155], a[12:15], v[32:35], 0
  ds_write_b128 v10, v[120:123] offset:0
  v_add_f32 v108, v108, v208
  v_mfma_f32_16x16x32_bf16 v[156:159], a[16:19], v[32:35], 0
  v_add_f32 v109, v109, v209
  s_waitcnt vmcnt(8)
  v_mfma_f32_16x16x32_bf16 v[140:143], a[20:23], v[36:39], v[140:143]
  global_load_dwordx4 v[72:75], v29, s[22:23] offset:-4096 sc1
  v_add_f32 v110, v110, v210
  v_mfma_f32_16x16x32_bf16 v[144:147], a[24:27], v[36:39], v[144:147]
  ds_write_b128 v10, v[124:127] offset:1024
  v_add_f32 v111, v111, v211
  v_mfma_f32_16x16x32_bf16 v[148:151], a[28:31], v[36:39], v[148:151]
  v_add_f32 v112, v112, v212
  v_add_f32 v113, v113, v213
  v_mfma_f32_16x16x32_bf16 v[152:155], a[32:35], v[36:39], v[152:155]
  v_add_f32 v114, v114, v214
  v_add_f32 v115, v115, v215
  v_mfma_f32_16x16x32_bf16 v[156:159], a[36:39], v[36:39], v[156:159]
  ds_write_b128 v10, v[128:131] offset:2048
  s_waitcnt vmcnt(8)
  v_mfma_f32_16x16x32_bf16 v[140:143], a[40:43], v[40:43], v[140:143]
  global_load_dwordx4 v[76:79], v29, s[22:23] offset:0 sc1
  v_add_f32 v116, v116, v216
  v_mfma_f32_16x16x32_bf16 v[144:147], a[44:47], v[40:43], v[144:147]
  v_add_f32 v117, v117, v217
  v_add_f32 v118, v118, v218
  v_mfma_f32_16x16x32_bf16 v[148:151], a[48:51], v[40:43], v[148:151]
  ds_write_b128 v10, v[132:135] offset:3072
  v_add_f32 v119, v119, v219
  v_mfma_f32_16x16x32_bf16 v[152:155], a[52:55], v[40:43], v[152:155]
  v_lshlrev_b32 v80, 16, v244
  v_and_b32 v81, 0xffff0000, v244
  v_mfma_f32_16x16x32_bf16 v[156:159], a[56:59], v[40:43], v[156:159]
  v_lshlrev_b32 v82, 16, v245
  s_waitcnt vmcnt(8)
  v_mfma_f32_16x16x32_bf16 v[140:143], a[60:63], v[44:47], v[140:143]
  ds_write_b128 v10, v[136:139] offset:4096
  v_and_b32 v83, 0xffff0000, v245
  v_mfma_f32_16x16x32_bf16 v[144:147], a[64:67], v[44:47], v[144:147]
  v_lshlrev_b32 v84, 16, v246
  v_and_b32 v85, 0xffff0000, v246
  v_mfma_f32_16x16x32_bf16 v[148:151], a[68:71], v[44:47], v[148:151]
  v_lshlrev_b32 v86, 16, v247
  v_and_b32 v87, 0xffff0000, v247
  v_mfma_f32_16x16x32_bf16 v[152:155], a[72:75], v[44:47], v[152:155]
  v_lshlrev_b32 v88, 16, v248
  v_and_b32 v89, 0xffff0000, v248
  v_mfma_f32_16x16x32_bf16 v[156:159], a[76:79], v[44:47], v[156:159]
  v_lshlrev_b32 v90, 16, v249
  s_waitcnt vmcnt(7)
  v_mfma_f32_16x16x32_bf16 v[140:143], a[80:83], v[48:51], v[140:143]
  v_and_b32 v91, 0xffff0000, v249
  v_lshlrev_b32 v92, 16, v250
  v_mfma_f32_16x16x32_bf16 v[144:147], a[84:87], v[48:51], v[144:147]
  v_and_b32 v93, 0xffff0000, v250
  v_lshlrev_b32 v94, 16, v251
  v_mfma_f32_16x16x32_bf16 v[148:151], a[88:91], v[48:51], v[148:151]
  v_and_b32 v95, 0xffff0000, v251
  v_lshlrev_b32 v96, 16, v252
  v_mfma_f32_16x16x32_bf16 v[152:155], a[92:95], v[48:51], v[152:155]
  v_and_b32 v97, 0xffff0000, v252
  v_lshlrev_b32 v98, 16, v253
  v_mfma_f32_16x16x32_bf16 v[156:159], a[96:99], v[48:51], v[156:159]
  v_and_b32 v99, 0xffff0000, v253
  s_waitcnt vmcnt(6)
  v_mfma_f32_16x16x32_bf16 v[140:143], a[100:103], v[52:55], v[140:143]
  v_add_f32 v100, v100, v160
  v_add_f32 v101, v101, v161
  v_mfma_f32_16x16x32_bf16 v[144:147], a[104:107], v[52:55], v[144:147]
  v_add_f32 v102, v102, v162
  v_add_f32 v103, v103, v163
  v_mfma_f32_16x16x32_bf16 v[148:151], a[108:111], v[52:55], v[148:151]
  v_add_f32 v104, v104, v164
  v_add_f32 v105, v105, v165
  v_mfma_f32_16x16x32_bf16 v[152:155], a[112:115], v[52:55], v[152:155]
  v_add_f32 v106, v106, v166
  v_add_f32 v107, v107, v167
  v_mfma_f32_16x16x32_bf16 v[156:159], a[116:119], v[52:55], v[156:159]
  v_add_f32 v108, v108, v168
  s_waitcnt vmcnt(5)
  v_mfma_f32_16x16x32_bf16 v[140:143], a[120:123], v[56:59], v[140:143]
  s_waitcnt lgkmcnt(0)
  s_barrier
  v_mfma_f32_16x16x32_bf16 v[144:147], a[124:127], v[56:59], v[144:147]
  v_add_f32 v109, v109, v169
  v_add_f32 v110, v110, v170
  v_mfma_f32_16x16x32_bf16 v[148:151], a[128:131], v[56:59], v[148:151]
  v_add_f32 v111, v111, v171
  v_add_f32 v112, v112, v172
  v_mfma_f32_16x16x32_bf16 v[152:155], a[132:135], v[56:59], v[152:155]
  v_add_f32 v113, v113, v173
  v_add_f32 v114, v114, v174
  v_mfma_f32_16x16x32_bf16 v[156:159], a[136:139], v[56:59], v[156:159]
  v_add_f32 v115, v115, v175
  s_waitcnt vmcnt(4)
  v_mfma_f32_16x16x32_bf16 v[140:143], a[140:143], v[60:63], v[140:143]
  v_add_f32 v116, v116, v176
  v_add_f32 v117, v117, v177
  v_mfma_f32_16x16x32_bf16 v[144:147], a[144:147], v[60:63], v[144:147]
  v_add_f32 v118, v118, v178
  v_add_f32 v119, v119, v179
  v_mfma_f32_16x16x32_bf16 v[148:151], a[148:151], v[60:63], v[148:151]
  v_fma_f32 v100, v100, v220, v80
  v_fma_f32 v101, v101, v221, v81
  v_mfma_f32_16x16x32_bf16 v[152:155], a[152:155], v[60:63], v[152:155]
  v_fma_f32 v102, v102, v222, v82
  v_fma_f32 v103, v103, v223, v83
  v_mfma_f32_16x16x32_bf16 v[156:159], a[156:159], v[60:63], v[156:159]
  v_cvt_pk_bf16_f32 v100, v100, v101
  s_waitcnt vmcnt(3)
  v_mfma_f32_16x16x32_bf16 v[140:143], a[160:163], v[64:67], v[140:143]
  v_cvt_pk_bf16_f32 v101, v102, v103
  ds_write_b64 v13, v[100:101] offset:0
  v_mfma_f32_16x16x32_bf16 v[144:147], a[164:167], v[64:67], v[144:147]
  v_fma_f32 v104, v104, v224, v84
  v_fma_f32 v105, v105, v225, v85
  v_mfma_f32_16x16x32_bf16 v[148:151], a[168:171], v[64:67], v[148:151]
  v_fma_f32 v106, v106, v226, v86
  v_fma_f32 v107, v107, v227, v87
  v_mfma_f32_16x16x32_bf16 v[152:155], a[172:175], v[64:67], v[152:155]
  v_cvt_pk_bf16_f32 v104, v104, v105
  v_cvt_pk_bf16_f32 v105, v106, v107
  v_mfma_f32_16x16x32_bf16 v[156:159], a[176:179], v[64:67], v[156:159]
  ds_write_b64 v13, v[104:105] offset:32
  s_waitcnt vmcnt(2)
  v_mfma_f32_16x16x32_bf16 v[140:143], a[180:183], v[68:71], v[140:143]
  v_fma_f32 v108, v108, v228, v88
  v_fma_f32 v109, v109, v229, v89
  v_mfma_f32_16x16x32_bf16 v[144:147], a[184:187], v[68:71], v[144:147]
  v_fma_f32 v110, v110, v230, v90
  v_fma_f32 v111, v111, v231, v91
  v_mfma_f32_16x16x32_bf16 v[148:151], a[188:191], v[68:71], v[148:151]
  v_cvt_pk_bf16_f32 v108, v108, v109
  v_cvt_pk_bf16_f32 v109, v110, v111
  v_mfma_f32_16x16x32_bf16 v[152:155], a[192:195], v[68:71], v[152:155]
  ds_write_b64 v13, v[108:109] offset:64
  v_fma_f32 v112, v112, v232, v92
  v_mfma_f32_16x16x32_bf16 v[156:159], a[196:199], v[68:71], v[156:159]
  v_fma_f32 v113, v113, v233, v93
  s_waitcnt vmcnt(1)
  v_mfma_f32_16x16x32_bf16 v[140:143], a[200:203], v[72:75], v[140:143]
  v_fma_f32 v114, v114, v234, v94
  v_fma_f32 v115, v115, v235, v95
  v_mfma_f32_16x16x32_bf16 v[144:147], a[204:207], v[72:75], v[144:147]
  v_cvt_pk_bf16_f32 v112, v112, v113
  v_cvt_pk_bf16_f32 v113, v114, v115
  v_mfma_f32_16x16x32_bf16 v[148:151], a[208:211], v[72:75], v[148:151]
  ds_write_b64 v13, v[112:113] offset:96
  v_fma_f32 v116, v116, v236, v96
  v_mfma_f32_16x16x32_bf16 v[152:155], a[212:215], v[72:75], v[152:155]
  v_fma_f32 v117, v117, v237, v97
  v_fma_f32 v118, v118, v238, v98
  v_mfma_f32_16x16x32_bf16 v[156:159], a[216:219], v[72:75], v[156:159]
  v_fma_f32 v119, v119, v239, v99
warm9:
  s_cbranch_execz warm_back
  s_waitcnt vmcnt(0)
  v_mfma_f32_16x16x32_bf16 v[140:143], a[220:223], v[76:79], v[140:143]
  v_cvt_pk_bf16_f32 v116, v116, v117
  v_cvt_pk_bf16_f32 v117, v118, v119
  v_mfma_f32_16x16x32_bf16 v[144:147], a[224:227], v[76:79], v[144:147]
  ds_write_b64 v13, v[116:117] offset:128
  v_mfma_f32_16x16x32_bf16 v[148:151], a[228:231], v[76:79], v[148:151]
  v_mfma_f32_16x16x32_bf16 v[152:155], a[232:235], v[76:79], v[152:155]
  v_mfma_f32_16x16x32_bf16 v[156:159], a[236:239], v[76:79], v[156:159]
  s_nop 0
  ds_write_b128 v11, v[140:143] offset:0
  s_nop 1
  ds_write_b128 v11, v[144:147] offset:1024
  s_nop 0
  ds_write_b128 v11, v[148:151] offset:2048
  ds_write_b128 v11, v[152:155] offset:3072
  ds_write_b128 v11, v[156:159] offset:4096
  s_waitcnt lgkmcnt(0)
  s_barrier
  ds_read_b128 v[160:163], v20
  ds_read_b128 v[164:167], v21
  ds_read_b128 v[168:171], v22
  s_waitcnt lgkmcnt(2)
  global_store_dwordx4 v14, v[160:163], s[66:67]
  s_waitcnt lgkmcnt(1)
  global_store_dwordx4 v15, v[164:167], s[66:67]
  s_waitcnt lgkmcnt(0)
  s_mov_b64 exec, 0xffffffff
  global_store_dwordx4 v16, v[168:171], s[66:67]
  s_mov_b64 exec, -1
  s_branch f_done
f_pathb:
  s_waitcnt vmcnt(8)
  v_mfma_f32_16x16x32_bf16 v[120:123], a[0:3], v[32:35], 0
  global_load_dwordx4 v[68:71], v28, s[22:23] offset:0 sc1
  v_add_u32 v28, 8192, v28
  v_mfma_f32_16x16x32_bf16 v[124:127], a[4:7], v[32:35], 0
  ds_write_b128 v2, v[220:223]
  v_mfma_f32_16x16x32_bf16 v[128:131], a[8:11], v[32:35], 0
  v_mfma_f32_16x16x32_bf16 v[132:135], a[12:15], v[32:35], 0
  v_mfma_f32_16x16x32_bf16 v[136:139], a[16:19], v[32:35], 0
  ds_write_b128 v9, v[100:103] offset:0
  s_waitcnt vmcnt(8)
  v_mfma_f32_16x16x32_bf16 v[120:123], a[20:23], v[36:39], v[120:123]
  global_load_dwordx4 v[72:75], v28, s[22:23] offset:-4096 sc1
  v_mfma_f32_16x16x32_bf16 v[124:127], a[24:27], v[36:39], v[124:127]
  v_mfma_f32_16x16x32_bf16 v[128:131], a[28:31], v[36:39], v[128:131]
  ds_write_b128 v9, v[104:107] offset:1024
  v_mfma_f32_16x16x32_bf16 v[132:135], a[32:35], v[36:39], v[132:135]
  v_mfma_f32_16x16x32_bf16 v[136:139], a[36:39], v[36:39], v[136:139]
  s_waitcnt vmcnt(8)
  v_mfma_f32_16x16x32_bf16 v[120:123], a[40:43], v[40:43], v[120:123]
  global_load_dwordx4 v[76:79], v28, s[22:23] offset:0 sc1
  ds_write_b128 v9, v[108:111] offset:2048
  v_mfma_f32_16x16x32_bf16 v[124:127], a[44:47], v[40:43], v[124:127]
  v_mfma_f32_16x16x32_bf16 v[128:131], a[48:51], v[40:43], v[128:131]
  v_mfma_f32_16x16x32_bf16 v[132:135], a[52:55], v[40:43], v[132:135]
  ds_write_b128 v9, v[112:115] offset:3072
  v_mfma_f32_16x16x32_bf16 v[136:139], a[56:59], v[40:43], v[136:139]
  s_waitcnt vmcnt(8)
  v_mfma_f32_16x16x32_bf16 v[120:123], a[60:63], v[44:47], v[120:123]
  global_load_dwordx4 v[32:35], v29, s[22:23] offset:-4096 sc1
  v_mfma_f32_16x16x32_bf16 v[124:127], a[64:67], v[44:47], v[124:127]
  ds_write_b128 v9, v[116:119] offset:4096
  v_mfma_f32_16x16x32_bf16 v[128:131], a[68:71], v[44:47], v[128:131]
  v_mfma_f32_16x16x32_bf16 v[132:135], a[72:75], v[44:47], v[132:135]
  v_mfma_f32_16x16x32_bf16 v[136:139], a[76:79], v[44:47], v[136:139]
  ds_read_b128 v[220:223], v17 offset:0
  s_waitcnt vmcnt(8)
  v_mfma_f32_16x16x32_bf16 v[120:123], a[80:83], v[48:51], v[120:123]
  global_load_dwordx4 v[36:39], v29, s[22:23] offset:0 sc1
  v_add_u32 v29, 8192, v29
  v_mfma_f32_16x16x32_bf16 v[124:127], a[84:87], v[48:51], v[124:127]
  ds_read_b128 v[224:227], v17 offset:64
  v_mfma_f32_16x16x32_bf16 v[128:131], a[88:91], v[48:51], v[128:131]
  ds_read_b128 v[228:231], v17 offset:128
  v_mfma_f32_16x16x32_bf16 v[132:135], a[92:95], v[48:51], v[132:135]
  ds_read_b128 v[232:235], v17 offset:192
  v_mfma_f32_16x16x32_bf16 v[136:139], a[96:99], v[48:51], v[136:139]
  s_waitcnt lgkmcnt(0)
  s_barrier
  s_waitcnt vmcnt(8)
  v_mfma_f32_16x16x32_bf16 v[120:123], a[100:103], v[52:55], v[120:123]
  global_load_dwordx4 v[40:43], v29, s[22:23] offset:-4096 sc1
  ds_read_b128 v[236:239], v17 offset:256
  v_mfma_f32_16x16x32_bf16 v[124:127], a[104:107], v[52:55], v[124:127]
  v_lshlrev_b32 v80, 16, v244
  v_and_b32 v81, 0xffff0000, v244
  v_mfma_f32_16x16x32_bf16 v[128:131], a[108:111], v[52:55], v[128:131]
  v_lshlrev_b32 v82, 16, v245
  v_and_b32 v83, 0xffff0000, v245
  v_mfma_f32_16x16x32_bf16 v[132:135], a[112:115], v[52:55], v[132:135]
  v_lshlrev_b32 v84, 16, v246
  v_and_b32 v85, 0xffff0000, v246
  v_mfma_f32_16x16x32_bf16 v[136:139], a[116:119], v[52:55], v[136:139]
  v_lshlrev_b32 v86, 16, v247
  s_waitcnt vmcnt(8)
  v_mfma_f32_16x16x32_bf16 v[120:123], a[120:123], v[56:59], v[120:123]
  global_load_dwordx4 v[44:47], v29, s[22:23] offset:0 sc1
  v_add_u32 v29, 8192, v29
  v_mfma_f32_16x16x32_bf16 v[124:127], a[124:127], v[56:59], v[124:127]
  v_and_b32 v87, 0xffff0000, v247
  v_lshlrev_b32 v88, 16, v248
  v_mfma_f32_16x16x32_bf16 v[128:131], a[128:131], v[56:59], v[128:131]
  v_and_b32 v89, 0xffff0000, v248
  v_lshlrev_b32 v90, 16, v249
  v_mfma_f32_16x16x32_bf16 v[132:135], a[132:135], v[56:59], v[132:135]
  v_and_b32 v91, 0xffff0000, v249
  v_lshlrev_b32 v92, 16, v250
  v_mfma_f32_16x16x32_bf16 v[136:139], a[136:139], v[56:59], v[136:139]
  v_and_b32 v93, 0xffff0000, v250
  s_waitcnt vmcnt(8)
  v_mfma_f32_16x16x32_bf16 v[120:123], a[140:143], v[60:63], v[120:123]
  global_load_dwordx4 v[48:51], v29, s[22:23] offset:-4096 sc1
  v_lshlrev_b32 v94, 16, v251
  v_mfma_f32_16x16x32_bf16 v[124:127], a[144:147], v[60:63], v[124:127]
  v_and_b32 v95, 0xffff0000, v251
  v_lshlrev_b32 v96, 16, v252
  v_mfma_f32_16x16x32_bf16 v[128:131], a[148:151], v[60:63], v[128:131]
  v_and_b32 v97, 0xffff0000, v252
  v_lshlrev_b32 v98, 16, v253
  v_mfma_f32_16x16x32_bf16 v[132:135], a[152:155], v[60:63], v[132:135]
  v_and_b32 v99, 0xffff0000, v253
  v_mfma_f32_16x16x32_bf16 v[136:139], a[156:159], v[60:63], v[136:139]
  s_waitcnt vmcnt(8)
  v_mfma_f32_16x16x32_bf16 v[120:123], a[160:163], v[64:67], v[120:123]
  global_load_dwordx4 v[52:55], v29, s[22:23] offset:0 sc1
  v_add_u32 v29, 8192, v29
  v_mfma_f32_16x16x32_bf16 v[124:127], a[164:167], v[64:67], v[124:127]
  v_mfma_f32_16x16x32_bf16 v[128:131], a[168:171], v[64:67], v[128:131]
  v_mfma_f32_16x16x32_bf16 v[132:135], a[172:175], v[64:67], v[132:135]
  v_mfma_f32_16x16x32_bf16 v[136:139], a[176:179], v[64:67], v[136:139]
  s_waitcnt vmcnt(8)
  v_mfma_f32_16x16x32_bf16 v[120:123], a[180:183], v[68:71], v[120:123]
  global_load_dwordx4 v[56:59], v29, s[22:23] offset:-4096 sc1
  v_mfma_f32_16x16x32_bf16 v[124:127], a[184:187], v[68:71], v[124:127]
  v_mfma_f32_16x16x32_bf16 v[128:131], a[188:191], v[68:71], v[128:131]
  v_mfma_f32_16x16x32_bf16 v[132:135], a[192:195], v[68:71], v[132:135]
  v_mfma_f32_16x16x32_bf16 v[136:139], a[196:199], v[68:71], v[136:139]
  s_waitcnt vmcnt(8)
  v_mfma_f32_16x16x32_bf16 v[120:123], a[200:203], v[72:75], v[120:123]
  global_load_dwordx4 v[60:63], v29, s[22:23] offset:0 sc1
  v_add_u32 v29, 8192, v29
  v_mfma_f32_16x16x32_bf16 v[124:127], a[204:207], v[72:75], v[124:127]
  v_mfma_f32_16x16x32_bf16 v[128:131], a[208:211], v[72:75], v[128:131]
  v_mfma_f32_16x16x32_bf16 v[132:135], a[212:215], v[72:75], v[132:135]
  v_mfma_f32_16x16x32_bf16 v[136:139], a[216:219], v[72:75], v[136:139]
  s_waitcnt vmcnt(8)
  v_mfma_f32_16x16x32_bf16 v[120:123], a[220:223], v[76:79], v[120:123]
  global_load_dwordx4 v[64:67], v29, s[22:23] offset:-4096 sc1
  v_mfma_f32_16x16x32_bf16 v[124:127], a[224:227], v[76:79], v[124:127]
  v_mfma_f32_16x16x32_bf16 v[128:131], a[228:231], v[76:79], v[128:131]
  v_mfma_f32_16x16x32_bf16 v[132:135], a[232:235], v[76:79], v[132:135]
  v_mfma_f32_16x16x32_bf16 v[136:139], a[236:239], v[76:79], v[136:139]
  s_waitcnt vmcnt(8)
  v_mfma_f32_16x16x32_bf16 v[140:143], a[0:3], v[32:35], 0
  global_load_dwordx4 v[68:71], v29, s[22:23] offset:0 sc1
  v_add_u32 v29, 8192, v29
  v_mfma_f32_16x16x32_bf16 v[144:147], a[4:7], v[32:35], 0
  v_mfma_f32_16x16x32_bf16 v[148:151], a[8:11], v[32:35], 0
  v_mfma_f32_16x16x32_bf16 v[152:155], a[12:15], v[32:35], 0
  ds_write_b128 v10, v[120:123] offset:0
  v_mfma_f32_16x16x32_bf16 v[156:159], a[16:19], v[32:35], 0
  s_waitcnt vmcnt(8)
  v_mfma_f32_16x16x32_bf16 v[140:143], a[20:23], v[36:39], v[140:143]
  global_load_dwordx4 v[72:75], v29, s[22:23] offset:-4096 sc1
  v_mfma_f32_16x16x32_bf16 v[144:147], a[24:27], v[36:39], v[144:147]
  ds_write_b128 v10, v[124:127] offset:1024
  v_mfma_f32_16x16x32_bf16 v[148:151], a[28:31], v[36:39], v[148:151]
  v_mfma_f32_16x16x32_bf16 v[152:155], a[32:35], v[36:39], v[152:155]
  v_mfma_f32_16x16x32_bf16 v[156:159], a[36:39], v[36:39], v[156:159]
  ds_write_b128 v10, v[128:131] offset:2048
  s_waitcnt vmcnt(8)
  v_mfma_f32_16x16x32_bf16 v[140:143], a[40:43], v[40:43], v[140:143]
  global_load_dwordx4 v[76:79], v29, s[22:23] offset:0 sc1
  v_mfma_f32_16x16x32_bf16 v[144:147], a[44:47], v[40:43], v[144:147]
  v_mfma_f32_16x16x32_bf16 v[148:151], a[48:51], v[40:43], v[148:151]
  ds_write_b128 v10, v[132:135] offset:3072
  v_mfma_f32_16x16x32_bf16 v[152:155], a[52:55], v[40:43], v[152:155]
  v_mfma_f32_16x16x32_bf16 v[156:159], a[56:59], v[40:43], v[156:159]
  s_waitcnt vmcnt(8)
  v_mfma_f32_16x16x32_bf16 v[140:143], a[60:63], v[44:47], v[140:143]
  ds_write_b128 v10, v[136:139] offset:4096
  v_mfma_f32_16x16x32_bf16 v[144:147], a[64:67], v[44:47], v[144:147]
  v_mfma_f32_16x16x32_bf16 v[148:151], a[68:71], v[44:47], v[148:151]
  v_mfma_f32_16x16x32_bf16 v[152:155], a[72:75], v[44:47], v[152:155]
  v_mfma_f32_16x16x32_bf16 v[156:159], a[76:79], v[44:47], v[156:159]
  s_waitcnt vmcnt(7)
  v_mfma_f32_16x16x32_bf16 v[140:143], a[80:83], v[48:51], v[140:143]
  v_mfma_f32_16x16x32_bf16 v[144:147], a[84:87], v[48:51], v[144:147]
  v_mfma_f32_16x16x32_bf16 v[148:151], a[88:91], v[48:51], v[148:151]
  v_mfma_f32_16x16x32_bf16 v[152:155], a[92:95], v[48:51], v[152:155]
  v_mfma_f32_16x16x32_bf16 v[156:159], a[96:99], v[48:51], v[156:159]
  s_waitcnt vmcnt(6)
  v_mfma_f32_16x16x32_bf16 v[140:143], a[100:103], v[52:55], v[140:143]
  v_mfma_f32_16x16x32_bf16 v[144:147], a[104:107], v[52:55], v[144:147]
  v_mfma_f32_16x16x32_bf16 v[148:151], a[108:111], v[52:55], v[148:151]
  v_mfma_f32_16x16x32_bf16 v[152:155], a[112:115], v[52:55], v[152:155]
  v_mfma_f32_16x16x32_bf16 v[156:159], a[116:119], v[52:55], v[156:159]
  s_waitcnt vmcnt(5)
  v_mfma_f32_16x16x32_bf16 v[140:143], a[120:123], v[56:59], v[140:143]
  s_waitcnt lgkmcnt(0)
  s_barrier
  v_mfma_f32_16x16x32_bf16 v[144:147], a[124:127], v[56:59], v[144:147]
  ds_read_b128 v[160:163], v12 offset:5120
  v_mfma_f32_16x16x32_bf16 v[148:151], a[128:131], v[56:59], v[148:151]
  ds_read_b128 v[200:203], v12 offset:15360
  v_mfma_f32_16x16x32_bf16 v[152:155], a[132:135], v[56:59], v[152:155]
  ds_read_b128 v[164:167], v12 offset:6144
  v_mfma_f32_16x16x32_bf16 v[156:159], a[136:139], v[56:59], v[156:159]
  ds_read_b128 v[204:207], v12 offset:16384
  s_waitcnt vmcnt(4)
  v_mfma_f32_16x16x32_bf16 v[140:143], a[140:143], v[60:63], v[140:143]
  ds_read_b128 v[168:171], v12 offset:7168
  v_mfma_f32_16x16x32_bf16 v[144:147], a[144:147], v[60:63], v[144:147]
  ds_read_b128 v[208:211], v12 offset:17408
  v_mfma_f32_16x16x32_bf16 v[148:151], a[148:151], v[60:63], v[148:151]
  ds_read_b128 v[172:175], v12 offset:8192
  v_mfma_f32_16x16x32_bf16 v[152:155], a[152:155], v[60:63], v[152:155]
  ds_read_b128 v[212:215], v12 offset:18432
  v_mfma_f32_16x16x32_bf16 v[156:159], a[156:159], v[60:63], v[156:159]
  ds_read_b128 v[176:179], v12 offset:9216
  s_waitcnt vmcnt(3)
  v_mfma_f32_16x16x32_bf16 v[140:143], a[160:163], v[64:67], v[140:143]
  ds_read_b128 v[216:219], v12 offset:19456
  v_mfma_f32_16x16x32_bf16 v[144:147], a[164:167], v[64:67], v[144:147]
  v_mfma_f32_16x16x32_bf16 v[148:151], a[168:171], v[64:67], v[148:151]
  v_mfma_f32_16x16x32_bf16 v[152:155], a[172:175], v[64:67], v[152:155]
  v_mfma_f32_16x16x32_bf16 v[156:159], a[176:179], v[64:67], v[156:159]
  s_waitcnt vmcnt(2)
  v_mfma_f32_16x16x32_bf16 v[140:143], a[180:183], v[68:71], v[140:143]
  v_mfma_f32_16x16x32_bf16 v[144:147], a[184:187], v[68:71], v[144:147]
  s_waitcnt lgkmcnt(3)
  v_add_f32 v160, v160, v200
  v_add_f32 v161, v161, v201
  v_mfma_f32_16x16x32_bf16 v[148:151], a[188:191], v[68:71], v[148:151]
  v_add_f32 v162, v162, v202
  v_add_f32 v163, v163, v203
  v_mfma_f32_16x16x32_bf16 v[152:155], a[192:195], v[68:71], v[152:155]
  v_add_f32 v164, v164, v204
  v_add_f32 v165, v165, v205
  v_mfma_f32_16x16x32_bf16 v[156:159], a[196:199], v[68:71], v[156:159]
  v_add_f32 v166, v166, v206
  s_waitcnt vmcnt(1)
  v_mfma_f32_16x16x32_bf16 v[140:143], a[200:203], v[72:75], v[140:143]
  v_add_f32 v167, v167, v207
  v_add_f32 v168, v168, v208
  v_mfma_f32_16x16x32_bf16 v[144:147], a[204:207], v[72:75], v[144:147]
  v_add_f32 v169, v169, v209
  v_add_f32 v170, v170, v210
  v_mfma_f32_16x16x32_bf16 v[148:151], a[208:211], v[72:75], v[148:151]
  v_add_f32 v171, v171, v211
  s_waitcnt lgkmcnt(0)
  v_add_f32 v172, v172, v212
  v_mfma_f32_16x16x32_bf16 v[152:155], a[212:215], v[72:75], v[152:155]
  v_add_f32 v173, v173, v213
  v_add_f32 v174, v174, v214
  v_mfma_f32_16x16x32_bf16 v[156:159], a[216:219], v[72:75], v[156:159]
  v_add_f32 v175, v175, v215
  s_waitcnt vmcnt(0)
  v_mfma_f32_16x16x32_bf16 v[140:143], a[220:223], v[76:79], v[140:143]
  v_add_f32 v176, v176, v216
  v_add_f32 v177, v177, v217
  v_mfma_f32_16x16x32_bf16 v[144:147], a[224:227], v[76:79], v[144:147]
  v_add_f32 v178, v178, v218
  v_add_f32_e64 v179, v179, v219
  v_mfma_f32_16x16x32_bf16 v[148:151], a[228:231], v[76:79], v[148:151]
  v_mfma_f32_16x16x32_bf16 v[152:155], a[232:235], v[76:79], v[152:155]
  v_mfma_f32_16x16x32_bf16 v[156:159], a[236:239], v[76:79], v[156:159]
  v_pk_add_f32 v[140:141], v[140:141], v[160:161]
  v_pk_add_f32 v[142:143], v[142:143], v[162:163]
  s_nop 0
  v_pk_add_f32 v[144:145], v[144:145], v[164:165]
  v_pk_add_f32 v[146:147], v[146:147], v[166:167]
  s_nop 0
  v_pk_add_f32 v[148:149], v[148:149], v[168:169]
  v_pk_add_f32 v[150:151], v[150:151], v[170:171]
  v_pk_add_f32 v[152:153], v[152:153], v[172:173]
  v_pk_add_f32 v[154:155], v[154:155], v[174:175]
  v_pk_add_f32 v[156:157], v[156:157], v[176:177]
  v_pk_add_f32 v[158:159], v[158:159], v[178:179]
  s_barrier
  ds_read_b128 v[180:183], v12 offset:10240
  ds_read_b128 v[184:187], v12 offset:11264
  ds_read_b128 v[188:191], v12 offset:12288
  ds_read_b128 v[192:195], v12 offset:13312
  ds_read_b128 v[196:199], v12 offset:14336
  s_waitcnt lgkmcnt(4)
  v_pk_add_f32 v[140:141], v[140:141], v[180:181]
  v_pk_add_f32 v[142:143], v[142:143], v[182:183]
  v_pk_fma_f32 v[140:141], v[140:141], v[220:221], v[80:81]
  v_pk_fma_f32 v[142:143], v[142:143], v[222:223], v[82:83]
  v_cvt_pk_bf16_f32 v140, v140, v141
  v_cvt_pk_bf16_f32 v141, v142, v143
  ds_write_b64 v13, v[140:141] offset:0
  s_waitcnt lgkmcnt(4)
  s_nop 0
  v_pk_add_f32 v[144:145], v[144:145], v[184:185]
  v_pk_add_f32 v[146:147], v[146:147], v[186:187]
  v_pk_fma_f32 v[144:145], v[144:145], v[224:225], v[84:85]
  v_pk_fma_f32 v[146:147], v[146:147], v[226:227], v[86:87]
  v_cvt_pk_bf16_f32 v144, v144, v145
  v_cvt_pk_bf16_f32 v145, v146, v147
  ds_write_b64 v13, v[144:145] offset:32
  s_waitcnt lgkmcnt(4)
  s_nop 0
  v_pk_add_f32 v[148:149], v[148:149], v[188:189]
  v_pk_add_f32 v[150:151], v[150:151], v[190:191]
  v_pk_fma_f32 v[148:149], v[148:149], v[228:229], v[88:89]
  v_pk_fma_f32 v[150:151], v[150:151], v[230:231], v[90:91]
  v_cvt_pk_bf16_f32 v148, v148, v149
  v_cvt_pk_bf16_f32 v149, v150, v151
  ds_write_b64 v13, v[148:149] offset:64
  s_waitcnt lgkmcnt(4)
  s_nop 0
  v_pk_add_f32 v[152:153], v[152:153], v[192:193]
  v_pk_add_f32 v[154:155], v[154:155], v[194:195]
  v_pk_fma_f32 v[152:153], v[152:153], v[232:233], v[92:93]
  v_pk_fma_f32 v[154:155], v[154:155], v[234:235], v[94:95]
  v_cvt_pk_bf16_f32 v152, v152, v153
  v_cvt_pk_bf16_f32 v153, v154, v155
  ds_write_b64 v13, v[152:153] offset:96
  s_waitcnt lgkmcnt(4)
  s_nop 0
  v_pk_add_f32 v[156:157], v[156:157], v[196:197]
  v_pk_add_f32 v[158:159], v[158:159], v[198:199]
  v_pk_fma_f32 v[156:157], v[156:157], v[236:237], v[96:97]
  v_pk_fma_f32 v[158:159], v[158:159], v[238:239], v[98:99]
  v_cvt_pk_bf16_f32 v156, v156, v157
  v_cvt_pk_bf16_f32 v157, v158, v159
  ds_write_b64 v13, v[156:157] offset:128
  ds_read_b128 v[160:163], v20
  ds_read_b128 v[164:167], v21
  ds_read_b128 v[168:171], v22
  s_waitcnt lgkmcnt(2)
  global_store_dwordx4 v14, v[160:163], s[66:67]
  s_waitcnt lgkmcnt(1)
  global_store_dwordx4 v15, v[164:167], s[66:67]
  s_waitcnt lgkmcnt(0)
  s_mov_b64 exec, 0xffffffff
  global_store_dwordx4 v16, v[168:171], s[66:67]
  s_mov_b64 exec, -1
f_done:
f_end:
  s_endpgm
u_spinm:
  s_mov_b32 s64, 0
u_spinm_l:
  s_waitcnt vmcnt(0)
  s_sleep 2
  global_load_dwordx2 v[208:209], v44, s[22:23] offset:2560 sc1
  global_load_dwordx2 v[210:211], v45, s[22:23] offset:2560 sc1
  global_load_dwordx2 v[212:213], v46, s[22:23] offset:2560 sc1
  global_load_dwordx2 v[214:215], v47, s[22:23] offset:2560 sc1
  s_waitcnt vmcnt(0)
  v_xor_b32 v209, s65, v209
  v_xor_b32 v211, s65, v211
  v_xor_b32 v213, s65, v213
  v_xor_b32 v215, s65, v215
  v_or3_b32 v209, v209, v211, v213
  v_or_b32 v209, v209, v215
  v_cmp_ne_u32 vcc, 0, v209
  s_add_u32 s64, s64, 1
  s_cmp_ge_u32 s64, 262144
  s_cbranch_scc1 u_okm
  s_cbranch_vccnz u_spinm_l
  s_branch u_okm
u_spinw:
  s_mov_b32 s64, 0
u_spinw_l:
  s_waitcnt vmcnt(0)
  s_sleep 2
  s_mov_b64 exec, 0xfff
  global_load_dword v11, v10, s[22:23] sc1
  s_mov_b64 exec, -1
  s_waitcnt vmcnt(0)
  v_cmp_ne_u32 vcc, s65, v11
  s_nop 0
  s_and_b64 vcc, vcc, 0xfff
  s_add_u32 s64, s64, 1
  s_cmp_ge_u32 s64, 262144
  s_cbranch_scc1 u_okw
  s_cbranch_vccnz u_spinw_l
  s_branch u_okw
u_hint2:
  s_mov_b32 s64, 0
u_hint2_l:
  s_waitcnt vmcnt(0)
  s_sleep 0
  s_mov_b64 exec, 0xfffff
  global_load_dword v109, v108, s[22:23] sc1
  s_mov_b64 exec, -1
  s_waitcnt vmcnt(0)
  v_cmp_ne_u32 vcc, s65, v109
  s_nop 0
  s_and_b64 vcc, vcc, 0xfffff
  s_add_u32 s64, s64, 1
  s_cmp_ge_u32 s64, 24
  s_cbranch_scc1 u_hint2_ok
  s_cbranch_vccnz u_hint2_l
  s_branch u_hint2_ok
u_hinta:
  s_mov_b32 s64, 0
u_hinta_l:
  s_waitcnt vmcnt(0)
  s_sleep 0
  s_mov_b64 exec, 0xffff
  global_load_dword v237, v244, s[22:23] sc1
  s_mov_b64 exec, -1
  s_waitcnt vmcnt(0)
  v_cmp_ne_u32 vcc, s65, v237
  s_nop 0
  s_and_b64 vcc, vcc, 0xffff
  s_add_u32 s64, s64, 1
  s_cmp_ge_u32 s64, 24
  s_cbranch_scc1 u_hinta_ok
  s_cbranch_vccnz u_hinta_l
  s_branch u_hinta_ok
u_spina:
  s_mov_b32 s64, 0
u_spina_l:
  s_waitcnt vmcnt(0)
  s_sleep 2
  s_mov_b64 exec, 0xffffffff
  global_load_dword v236, v225, s[22:23] sc1
  s_mov_b64 exec, -1
  s_waitcnt vmcnt(0)
  v_cmp_ne_u32 vcc, s65, v236
  s_nop 0
  s_and_b64 vcc, vcc, 0xffffffff
  s_add_u32 s64, s64, 1
  s_cmp_ge_u32 s64, 262144
  s_cbranch_scc1 u_oka
  s_cbranch_vccnz u_spina_l
  s_branch u_oka
u_spinmd:
  s_mov_b32 s64, 0
u_spinmd_l:
  s_waitcnt vmcnt(0)
  s_sleep 2
  s_mov_b64 exec, s[56:57]
  global_load_dwordx2 v[240:241], v227, s[22:23] sc1
  s_mov_b64 exec, -1
  s_waitcnt vmcnt(0)
  v_cmp_ne_u32 vcc, s65, v241
  s_nop 0
  s_and_b64 vcc, vcc, s[56:57]
  s_add_u32 s64, s64, 1
  s_cmp_ge_u32 s64, 262144
  s_cbranch_scc1 u_okmd
  s_cbranch_vccnz u_spinmd_l
  s_branch u_okmd
f_spinw:
  s_mov_b32 s64, 0
f_spinw_l:
  s_waitcnt vmcnt(0)
  s_sleep 2
  s_mov_b64 exec, 0xfff
  global_load_dword v106, v110, s[22:23] sc1
  s_mov_b64 exec, -1
  s_waitcnt vmcnt(0)
  v_cmp_ne_u32 vcc, s65, v106
  s_nop 0
  s_and_b64 vcc, vcc, 0xfff
  s_add_u32 s64, s64, 1
  s_cmp_ge_u32 s64, 262144
  s_cbranch_scc1 f_okw
  s_cbranch_vccnz f_spinw_l
  s_branch f_okw
u_hint1:
  s_mov_b32 s64, 0
u_hint1_l:
  s_waitcnt vmcnt(0)
  s_sleep 0
  s_mov_b64 exec, 0xfffff
  global_load_dword v109, v108, s[22:23] sc1
  s_mov_b64 exec, -1
  s_waitcnt vmcnt(0)
  v_cmp_ne_u32 vcc, s65, v109
  s_nop 0
  s_and_b64 vcc, vcc, 0xfffff
  s_add_u32 s64, s64, 1
  s_cmp_ge_u32 s64, 24
  s_cbranch_scc1 u_hint1_ok
  s_cbranch_vccnz u_hint1_l
  s_branch u_hint1_ok
f_spinb:
  s_mov_b32 s64, 0
f_spinb_l:
  s_waitcnt vmcnt(0)
  s_sleep 2
  global_load_dword v24, v5, s[22:23] sc1
  s_waitcnt vmcnt(0)
  v_cmp_ne_u32 vcc, s65, v24
  s_add_u32 s64, s64, 1
  s_cmp_ge_u32 s64, 262144
  s_cbranch_scc1 f_okb
  s_cbranch_vccnz f_spinb_l
  s_branch f_okb
u_spins:
  s_mov_b32 s64, 0
u_spins_l:
  s_waitcnt vmcnt(0)
  s_sleep 2
  global_load_dwordx2 v[208:209], v44, s[22:23] offset:-2560 sc1
  global_load_dwordx2 v[210:211], v45, s[22:23] offset:-2560 sc1
  global_load_dwordx2 v[212:213], v46, s[22:23] offset:-2560 sc1
  global_load_dwordx2 v[214:215], v47, s[22:23] offset:-2560 sc1
  s_waitcnt vmcnt(0)
  v_xor_b32 v209, s65, v209
  v_xor_b32 v211, s65, v211
  v_xor_b32 v213, s65, v213
  v_xor_b32 v215, s65, v215
  v_or3_b32 v209, v209, v211, v213
  v_or_b32 v209, v209, v215
  v_cmp_ne_u32 vcc, 0, v209
  s_add_u32 s64, s64, 1
  s_cmp_ge_u32 s64, 262144
  s_cbranch_scc1 u_oks
  s_cbranch_vccnz u_spins_l
  s_branch u_oks
f_spinb1:
  s_mov_b32 s64, 0
f_spinb1_l:
  s_waitcnt vmcnt(0)
  s_sleep 2
  global_load_dword v24, v5, s[22:23] sc1
  s_waitcnt vmcnt(0)
  v_cmp_ne_u32 vcc, s65, v24
  s_add_u32 s64, s64, 1
  s_cmp_ge_u32 s64, 262144
  s_cbranch_scc1 f_okb1
  s_cbranch_vccnz f_spinb1_l
  s_branch f_okb1
f_sping0:
  s_mov_b32 s64, 0
f_sping0_l:
  s_waitcnt vmcnt(0)
  s_sleep 2
  global_load_dwordx4 v[224:227], v15, s[22:23] offset:0 sc1
  global_load_dwordx4 v[228:231], v15, s[22:23] offset:1024 sc1
  s_waitcnt vmcnt(0)
  v_min3_f32 v232, v225, v227, v229
  v_min_f32 v232, v232, v231
  v_cmp_gt_f32 vcc, 0, v232
  s_add_u32 s64, s64, 1
  s_cmp_ge_u32 s64, 262144
  s_cbranch_scc1 f_okg0
  s_cbranch_vccnz f_sping0_l
  s_branch f_okg0
f_sping1:
  s_mov_b32 s64, 0
f_sping1_l:
  s_waitcnt vmcnt(0)
  s_sleep 2
  global_load_dwordx4 v[224:227], v15, s[22:23] offset:512 sc1
  global_load_dwordx4 v[228:231], v15, s[22:23] offset:1536 sc1
  s_waitcnt vmcnt(0)
  v_min3_f32 v232, v225, v227, v229
  v_min_f32 v232, v232, v231
  v_cmp_gt_f32 vcc, 0, v232
  s_add_u32 s64, s64, 1
  s_cmp_ge_u32 s64, 262144
  s_cbranch_scc1 f_okg1
  s_cbranch_vccnz f_sping1_l
  s_branch f_okg1
f_spinc0:
  s_mov_b32 s64, 0
f_spinc0_l:
  s_waitcnt vmcnt(0)
  s_sleep 2
  s_mov_b64 exec, 15
  global_load_dword v24, v30, s[22:23] offset:0 sc1
  s_mov_b64 exec, -1
  s_waitcnt vmcnt(0)
  v_cmp_ne_u32 vcc, s65, v24
  s_add_u32 s64, s64, 1
  s_cmp_ge_u32 s64, 262144
  s_cbranch_scc1 f_okc0
  s_cbranch_vccnz f_spinc0_l
  s_branch f_okc0
f_spinc1:
  s_mov_b32 s64, 0
f_spinc1_l:
  s_waitcnt vmcnt(0)
  s_sleep 2
  s_mov_b64 exec, 15
  global_load_dword v24, v30, s[22:23] offset:128 sc1
  s_mov_b64 exec, -1
  s_waitcnt vmcnt(0)
  v_cmp_ne_u32 vcc, s65, v24
  s_add_u32 s64, s64, 1
  s_cmp_ge_u32 s64, 262144
  s_cbranch_scc1 f_okc1
  s_cbranch_vccnz f_spinc1_l
  s_branch f_okc1
.section .rodata,"a"
.p2align 6
.amdhsa_kernel adaLN_cond__ssm_conv_s4__glu_gated_geglu__prompt_kernel
  .amdhsa_next_free_vgpr 512
  .amdhsa_next_free_sgpr 102
  .amdhsa_accum_offset 256
  .amdhsa_group_segment_fixed_size 0
  .amdhsa_kernarg_size 144
  .amdhsa_user_sgpr_count 2
  .amdhsa_user_sgpr_kernarg_segment_ptr 1
  .amdhsa_system_sgpr_workgroup_id_x 1
  .amdhsa_float_denorm_mode_32 3
.end_amdhsa_kernel
.text
code_end:
```
